```python
import torch

def _softmax(x, axis=-1):
    return torch.softmax(x, dim=axis)

def _gelu(x):
    return torch.nn.functional.gelu(x, approximate='tanh')

def _silu(x):
    return torch.nn.functional.silu(x)

def _sigmoid(x):
    return torch.sigmoid(x)

def _layernorm(x, axis=-1, eps=1e-05):
    m = x.mean(dim=axis, keepdim=True)
    v = x.var(dim=axis, keepdim=True, unbiased=False)
    return (x - m) / torch.sqrt(v + eps)

def _scatter_add(tgt, idx, src, axis=0):
    return tgt.clone().index_add_(axis, idx, src)

def _segment_sum(src, seg, n):
    out = torch.zeros((n,) + src.shape[1:], dtype=src.dtype)
    return out.index_add_(0, seg, src)

def _pad(x, pw):
    flat = tuple((v for pair in reversed(pw) for v in pair))
    return torch.nn.functional.pad(x, flat)
kernel_name = 'standalone__swin_window_attn__vision'

def setup_inputs():

    _w = lambda a: (lambda t: t.to(torch.bfloat16) if t.is_floating_point() else t)(torch.as_tensor(a))
    H = W = 384 // 7 * 7
    C, win = (384, 7)
    return {'x': _w((lambda *s: torch.randn(*s, dtype=torch.bfloat16) * 0.2)(1, H, W, C)), 'wqkv': _w((lambda *s: torch.randn(*s, dtype=torch.bfloat16) * 0.2)(C, 3 * C)), 'wo': _w((lambda *s: torch.randn(*s, dtype=torch.bfloat16) * 0.05)(C, C))}

def reference(x, wqkv, wo):
    B, H, W, C = x.shape
    win = 7
    nh, nw = (H // win, W // win)
    xw = (lambda x, *d: x.permute(*d))(x.reshape(B, nh, win, nw, win, C), 0, 1, 3, 2, 4, 5)
    xw = xw.reshape(B * nh * nw, win * win, C)
    qkv = xw @ wqkv
    q, k, v = (qkv[..., :C].clone(), qkv[..., C:2 * C].clone(), qkv[..., 2 * C:].clone())
    scale = C ** (-0.5)
    p = _softmax(torch.einsum('bqc,bkc->bqk', q, k) * scale, axis=-1)
    o = torch.einsum('bqk,bkc->bqc', p, v) @ wo
    o = (lambda x, *d: x.permute(*d))(o.reshape(B, nh, nw, win, win, C), 0, 1, 3, 2, 4, 5)
    return o.reshape(B, H, W, C)
```

```asm
; @launch grid=(256,1,1) block=(256,1,1) lds=161280
.amdgcn_target "amdgcn-amd-amdhsa--gfx950"
.text
.globl standalone__swin_window_attn__vision_kernel
.p2align 8
.type standalone__swin_window_attn__vision_kernel,@function
standalone__swin_window_attn__vision_kernel:
    s_cmp_ge_u32 s2, 256
    s_cbranch_scc1 L_end
    s_load_dwordx4 s[4:7], s[0:1], 0
    s_load_dwordx4 s[8:11], s[0:1], 16
    s_load_dwordx4 s[12:15], s[0:1], 32
    v_and_b32 v25, 63, v0
    s_getpc_b64 s[64:65]
L_pc_entry:
    v_min_u32 v22, (L_round-L_pc_entry)/128, v25
    v_lshlrev_b32 v22, 7, v22
    v_mov_b32 v23, s65
    v_add_co_u32 v22, vcc, s64, v22
    s_nop 1
    v_addc_co_u32 v23, vcc, 0, v23, vcc
    global_load_dword v41, v[22:23], off
    s_add_u32 s64, s64, L_nofold1-L_pc_entry
    s_addc_u32 s65, s65, 0
    v_min_u32 v22, (L_code_end-L_nofold1)/128-1, v25
    v_lshlrev_b32 v22, 7, v22
    v_mov_b32 v23, s65
    v_add_co_u32 v22, vcc, s64, v22
    s_nop 1
    v_addc_co_u32 v23, vcc, 0, v23, vcc
    global_load_dword v41, v[22:23], off
    v_lshrrev_b32 v22, 6, v0
    v_lshrrev_b32 v20, 4, v25
    v_readfirstlane_b32 s28, v22
    v_and_b32 v21, 15, v25
    v_lshlrev_b32 v1, 4, v25
    v_add_u32 v2, 49152, v1
    s_waitcnt lgkmcnt(0)
    s_cmp_lt_u32 s2, 13
    s_cbranch_scc1 L_server
    s_sub_u32 s30, s2, 13
    s_cmp_ge_u32 s30, 144
    s_cbranch_scc1 L_nofold1
    s_mov_b32 s52, s6
    s_mov_b32 s53, s7
    s_mov_b32 s54, 884736
    s_mov_b32 s55, 0x20000
    s_mov_b32 s56, s8
    s_mov_b32 s57, s9
    s_mov_b32 s58, 294912
    s_mov_b32 s59, 0x20000
    s_cmp_ge_u32 s30, 72
    s_cselect_b32 s60, 1, 0
    s_mul_i32 s61, s60, 72
    s_sub_u32 s61, s30, s61
    s_mul_i32 s62, s61, 5462
    s_lshr_b32 s62, s62, 16
    s_mul_i32 s63, s62, 12
    s_sub_u32 s63, s61, s63
    s_mov_b32 s40, 2304
    s_lshl_b32 s41, s63, 5
    s_add_u32 s41, s41, s28
    s_mul_i32 s44, s60, 1536
    v_lshlrev_b32 v22, 3, v20
    v_add_u32 v22, s41, v22
    v_mul_lo_u32 v22, v22, s40
    v_lshlrev_b32 v24, 4, v21
    v_add3_u32 v26, v22, v24, s44
    s_mul_i32 s45, s28, 1088
    s_mov_b32 s41, 0
    s_add_u32 m0, s45, 0
    s_nop 0
    buffer_load_dwordx4 v26, s[52:55], s41 offen offset:0 lds
    s_add_u32 m0, s45, 4096
    s_nop 0
    buffer_load_dwordx4 v26, s[52:55], s41 offen offset:256 lds
    s_add_u32 m0, s45, 8192
    s_nop 0
    buffer_load_dwordx4 v26, s[52:55], s41 offen offset:512 lds
    s_mov_b32 s41, 9216
    s_add_u32 m0, s45, 13056
    s_nop 0
    buffer_load_dwordx4 v26, s[52:55], s41 offen offset:0 lds
    s_add_u32 m0, s45, 17152
    s_nop 0
    buffer_load_dwordx4 v26, s[52:55], s41 offen offset:256 lds
    s_add_u32 m0, s45, 21248
    s_nop 0
    buffer_load_dwordx4 v26, s[52:55], s41 offen offset:512 lds
    s_cmp_eq_u32 s60, 1
    s_cbranch_scc1 L_fold_n
    s_lshr_b32 s41, s28, 1
    s_lshl_b32 s44, s62, 1
    s_add_u32 s41, s41, s44
    s_and_b32 s44, s28, 1
    s_lshl_b32 s61, s41, 5
    s_lshl_b32 s45, s44, 2
    s_add_u32 s61, s61, s45
    v_lshlrev_b32 v22, 3, v20
    v_add_u32 v22, s61, v22
    v_mul_lo_u32 v22, v22, s40
    v_add3_u32 v27, v22, v24, 0
    v_add_u32 v27, 768, v27
    s_mul_i32 s45, s28, 13056
    s_add_u32 s45, s45, 26112
    s_mov_b32 s61, 0
    s_add_u32 m0, s45, 0
    s_nop 0
    buffer_load_dwordx4 v27, s[52:55], s61 offen offset:0 lds
    s_add_u32 m0, s45, 4096
    s_nop 0
    buffer_load_dwordx4 v27, s[52:55], s61 offen offset:256 lds
    s_add_u32 m0, s45, 8192
    s_nop 0
    buffer_load_dwordx4 v27, s[52:55], s61 offen offset:512 lds
    s_mov_b32 s61, 2304
    s_add_u32 m0, s45, 1088
    s_nop 0
    buffer_load_dwordx4 v27, s[52:55], s61 offen offset:0 lds
    s_add_u32 m0, s45, 5184
    s_nop 0
    buffer_load_dwordx4 v27, s[52:55], s61 offen offset:256 lds
    s_add_u32 m0, s45, 9280
    s_nop 0
    buffer_load_dwordx4 v27, s[52:55], s61 offen offset:512 lds
    s_mov_b32 s61, 4608
    s_add_u32 m0, s45, 2176
    s_nop 0
    buffer_load_dwordx4 v27, s[52:55], s61 offen offset:0 lds
    s_add_u32 m0, s45, 6272
    s_nop 0
    buffer_load_dwordx4 v27, s[52:55], s61 offen offset:256 lds
    s_add_u32 m0, s45, 10368
    s_nop 0
    buffer_load_dwordx4 v27, s[52:55], s61 offen offset:512 lds
    s_mov_b32 s61, 6912
    s_add_u32 m0, s45, 3264
    s_nop 0
    buffer_load_dwordx4 v27, s[52:55], s61 offen offset:0 lds
    s_add_u32 m0, s45, 7360
    s_nop 0
    buffer_load_dwordx4 v27, s[52:55], s61 offen offset:256 lds
    s_add_u32 m0, s45, 11456
    s_nop 0
    buffer_load_dwordx4 v27, s[52:55], s61 offen offset:512 lds
    s_mul_i32 s41, s41, 24576
    s_lshl_b32 s61, s63, 1
    s_add_u32 s61, s61, s44
    s_lshl_b32 s61, s61, 10
    s_add_u32 s41, s41, s61
    s_mov_b32 s44, 0x3d96c740
    v_add_u32 v30, s41, v1
    v_and_b32 v22, 3, v21
    v_mul_u32_u24 v22, 1088, v22
    v_lshrrev_b32 v23, 2, v21
    v_lshlrev_b32 v23, 8, v23
    v_lshlrev_b32 v31, 4, v20
    v_add3_u32 v28, v22, v23, v31
    v_add_u32 v29, s45, v28
    s_mov_b32 s16, s4
    s_mov_b32 s17, s5
    s_mov_b32 s18, 109734912
    s_mov_b32 s19, 0x20000
    s_mov_b32 s20, s14
    s_mov_b32 s21, s15
    s_mov_b32 s22, 5171200
    s_mov_b32 s23, 0x20000
    s_mov_b32 s48, s12
    s_mov_b32 s49, s13
    s_mov_b32 s50, 256
    s_mov_b32 s51, 0x20000
    s_mov_b32 s46, 284928
    s_mov_b32 s65, 591872
    buffer_load_dword v42, off, s[20:23], s65
    buffer_load_dword v42, off, s[48:51], 0 offset:64 sc1
    s_mov_b32 s24, s10
    s_mov_b32 s25, s11
    s_mov_b32 s26, 0
    s_mov_b32 s27, 0x20000
    s_mul_i32 s29, s28, 6144
    s_mul_i32 s31, s28, 13056
    s_add_u32 s31, s31, 98304
    s_mul_i32 s32, s28, 2304
    s_add_u32 s32, s32, 150528
    s_mul_i32 s39, s30, 12
    s_add_u32 s39, s39, s28
    s_mov_b32 s38, 0
    s_mov_b32 s42, -1
    s_mov_b32 s43, 0xffff
    s_mov_b32 s34, 0
    s_mov_b32 s90, 0x00010001
    s_mov_b32 s91, 0x00010001
    s_mul_i32 s65, s39, 19419
    s_lshr_b32 s65, s65, 20
    s_mul_i32 s65, s65, 1741824
    s_mul_i32 s33, s39, 5376
    s_add_u32 s33, s33, s65
    v_lshlrev_b32 v24, 4, v21
    v_lshlrev_b32 v22, 2, v20
    v_add_u32 v22, 0, v22
    v_mul_u32_u24 v23, 37, v22
    v_lshrrev_b32 v23, 8, v23
    v_mul_lo_u32 v23, v23, s46
    v_mul_u32_u24 v22, 768, v22
    v_add3_u32 v7, v22, v23, v24
    v_lshlrev_b32 v22, 2, v20
    v_add_u32 v22, 1, v22
    v_mul_u32_u24 v23, 37, v22
    v_lshrrev_b32 v23, 8, v23
    v_mul_lo_u32 v23, v23, s46
    v_mul_u32_u24 v22, 768, v22
    v_add3_u32 v8, v22, v23, v24
    v_lshlrev_b32 v22, 2, v20
    v_add_u32 v22, 2, v22
    v_mul_u32_u24 v23, 37, v22
    v_lshrrev_b32 v23, 8, v23
    v_mul_lo_u32 v23, v23, s46
    v_mul_u32_u24 v22, 768, v22
    v_add3_u32 v9, v22, v23, v24
    v_lshlrev_b32 v22, 2, v20
    v_add_u32 v22, 3, v22
    v_mul_u32_u24 v23, 37, v22
    v_lshrrev_b32 v23, 8, v23
    v_mul_lo_u32 v23, v23, s46
    v_mul_u32_u24 v22, 768, v22
    v_add3_u32 v10, v22, v23, v24
    v_lshlrev_b32 v22, 2, v20
    v_add_u32 v22, 16, v22
    v_mul_u32_u24 v23, 37, v22
    v_lshrrev_b32 v23, 8, v23
    v_mul_lo_u32 v23, v23, s46
    v_mul_u32_u24 v22, 768, v22
    v_add3_u32 v11, v22, v23, v24
    v_lshlrev_b32 v22, 2, v20
    v_add_u32 v22, 17, v22
    v_mul_u32_u24 v23, 37, v22
    v_lshrrev_b32 v23, 8, v23
    v_mul_lo_u32 v23, v23, s46
    v_mul_u32_u24 v22, 768, v22
    v_add3_u32 v12, v22, v23, v24
    v_lshlrev_b32 v22, 2, v20
    v_add_u32 v22, 18, v22
    v_mul_u32_u24 v23, 37, v22
    v_lshrrev_b32 v23, 8, v23
    v_mul_lo_u32 v23, v23, s46
    v_mul_u32_u24 v22, 768, v22
    v_add3_u32 v13, v22, v23, v24
    v_lshlrev_b32 v22, 2, v20
    v_add_u32 v22, 19, v22
    v_mul_u32_u24 v23, 37, v22
    v_lshrrev_b32 v23, 8, v23
    v_mul_lo_u32 v23, v23, s46
    v_mul_u32_u24 v22, 768, v22
    v_add3_u32 v14, v22, v23, v24
    v_lshlrev_b32 v22, 2, v20
    v_add_u32 v22, 32, v22
    v_mul_u32_u24 v23, 37, v22
    v_lshrrev_b32 v23, 8, v23
    v_mul_lo_u32 v23, v23, s46
    v_mul_u32_u24 v22, 768, v22
    v_add3_u32 v15, v22, v23, v24
    v_lshlrev_b32 v22, 2, v20
    v_add_u32 v22, 33, v22
    v_mul_u32_u24 v23, 37, v22
    v_lshrrev_b32 v23, 8, v23
    v_mul_lo_u32 v23, v23, s46
    v_mul_u32_u24 v22, 768, v22
    v_add3_u32 v16, v22, v23, v24
    v_lshlrev_b32 v22, 2, v20
    v_add_u32 v22, 34, v22
    v_mul_u32_u24 v23, 37, v22
    v_lshrrev_b32 v23, 8, v23
    v_mul_lo_u32 v23, v23, s46
    v_mul_u32_u24 v22, 768, v22
    v_add3_u32 v17, v22, v23, v24
    v_lshlrev_b32 v22, 2, v20
    v_add_u32 v22, 35, v22
    v_mul_u32_u24 v23, 37, v22
    v_lshrrev_b32 v23, 8, v23
    v_mul_lo_u32 v23, v23, s46
    v_mul_u32_u24 v22, 768, v22
    v_add3_u32 v18, v22, v23, v24
    s_waitcnt vmcnt(0)
    s_barrier
    ds_read_b128 v[32:35], v28 offset:0
    ds_read_b128 v[80:83], v28 offset:13056
    ds_read_b128 v[128:131], v29 offset:0
    ds_read_b128 v[36:39], v28 offset:64
    ds_read_b128 v[84:87], v28 offset:13120
    ds_read_b128 v[132:135], v29 offset:64
    ds_read_b128 v[40:43], v28 offset:128
    ds_read_b128 v[88:91], v28 offset:13184
    ds_read_b128 v[136:139], v29 offset:128
    ds_read_b128 v[44:47], v28 offset:192
    ds_read_b128 v[92:95], v28 offset:13248
    ds_read_b128 v[140:143], v29 offset:192
    s_waitcnt lgkmcnt(9)
    v_mfma_f32_16x16x32_bf16 v[176:179], v[32:35], v[128:131], 0
    v_mfma_f32_16x16x32_bf16 v[180:183], v[80:83], v[128:131], 0
    s_waitcnt lgkmcnt(6)
    ds_read_b128 v[48:51], v28 offset:4352
    ds_read_b128 v[96:99], v28 offset:17408
    ds_read_b128 v[144:147], v29 offset:4352
    v_mfma_f32_16x16x32_bf16 v[176:179], v[36:39], v[132:135], v[176:179]
    v_mfma_f32_16x16x32_bf16 v[180:183], v[84:87], v[132:135], v[180:183]
    s_waitcnt lgkmcnt(6)
    ds_read_b128 v[52:55], v28 offset:4416
    ds_read_b128 v[100:103], v28 offset:17472
    ds_read_b128 v[148:151], v29 offset:4416
    v_mfma_f32_16x16x32_bf16 v[176:179], v[40:43], v[136:139], v[176:179]
    v_mfma_f32_16x16x32_bf16 v[180:183], v[88:91], v[136:139], v[180:183]
    s_waitcnt lgkmcnt(6)
    ds_read_b128 v[56:59], v28 offset:4480
    ds_read_b128 v[104:107], v28 offset:17536
    ds_read_b128 v[152:155], v29 offset:4480
    v_mfma_f32_16x16x32_bf16 v[176:179], v[44:47], v[140:143], v[176:179]
    v_mfma_f32_16x16x32_bf16 v[180:183], v[92:95], v[140:143], v[180:183]
    s_waitcnt lgkmcnt(6)
    ds_read_b128 v[60:63], v28 offset:4544
    ds_read_b128 v[108:111], v28 offset:17600
    ds_read_b128 v[156:159], v29 offset:4544
    v_mfma_f32_16x16x32_bf16 v[176:179], v[48:51], v[144:147], v[176:179]
    v_mfma_f32_16x16x32_bf16 v[180:183], v[96:99], v[144:147], v[180:183]
    s_waitcnt lgkmcnt(6)
    ds_read_b128 v[64:67], v28 offset:8704
    ds_read_b128 v[112:115], v28 offset:21760
    ds_read_b128 v[160:163], v29 offset:8704
    v_mfma_f32_16x16x32_bf16 v[176:179], v[52:55], v[148:151], v[176:179]
    v_mfma_f32_16x16x32_bf16 v[180:183], v[100:103], v[148:151], v[180:183]
    s_waitcnt lgkmcnt(6)
    ds_read_b128 v[68:71], v28 offset:8768
    ds_read_b128 v[116:119], v28 offset:21824
    ds_read_b128 v[164:167], v29 offset:8768
    v_mfma_f32_16x16x32_bf16 v[176:179], v[56:59], v[152:155], v[176:179]
    v_mfma_f32_16x16x32_bf16 v[180:183], v[104:107], v[152:155], v[180:183]
    s_waitcnt lgkmcnt(6)
    ds_read_b128 v[72:75], v28 offset:8832
    ds_read_b128 v[120:123], v28 offset:21888
    ds_read_b128 v[168:171], v29 offset:8832
    v_mfma_f32_16x16x32_bf16 v[176:179], v[60:63], v[156:159], v[176:179]
    v_mfma_f32_16x16x32_bf16 v[180:183], v[108:111], v[156:159], v[180:183]
    s_waitcnt lgkmcnt(6)
    ds_read_b128 v[76:79], v28 offset:8896
    ds_read_b128 v[124:127], v28 offset:21952
    ds_read_b128 v[172:175], v29 offset:8896
    v_mfma_f32_16x16x32_bf16 v[176:179], v[64:67], v[160:163], v[176:179]
    v_mfma_f32_16x16x32_bf16 v[180:183], v[112:115], v[160:163], v[180:183]
    s_waitcnt lgkmcnt(6)
    v_mfma_f32_16x16x32_bf16 v[176:179], v[68:71], v[164:167], v[176:179]
    v_mfma_f32_16x16x32_bf16 v[180:183], v[116:119], v[164:167], v[180:183]
    s_waitcnt lgkmcnt(3)
    v_mfma_f32_16x16x32_bf16 v[176:179], v[72:75], v[168:171], v[176:179]
    v_mfma_f32_16x16x32_bf16 v[180:183], v[120:123], v[168:171], v[180:183]
    s_waitcnt lgkmcnt(0)
    v_mfma_f32_16x16x32_bf16 v[176:179], v[76:79], v[172:175], v[176:179]
    v_mfma_f32_16x16x32_bf16 v[180:183], v[124:127], v[172:175], v[180:183]
    s_nop 7
    s_branch L_fold_mm
L_fold_n:
    s_lshl_b32 s41, s62, 7
    s_mul_i32 s44, s28, 73728
    s_add_u32 s41, s41, s44
    s_mul_i32 s45, s28, 12288
    s_add_u32 s45, s45, 26112
    v_lshrrev_b32 v22, 3, v25
    v_mul_u32_u24 v22, 768, v22
    v_and_b32 v23, 7, v25
    v_lshlrev_b32 v23, 4, v23
    v_add3_u32 v27, v22, v23, s41
    s_mov_b32 s61, 0
    s_add_u32 m0, s45, 0
    s_nop 0
    buffer_load_dwordx4 v27, s[56:59], s61 offen offset:0 lds
    s_mov_b32 s61, 6144
    s_add_u32 m0, s45, 1024
    s_nop 0
    buffer_load_dwordx4 v27, s[56:59], s61 offen offset:0 lds
    s_mov_b32 s61, 12288
    s_add_u32 m0, s45, 2048
    s_nop 0
    buffer_load_dwordx4 v27, s[56:59], s61 offen offset:0 lds
    s_mov_b32 s61, 18432
    s_add_u32 m0, s45, 3072
    s_nop 0
    buffer_load_dwordx4 v27, s[56:59], s61 offen offset:0 lds
    s_mov_b32 s61, 24576
    s_add_u32 m0, s45, 4096
    s_nop 0
    buffer_load_dwordx4 v27, s[56:59], s61 offen offset:0 lds
    s_mov_b32 s61, 30720
    s_add_u32 m0, s45, 5120
    s_nop 0
    buffer_load_dwordx4 v27, s[56:59], s61 offen offset:0 lds
    s_mov_b32 s61, 36864
    s_add_u32 m0, s45, 6144
    s_nop 0
    buffer_load_dwordx4 v27, s[56:59], s61 offen offset:0 lds
    s_mov_b32 s61, 43008
    s_add_u32 m0, s45, 7168
    s_nop 0
    buffer_load_dwordx4 v27, s[56:59], s61 offen offset:0 lds
    s_mov_b32 s61, 49152
    s_add_u32 m0, s45, 8192
    s_nop 0
    buffer_load_dwordx4 v27, s[56:59], s61 offen offset:0 lds
    s_mov_b32 s61, 55296
    s_add_u32 m0, s45, 9216
    s_nop 0
    buffer_load_dwordx4 v27, s[56:59], s61 offen offset:0 lds
    s_mov_b32 s61, 61440
    s_add_u32 m0, s45, 10240
    s_nop 0
    buffer_load_dwordx4 v27, s[56:59], s61 offen offset:0 lds
    s_mov_b32 s61, 67584
    s_add_u32 m0, s45, 11264
    s_nop 0
    buffer_load_dwordx4 v27, s[56:59], s61 offen offset:0 lds
    s_lshl_b32 s44, s28, 1
    v_and_b32 v22, 7, v21
    v_lshlrev_b32 v22, 9, v22
    v_lshrrev_b32 v23, 3, v21
    v_add_u32 v23, s44, v23
    v_lshlrev_b32 v23, 4, v23
    v_lshlrev_b32 v24, 7, v20
    v_add3_u32 v22, v22, v23, v24
    v_add_u32 v19, 90112, v22
    s_lshr_b32 s41, s62, 1
    s_lshl_b32 s41, s41, 2
    s_add_u32 s41, s41, s28
    s_add_u32 s41, s41, 12
    s_mul_i32 s41, s41, 24576
    s_lshl_b32 s44, s63, 11
    s_add_u32 s41, s41, s44
    s_and_b32 s44, s62, 1
    s_lshl_b32 s44, s44, 7
    s_add_u32 s41, s41, s44
    s_mov_b32 s44, 1.0
    v_lshrrev_b32 v22, 5, v25
    v_lshlrev_b32 v22, 10, v22
    v_bfe_u32 v23, v25, 3, 2
    v_lshlrev_b32 v23, 8, v23
    v_and_b32 v24, 7, v25
    v_lshlrev_b32 v24, 4, v24
    v_add3_u32 v22, v22, v23, v24
    v_add_u32 v30, s41, v22
    v_and_b32 v22, 3, v21
    v_mul_u32_u24 v22, 1088, v22
    v_lshrrev_b32 v23, 2, v21
    v_lshlrev_b32 v23, 8, v23
    v_lshlrev_b32 v31, 4, v20
    v_add3_u32 v28, v22, v23, v31
    v_lshlrev_b32 v22, 3, v20
    v_bfe_u32 v23, v25, 2, 2
    v_add_u32 v22, v22, v23
    v_lshlrev_b32 v22, 7, v22
    v_and_b32 v23, 3, v25
    v_lshlrev_b32 v23, 3, v23
    s_lshl_b32 s41, s28, 5
    s_add_u32 s41, s41, 26112
    v_add3_u32 v29, v22, v23, s41
    s_mov_b32 s16, s4
    s_mov_b32 s17, s5
    s_mov_b32 s18, 109734912
    s_mov_b32 s19, 0x20000
    s_mov_b32 s20, s14
    s_mov_b32 s21, s15
    s_mov_b32 s22, 5171200
    s_mov_b32 s23, 0x20000
    s_mov_b32 s48, s12
    s_mov_b32 s49, s13
    s_mov_b32 s50, 256
    s_mov_b32 s51, 0x20000
    s_mov_b32 s46, 284928
    s_mov_b32 s65, 591872
    buffer_load_dword v42, off, s[20:23], s65
    buffer_load_dword v42, off, s[48:51], 0 offset:64 sc1
    s_mov_b32 s24, s10
    s_mov_b32 s25, s11
    s_mov_b32 s26, 0
    s_mov_b32 s27, 0x20000
    s_mul_i32 s29, s28, 6144
    s_mul_i32 s31, s28, 13056
    s_add_u32 s31, s31, 98304
    s_mul_i32 s32, s28, 2304
    s_add_u32 s32, s32, 150528
    s_mul_i32 s39, s30, 12
    s_add_u32 s39, s39, s28
    s_mov_b32 s38, 0
    s_mov_b32 s42, -1
    s_mov_b32 s43, 0xffff
    s_mov_b32 s34, 0
    s_mov_b32 s90, 0x00010001
    s_mov_b32 s91, 0x00010001
    s_mul_i32 s65, s39, 19419
    s_lshr_b32 s65, s65, 20
    s_mul_i32 s65, s65, 1741824
    s_mul_i32 s33, s39, 5376
    s_add_u32 s33, s33, s65
    v_lshlrev_b32 v24, 4, v21
    v_lshlrev_b32 v22, 2, v20
    v_add_u32 v22, 0, v22
    v_mul_u32_u24 v23, 37, v22
    v_lshrrev_b32 v23, 8, v23
    v_mul_lo_u32 v23, v23, s46
    v_mul_u32_u24 v22, 768, v22
    v_add3_u32 v7, v22, v23, v24
    v_lshlrev_b32 v22, 2, v20
    v_add_u32 v22, 1, v22
    v_mul_u32_u24 v23, 37, v22
    v_lshrrev_b32 v23, 8, v23
    v_mul_lo_u32 v23, v23, s46
    v_mul_u32_u24 v22, 768, v22
    v_add3_u32 v8, v22, v23, v24
    v_lshlrev_b32 v22, 2, v20
    v_add_u32 v22, 2, v22
    v_mul_u32_u24 v23, 37, v22
    v_lshrrev_b32 v23, 8, v23
    v_mul_lo_u32 v23, v23, s46
    v_mul_u32_u24 v22, 768, v22
    v_add3_u32 v9, v22, v23, v24
    v_lshlrev_b32 v22, 2, v20
    v_add_u32 v22, 3, v22
    v_mul_u32_u24 v23, 37, v22
    v_lshrrev_b32 v23, 8, v23
    v_mul_lo_u32 v23, v23, s46
    v_mul_u32_u24 v22, 768, v22
    v_add3_u32 v10, v22, v23, v24
    v_lshlrev_b32 v22, 2, v20
    v_add_u32 v22, 16, v22
    v_mul_u32_u24 v23, 37, v22
    v_lshrrev_b32 v23, 8, v23
    v_mul_lo_u32 v23, v23, s46
    v_mul_u32_u24 v22, 768, v22
    v_add3_u32 v11, v22, v23, v24
    v_lshlrev_b32 v22, 2, v20
    v_add_u32 v22, 17, v22
    v_mul_u32_u24 v23, 37, v22
    v_lshrrev_b32 v23, 8, v23
    v_mul_lo_u32 v23, v23, s46
    v_mul_u32_u24 v22, 768, v22
    v_add3_u32 v12, v22, v23, v24
    v_lshlrev_b32 v22, 2, v20
    v_add_u32 v22, 18, v22
    v_mul_u32_u24 v23, 37, v22
    v_lshrrev_b32 v23, 8, v23
    v_mul_lo_u32 v23, v23, s46
    v_mul_u32_u24 v22, 768, v22
    v_add3_u32 v13, v22, v23, v24
    v_lshlrev_b32 v22, 2, v20
    v_add_u32 v22, 19, v22
    v_mul_u32_u24 v23, 37, v22
    v_lshrrev_b32 v23, 8, v23
    v_mul_lo_u32 v23, v23, s46
    v_mul_u32_u24 v22, 768, v22
    v_add3_u32 v14, v22, v23, v24
    v_lshlrev_b32 v22, 2, v20
    v_add_u32 v22, 32, v22
    v_mul_u32_u24 v23, 37, v22
    v_lshrrev_b32 v23, 8, v23
    v_mul_lo_u32 v23, v23, s46
    v_mul_u32_u24 v22, 768, v22
    v_add3_u32 v15, v22, v23, v24
    v_lshlrev_b32 v22, 2, v20
    v_add_u32 v22, 33, v22
    v_mul_u32_u24 v23, 37, v22
    v_lshrrev_b32 v23, 8, v23
    v_mul_lo_u32 v23, v23, s46
    v_mul_u32_u24 v22, 768, v22
    v_add3_u32 v16, v22, v23, v24
    v_lshlrev_b32 v22, 2, v20
    v_add_u32 v22, 34, v22
    v_mul_u32_u24 v23, 37, v22
    v_lshrrev_b32 v23, 8, v23
    v_mul_lo_u32 v23, v23, s46
    v_mul_u32_u24 v22, 768, v22
    v_add3_u32 v17, v22, v23, v24
    v_lshlrev_b32 v22, 2, v20
    v_add_u32 v22, 35, v22
    v_mul_u32_u24 v23, 37, v22
    v_lshrrev_b32 v23, 8, v23
    v_mul_lo_u32 v23, v23, s46
    v_mul_u32_u24 v22, 768, v22
    v_add3_u32 v18, v22, v23, v24
    s_waitcnt vmcnt(0)
    s_barrier
    ds_read_b128 v[32:35], v28 offset:0
    ds_read_b128 v[80:83], v28 offset:13056
    ds_read_b64_tr_b16 v[128:129], v29 offset:0
    ds_read_b64_tr_b16 v[130:131], v29 offset:512
    ds_read_b128 v[36:39], v28 offset:64
    ds_read_b128 v[84:87], v28 offset:13120
    ds_read_b64_tr_b16 v[132:133], v29 offset:4096
    ds_read_b64_tr_b16 v[134:135], v29 offset:4608
    ds_read_b128 v[40:43], v28 offset:128
    ds_read_b128 v[88:91], v28 offset:13184
    ds_read_b64_tr_b16 v[136:137], v29 offset:8192
    ds_read_b64_tr_b16 v[138:139], v29 offset:8704
    s_waitcnt lgkmcnt(8)
    v_mfma_f32_16x16x32_bf16 v[176:179], v[32:35], v[128:131], 0
    v_mfma_f32_16x16x32_bf16 v[180:183], v[80:83], v[128:131], 0
    s_waitcnt lgkmcnt(4)
    ds_read_b128 v[44:47], v28 offset:192
    ds_read_b128 v[92:95], v28 offset:13248
    ds_read_b64_tr_b16 v[140:141], v29 offset:12288
    ds_read_b64_tr_b16 v[142:143], v29 offset:12800
    v_mfma_f32_16x16x32_bf16 v[176:179], v[36:39], v[132:135], v[176:179]
    v_mfma_f32_16x16x32_bf16 v[180:183], v[84:87], v[132:135], v[180:183]
    s_waitcnt lgkmcnt(4)
    ds_read_b128 v[48:51], v28 offset:4352
    ds_read_b128 v[96:99], v28 offset:17408
    ds_read_b64_tr_b16 v[144:145], v29 offset:16384
    ds_read_b64_tr_b16 v[146:147], v29 offset:16896
    v_mfma_f32_16x16x32_bf16 v[176:179], v[40:43], v[136:139], v[176:179]
    v_mfma_f32_16x16x32_bf16 v[180:183], v[88:91], v[136:139], v[180:183]
    s_waitcnt lgkmcnt(4)
    ds_read_b128 v[52:55], v28 offset:4416
    ds_read_b128 v[100:103], v28 offset:17472
    ds_read_b64_tr_b16 v[148:149], v29 offset:20480
    ds_read_b64_tr_b16 v[150:151], v29 offset:20992
    v_mfma_f32_16x16x32_bf16 v[176:179], v[44:47], v[140:143], v[176:179]
    v_mfma_f32_16x16x32_bf16 v[180:183], v[92:95], v[140:143], v[180:183]
    s_waitcnt lgkmcnt(4)
    ds_read_b128 v[56:59], v28 offset:4480
    ds_read_b128 v[104:107], v28 offset:17536
    ds_read_b64_tr_b16 v[152:153], v29 offset:24576
    ds_read_b64_tr_b16 v[154:155], v29 offset:25088
    v_mfma_f32_16x16x32_bf16 v[176:179], v[48:51], v[144:147], v[176:179]
    v_mfma_f32_16x16x32_bf16 v[180:183], v[96:99], v[144:147], v[180:183]
    s_waitcnt lgkmcnt(4)
    ds_read_b128 v[60:63], v28 offset:4544
    ds_read_b128 v[108:111], v28 offset:17600
    ds_read_b64_tr_b16 v[156:157], v29 offset:28672
    ds_read_b64_tr_b16 v[158:159], v29 offset:29184
    v_mfma_f32_16x16x32_bf16 v[176:179], v[52:55], v[148:151], v[176:179]
    v_mfma_f32_16x16x32_bf16 v[180:183], v[100:103], v[148:151], v[180:183]
    s_waitcnt lgkmcnt(4)
    ds_read_b128 v[64:67], v28 offset:8704
    ds_read_b128 v[112:115], v28 offset:21760
    ds_read_b64_tr_b16 v[160:161], v29 offset:32768
    ds_read_b64_tr_b16 v[162:163], v29 offset:33280
    v_mfma_f32_16x16x32_bf16 v[176:179], v[56:59], v[152:155], v[176:179]
    v_mfma_f32_16x16x32_bf16 v[180:183], v[104:107], v[152:155], v[180:183]
    s_waitcnt lgkmcnt(4)
    ds_read_b128 v[68:71], v28 offset:8768
    ds_read_b128 v[116:119], v28 offset:21824
    ds_read_b64_tr_b16 v[164:165], v29 offset:36864
    ds_read_b64_tr_b16 v[166:167], v29 offset:37376
    v_mfma_f32_16x16x32_bf16 v[176:179], v[60:63], v[156:159], v[176:179]
    v_mfma_f32_16x16x32_bf16 v[180:183], v[108:111], v[156:159], v[180:183]
    s_waitcnt lgkmcnt(4)
    ds_read_b128 v[72:75], v28 offset:8832
    ds_read_b128 v[120:123], v28 offset:21888
    ds_read_b64_tr_b16 v[168:169], v29 offset:40960
    ds_read_b64_tr_b16 v[170:171], v29 offset:41472
    v_mfma_f32_16x16x32_bf16 v[176:179], v[64:67], v[160:163], v[176:179]
    v_mfma_f32_16x16x32_bf16 v[180:183], v[112:115], v[160:163], v[180:183]
    s_waitcnt lgkmcnt(4)
    ds_read_b128 v[76:79], v28 offset:8896
    ds_read_b128 v[124:127], v28 offset:21952
    ds_read_b64_tr_b16 v[172:173], v29 offset:45056
    ds_read_b64_tr_b16 v[174:175], v29 offset:45568
    v_mfma_f32_16x16x32_bf16 v[176:179], v[68:71], v[164:167], v[176:179]
    v_mfma_f32_16x16x32_bf16 v[180:183], v[116:119], v[164:167], v[180:183]
    s_waitcnt lgkmcnt(4)
    v_mfma_f32_16x16x32_bf16 v[176:179], v[72:75], v[168:171], v[176:179]
    v_mfma_f32_16x16x32_bf16 v[180:183], v[120:123], v[168:171], v[180:183]
    s_waitcnt lgkmcnt(0)
    v_mfma_f32_16x16x32_bf16 v[176:179], v[76:79], v[172:175], v[176:179]
    v_mfma_f32_16x16x32_bf16 v[180:183], v[124:127], v[172:175], v[180:183]
    s_nop 7
L_fold_mm:
    v_mul_f32 v176, s44, v176
    v_mul_f32 v177, s44, v177
    v_mul_f32 v178, s44, v178
    v_mul_f32 v179, s44, v179
    v_mul_f32 v180, s44, v180
    v_mul_f32 v181, s44, v181
    v_mul_f32 v182, s44, v182
    v_mul_f32 v183, s44, v183
    v_cvt_pk_bf16_f32 v184, v176, v177
    v_cvt_pk_bf16_f32 v185, v178, v179
    v_cvt_pk_bf16_f32 v186, v180, v181
    v_cvt_pk_bf16_f32 v187, v182, v183
    s_cmp_eq_u32 s60, 0
    s_cbranch_scc1 L_fold_st
    ds_write_b128 v19, v[184:187] offset:0
    s_waitcnt lgkmcnt(0)
    s_barrier
    v_lshlrev_b32 v22, 0, v1
    s_lshl_b32 s41, s28, 10
    s_add_u32 s41, s41, 90112
    v_add_u32 v22, s41, v1
    ds_read_b128 v[184:187], v22 offset:0
    s_waitcnt lgkmcnt(0)
L_fold_st:
    buffer_store_dwordx4 v[184:187], v30, s[20:23], 0 offen offset:0 sc1
    s_waitcnt vmcnt(0)
    s_barrier
    s_cmp_lg_u32 s28, 3
    s_cbranch_scc1 L_noatom
    v_mov_b32 v22, 1
    s_and_b32 s61, s30, 7
    s_lshl_b32 s61, s61, 4
    s_mov_b64 exec, 1
    buffer_atomic_add v22, off, s[48:51], s61 sc1
    s_mov_b64 exec, -1
L_noatom:
    v_lshlrev_b32 v22, 2, v20
    v_add_u32 v22, 0, v22
    v_xor_b32 v22, v22, v21
    v_sub_u32 v22, v22, v21
    v_lshlrev_b32 v26, 4, v22
    v_lshlrev_b32 v22, 2, v20
    v_add_u32 v22, 1, v22
    v_xor_b32 v22, v22, v21
    v_sub_u32 v22, v22, v21
    v_lshlrev_b32 v27, 4, v22
    v_lshlrev_b32 v22, 2, v20
    v_add_u32 v22, 2, v22
    v_xor_b32 v22, v22, v21
    v_sub_u32 v22, v22, v21
    v_lshlrev_b32 v28, 4, v22
    v_lshlrev_b32 v22, 2, v20
    v_add_u32 v22, 3, v22
    v_xor_b32 v22, v22, v21
    v_sub_u32 v22, v22, v21
    v_lshlrev_b32 v29, 4, v22
    s_mul_i32 s63, s28, 24576
    v_add_u32 v30, v7, v26
    s_add_u32 m0, s63, 0
    s_nop 0
    buffer_load_dwordx4 v30, s[16:19], s33 offen offset:0 nt lds
    s_add_u32 m0, s63, 12032
    s_nop 0
    buffer_load_dwordx4 v30, s[16:19], s33 offen offset:256 nt lds
    v_add_u32 v31, v8, v27
    s_add_u32 m0, s63, 1024
    s_nop 0
    buffer_load_dwordx4 v31, s[16:19], s33 offen offset:0 nt lds
    s_add_u32 m0, s63, 13056
    s_nop 0
    buffer_load_dwordx4 v31, s[16:19], s33 offen offset:256 nt lds
    v_add_u32 v30, v9, v28
    s_add_u32 m0, s63, 2048
    s_nop 0
    buffer_load_dwordx4 v30, s[16:19], s33 offen offset:0 nt lds
    s_add_u32 m0, s63, 14080
    s_nop 0
    buffer_load_dwordx4 v30, s[16:19], s33 offen offset:256 nt lds
    v_add_u32 v31, v10, v29
    s_add_u32 m0, s63, 3072
    s_nop 0
    buffer_load_dwordx4 v31, s[16:19], s33 offen offset:0 nt lds
    s_add_u32 m0, s63, 15104
    s_nop 0
    buffer_load_dwordx4 v31, s[16:19], s33 offen offset:256 nt lds
    v_add_u32 v30, v11, v26
    s_add_u32 m0, s63, 4096
    s_nop 0
    buffer_load_dwordx4 v30, s[16:19], s33 offen offset:0 nt lds
    s_add_u32 m0, s63, 16128
    s_nop 0
    buffer_load_dwordx4 v30, s[16:19], s33 offen offset:256 nt lds
    v_add_u32 v31, v12, v27
    s_add_u32 m0, s63, 5120
    s_nop 0
    buffer_load_dwordx4 v31, s[16:19], s33 offen offset:0 nt lds
    s_add_u32 m0, s63, 17152
    s_nop 0
    buffer_load_dwordx4 v31, s[16:19], s33 offen offset:256 nt lds
    v_add_u32 v30, v13, v28
    s_add_u32 m0, s63, 6144
    s_nop 0
    buffer_load_dwordx4 v30, s[16:19], s33 offen offset:0 nt lds
    s_add_u32 m0, s63, 18176
    s_nop 0
    buffer_load_dwordx4 v30, s[16:19], s33 offen offset:256 nt lds
    v_add_u32 v31, v14, v29
    s_add_u32 m0, s63, 7168
    s_nop 0
    buffer_load_dwordx4 v31, s[16:19], s33 offen offset:0 nt lds
    s_add_u32 m0, s63, 19200
    s_nop 0
    buffer_load_dwordx4 v31, s[16:19], s33 offen offset:256 nt lds
    v_add_u32 v30, v15, v26
    s_add_u32 m0, s63, 8192
    s_nop 0
    buffer_load_dwordx4 v30, s[16:19], s33 offen offset:0 nt lds
    s_add_u32 m0, s63, 20224
    s_nop 0
    buffer_load_dwordx4 v30, s[16:19], s33 offen offset:256 nt lds
    v_add_u32 v31, v16, v27
    s_add_u32 m0, s63, 9216
    s_nop 0
    buffer_load_dwordx4 v31, s[16:19], s33 offen offset:0 nt lds
    s_add_u32 m0, s63, 21248
    s_nop 0
    buffer_load_dwordx4 v31, s[16:19], s33 offen offset:256 nt lds
    v_add_u32 v30, v17, v28
    s_add_u32 m0, s63, 10240
    s_nop 0
    buffer_load_dwordx4 v30, s[16:19], s33 offen offset:0 nt lds
    s_add_u32 m0, s63, 22272
    s_nop 0
    buffer_load_dwordx4 v30, s[16:19], s33 offen offset:256 nt lds
    v_add_u32 v31, v18, v29
    s_add_u32 m0, s63, 11264
    s_nop 0
    buffer_load_dwordx4 v31, s[16:19], s33 offen offset:0 nt lds
    s_add_u32 m0, s63, 23296
    s_nop 0
    buffer_load_dwordx4 v31, s[16:19], s33 offen offset:256 nt lds
    s_add_u32 m0, s32, 0
    s_add_u32 s65, s33, 1746432
    s_mov_b64 exec, s[42:43]
    buffer_load_dwordx4 v1, s[16:19], s65 offen nt lds
    s_mov_b64 exec, -1
L_join:
    v_cmp_eq_u32 vcc, 0, v20
    v_lshlrev_b32 v24, 4, v21
    v_add_u32 v22, 1746432, v24
    v_mov_b32 v23, 0x80000000
    v_cndmask_b32 v19, v23, v22, vcc
    v_mov_b32 v23, 0xff800000
    v_mov_b32 v22, 0
    v_cndmask_b32 v6, v23, v22, vcc
    v_and_b32 v22, 3, v21
    v_mul_u32_u24 v22, 1088, v22
    v_lshrrev_b32 v23, 2, v21
    v_lshlrev_b32 v23, 8, v23
    v_lshlrev_b32 v24, 4, v20
    v_add3_u32 v22, v22, v23, v24
    v_add_u32 v3, s31, v22
    v_cmp_eq_u32 vcc, 0, v21
    v_mov_b32 v22, 159744
    v_mov_b32 v23, s32
    s_nop 0
    v_cndmask_b32 v22, v22, v23, vcc
    v_add_u32 v4, v22, v24
    v_lshlrev_b32 v22, 2, v21
    v_add_u32 v22, 1536, v22
    v_add_u32 v5, s32, v22
    v_mov_b32 v32, 0
    v_mov_b32 v33, 0
    v_mov_b32 v34, 0
    v_mov_b32 v35, 0
    v_lshlrev_b32 v22, 4, v0
    v_add_u32 v22, 159744, v22
    v_cmp_gt_u32 vcc, 96, v0
    s_nop 4
    s_and_saveexec_b64 s[62:63], vcc
    s_cbranch_execz L_nozero
    ds_write_b128 v22, v[32:35] offset:0
L_nozero:
    s_mov_b64 exec, -1
    v_mov_b32 v75, 0
    v_mov_b32 v83, 0
    v_mov_b32 v91, 0
    v_mov_b32 v99, 0
    v_mov_b32 v107, 0
    v_mov_b32 v115, 0
    s_mul_i32 s62, s30, 3450
    s_lshr_b32 s62, s62, 16
    s_add_u32 s62, s62, 132
    s_cmp_ge_u32 s30, 144
    s_cbranch_scc1 L_nf_wait1
    s_waitcnt vmcnt(0)
L_w1:
    buffer_load_dword v36, off, s[48:51], 0 offset:128 sc1
    s_mul_i32 s63, s28, 24576
    v_and_b32 v22, 3, v21
    v_lshlrev_b32 v22, 10, v22
    v_lshrrev_b32 v23, 2, v21
    v_lshlrev_b32 v23, 8, v23
    v_add3_u32 v24, v22, v23, s63
    v_add_u32 v22, 0, v20
    v_xor_b32 v22, v22, v21
    v_lshlrev_b32 v22, 4, v22
    v_add_u32 v26, v22, v24
    v_add_u32 v22, 4, v20
    v_xor_b32 v22, v22, v21
    v_lshlrev_b32 v22, 4, v22
    v_add_u32 v27, v22, v24
    v_add_u32 v22, 8, v20
    v_xor_b32 v22, v22, v21
    v_lshlrev_b32 v22, 4, v22
    v_add_u32 v28, v22, v24
    v_add_u32 v22, 12, v20
    v_xor_b32 v22, v22, v21
    v_lshlrev_b32 v22, 4, v22
    v_add_u32 v29, v22, v24
    ds_read_b128 a[0:3], v26 offset:0
    ds_read_b128 a[48:51], v26 offset:4096
    ds_read_b128 a[96:99], v26 offset:8192
    ds_read_b128 a[4:7], v27 offset:0
    ds_read_b128 a[52:55], v27 offset:4096
    ds_read_b128 a[100:103], v27 offset:8192
    ds_read_b128 a[8:11], v28 offset:0
    ds_read_b128 a[56:59], v28 offset:4096
    ds_read_b128 a[104:107], v28 offset:8192
    ds_read_b128 a[12:15], v29 offset:0
    ds_read_b128 a[60:63], v29 offset:4096
    ds_read_b128 a[108:111], v29 offset:8192
    s_waitcnt lgkmcnt(0)
    ds_read_b128 a[16:19], v26 offset:12288
    ds_read_b128 a[64:67], v26 offset:16384
    ds_read_b128 a[112:115], v26 offset:20480
    ds_read_b128 a[20:23], v27 offset:12288
    ds_read_b128 a[68:71], v27 offset:16384
    ds_read_b128 a[116:119], v27 offset:20480
    ds_read_b128 a[168:171], v28 offset:12288
    ds_read_b128 a[200:203], v28 offset:16384
    ds_read_b128 a[232:235], v28 offset:20480
    ds_read_b128 a[172:175], v29 offset:12288
    ds_read_b128 a[204:207], v29 offset:16384
    ds_read_b128 a[236:239], v29 offset:20480
    s_waitcnt lgkmcnt(0)
    s_cmp_lg_u32 s28, 3
    s_cbranch_scc1 L_notw3
    s_waitcnt vmcnt(0)
    v_readfirstlane_b32 s63, v36
    s_nop 1
    s_cmp_eq_u32 s63, 1
    s_cbranch_scc1 L_polled_m
    s_mov_b32 s61, 0
L_poll_m:
    buffer_load_dword v23, off, s[48:51], 0 offset:128 sc1
    s_waitcnt vmcnt(0)
    v_readfirstlane_b32 s63, v23
    s_add_u32 s61, s61, 1
    s_nop 0
    s_cmp_eq_u32 s63, 1
    s_cbranch_scc1 L_polled_m
    s_cmp_ge_u32 s61, 400000
    s_cbranch_scc1 L_polled_m
    s_sleep 2
    s_branch L_poll_m
L_polled_m:
L_notw3:
    s_barrier
    s_add_u32 m0, s29, 0
    s_add_u32 s45, s29, 0
    buffer_load_dwordx4 v1, s[20:23], s45 offen offset:0 sc1 lds
    buffer_load_dwordx4 v1, s[20:23], s45 offen offset:1024 sc1 lds
    buffer_load_dwordx4 v1, s[20:23], s45 offen offset:2048 sc1 lds
    buffer_load_dwordx4 v1, s[20:23], s45 offen offset:3072 sc1 lds
    s_add_u32 m0, s29, 4096
    s_add_u32 s45, s29, 4096
    buffer_load_dwordx4 v1, s[20:23], s45 offen offset:0 sc1 lds
    buffer_load_dwordx4 v1, s[20:23], s45 offen offset:1024 sc1 lds
    s_add_u32 m0, s29, 24576
    s_add_u32 s45, s29, 24576
    buffer_load_dwordx4 v1, s[20:23], s45 offen offset:0 sc1 lds
    buffer_load_dwordx4 v1, s[20:23], s45 offen offset:1024 sc1 lds
    buffer_load_dwordx4 v1, s[20:23], s45 offen offset:2048 sc1 lds
    buffer_load_dwordx4 v1, s[20:23], s45 offen offset:3072 sc1 lds
    s_add_u32 m0, s29, 28672
    s_add_u32 s45, s29, 28672
    buffer_load_dwordx4 v1, s[20:23], s45 offen offset:0 sc1 lds
    buffer_load_dwordx4 v1, s[20:23], s45 offen offset:1024 sc1 lds
    s_cmp_ge_u32 s30, 144
    s_cbranch_scc1 L_x2late2
    s_add_u32 m0, s31, -512
    s_nop 0
    buffer_load_dwordx4 v7, s[16:19], s33 offen offset:512 nt lds
    s_add_u32 m0, s31, 576
    s_nop 0
    buffer_load_dwordx4 v8, s[16:19], s33 offen offset:512 nt lds
    s_add_u32 m0, s31, 1664
    s_nop 0
    buffer_load_dwordx4 v9, s[16:19], s33 offen offset:512 nt lds
    s_add_u32 m0, s31, 2752
    s_nop 0
    buffer_load_dwordx4 v10, s[16:19], s33 offen offset:512 nt lds
    s_add_u32 m0, s31, 3840
    s_nop 0
    buffer_load_dwordx4 v11, s[16:19], s33 offen offset:512 nt lds
    s_add_u32 m0, s31, 4928
    s_nop 0
    buffer_load_dwordx4 v12, s[16:19], s33 offen offset:512 nt lds
    s_add_u32 m0, s31, 6016
    s_nop 0
    buffer_load_dwordx4 v13, s[16:19], s33 offen offset:512 nt lds
    s_add_u32 m0, s31, 7104
    s_nop 0
    buffer_load_dwordx4 v14, s[16:19], s33 offen offset:512 nt lds
    s_add_u32 m0, s31, 8192
    s_nop 0
    buffer_load_dwordx4 v15, s[16:19], s33 offen offset:512 nt lds
    s_add_u32 m0, s31, 9280
    s_nop 0
    buffer_load_dwordx4 v16, s[16:19], s33 offen offset:512 nt lds
    s_add_u32 m0, s31, 10368
    s_nop 0
    buffer_load_dwordx4 v17, s[16:19], s33 offen offset:512 nt lds
    s_add_u32 m0, s31, 11456
    s_nop 0
    buffer_load_dwordx4 v18, s[16:19], s33 offen offset:512 nt lds
L_x2late2:
    s_lshr_b32 s63, s2, 3
    s_mul_i32 s63, s63, 18432
    s_mul_i32 s61, s28, 4608
    s_add_u32 s63, s63, s61
    v_min_u32 v22, 35, v25
    v_lshlrev_b32 v22, 7, v22
    buffer_load_dword v0, v22, s[20:23], s63 offen sc1
    s_cmp_ge_u32 s30, 144
    s_cbranch_scc1 L_nf_wait2
    s_waitcnt vmcnt(13) lgkmcnt(0)
L_fw1:
    s_barrier
    ds_read_b128 a[240:243], v1 offset:0
    ds_read_b128 a[244:247], v1 offset:1024
    ds_read_b128 a[248:251], v1 offset:2048
    s_waitcnt lgkmcnt(0)
.p2align 6
L_round:
    s_waitcnt lgkmcnt(2)
    v_mfma_f32_16x16x32_bf16 v[20:23], a[240:243], a[0:3], 0
    s_add_u32 s45, s29, 49152
    ds_read_b128 a[252:255], v1 offset:3072
    v_accvgpr_mov_b32 a24, a168
    v_mfma_f32_16x16x32_bf16 v[24:27], a[240:243], a[48:51], 0
    s_add_u32 m0, s29, 49152
    v_accvgpr_mov_b32 a25, a169
    v_accvgpr_mov_b32 a26, a170
    v_mfma_f32_16x16x32_bf16 v[28:31], a[240:243], a[96:99], 0
    s_waitcnt lgkmcnt(2)
    ds_read_b128 a[240:243], v1 offset:4096
    v_accvgpr_mov_b32 a27, a171
    v_mfma_f32_16x16x32_bf16 v[32:35], a[244:247], a[0:3], 0
    v_accvgpr_mov_b32 a72, a200
    v_accvgpr_mov_b32 a73, a201
    v_mfma_f32_16x16x32_bf16 v[36:39], a[244:247], a[48:51], 0
    v_accvgpr_mov_b32 a74, a202
    v_accvgpr_mov_b32 a75, a203
    v_mfma_f32_16x16x32_bf16 v[40:43], a[244:247], a[96:99], 0
    s_waitcnt lgkmcnt(2)
    ds_read_b128 a[244:247], v1 offset:5120
    v_accvgpr_mov_b32 a120, a232
    v_mfma_f32_16x16x32_bf16 v[20:23], a[248:251], a[4:7], v[20:23]
    v_accvgpr_mov_b32 a121, a233
    v_accvgpr_mov_b32 a122, a234
    v_mfma_f32_16x16x32_bf16 v[24:27], a[248:251], a[52:55], v[24:27]
    v_accvgpr_mov_b32 a123, a235
    v_accvgpr_mov_b32 a28, a172
    v_mfma_f32_16x16x32_bf16 v[28:31], a[248:251], a[100:103], v[28:31]
    s_waitcnt lgkmcnt(2)
    ds_read_b128 a[248:251], v1 offset:6144
    v_accvgpr_mov_b32 a29, a173
    v_mfma_f32_16x16x32_bf16 v[32:35], a[252:255], a[4:7], v[32:35]
    buffer_load_dwordx4 v1, s[20:23], s45 offen offset:0 sc1 lds
    v_mfma_f32_16x16x32_bf16 v[36:39], a[252:255], a[52:55], v[36:39]
    v_accvgpr_mov_b32 a30, a174
    v_accvgpr_mov_b32 a31, a175
    v_mfma_f32_16x16x32_bf16 v[40:43], a[252:255], a[100:103], v[40:43]
    s_waitcnt lgkmcnt(2)
    ds_read_b128 a[252:255], v1 offset:7168
    v_accvgpr_mov_b32 a76, a204
    v_mfma_f32_16x16x32_bf16 v[20:23], a[240:243], a[8:11], v[20:23]
    v_accvgpr_mov_b32 a77, a205
    v_accvgpr_mov_b32 a78, a206
    v_mfma_f32_16x16x32_bf16 v[24:27], a[240:243], a[56:59], v[24:27]
    buffer_load_dwordx4 v1, s[20:23], s45 offen offset:1024 sc1 lds
    v_mfma_f32_16x16x32_bf16 v[28:31], a[240:243], a[104:107], v[28:31]
    s_waitcnt lgkmcnt(2)
    ds_read_b128 a[240:243], v1 offset:8192
    v_accvgpr_mov_b32 a79, a207
    v_mfma_f32_16x16x32_bf16 v[32:35], a[244:247], a[8:11], v[32:35]
    s_mov_b32 s35, s33
    v_accvgpr_mov_b32 a124, a236
    v_accvgpr_mov_b32 a125, a237
    v_mfma_f32_16x16x32_bf16 v[36:39], a[244:247], a[56:59], v[36:39]
    s_mul_i32 s36, s39, 1536
    v_accvgpr_mov_b32 a126, a238
    v_accvgpr_mov_b32 a127, a239
    v_mfma_f32_16x16x32_bf16 v[40:43], a[244:247], a[104:107], v[40:43]
    s_waitcnt lgkmcnt(2)
    s_add_u32 s36, s36, 593920
    ds_read_b128 a[244:247], v1 offset:9216
    v_mfma_f32_16x16x32_bf16 v[20:23], a[248:251], a[12:15], v[20:23]
    s_mul_i32 s37, s38, 13
    buffer_load_dwordx4 v1, s[20:23], s45 offen offset:2048 sc1 lds
    v_mfma_f32_16x16x32_bf16 v[24:27], a[248:251], a[60:63], v[24:27]
    s_add_u32 s37, s37, s62
    s_add_u32 s39, s39, 4
    ds_read_u16 v106, v5 offset:704
    v_mfma_f32_16x16x32_bf16 v[28:31], a[248:251], a[108:111], v[28:31]
    s_waitcnt lgkmcnt(3)
    s_mul_i32 s44, s39, 19419
    ds_read_b128 a[248:251], v1 offset:10240
    v_mfma_f32_16x16x32_bf16 v[32:35], a[252:255], a[12:15], v[32:35]
    s_lshr_b32 s44, s44, 20
    s_mul_i32 s44, s44, 1741824
    s_mul_i32 s33, s39, 5376
    v_mfma_f32_16x16x32_bf16 v[36:39], a[252:255], a[60:63], v[36:39]
    buffer_load_dwordx4 v1, s[20:23], s45 offen offset:3072 sc1 lds
    s_add_u32 s45, s29, 53248
    v_mfma_f32_16x16x32_bf16 v[40:43], a[252:255], a[108:111], v[40:43]
    s_waitcnt lgkmcnt(3)
    s_add_u32 m0, s29, 53248
    ds_read_b128 a[252:255], v1 offset:11264
    v_mfma_f32_16x16x32_bf16 v[20:23], a[240:243], a[16:19], v[20:23]
    s_waitcnt vmcnt(5)
    s_add_u32 s33, s33, s44
    s_cmp_lt_u32 s38, 2
    s_cselect_b32 s18, 109734912, 0
    ds_read_b128 a[32:35], v3 offset:0
    v_mfma_f32_16x16x32_bf16 v[24:27], a[240:243], a[64:67], v[24:27]
    v_cvt_pk_bf16_f32 v100, v44, v45
    v_cvt_pk_bf16_f32 v101, v46, v47
    v_mfma_f32_16x16x32_bf16 v[28:31], a[240:243], a[112:115], v[28:31]
    s_waitcnt lgkmcnt(4)
    ds_read_b128 a[240:243], v1 offset:12288
    v_cvt_pk_bf16_f32 v102, v48, v49
    v_mfma_f32_16x16x32_bf16 v[32:35], a[244:247], a[16:19], v[32:35]
    ds_read_b128 a[80:83], v3 offset:4352
    v_cvt_pk_bf16_f32 v103, v50, v51
    v_mfma_f32_16x16x32_bf16 v[36:39], a[244:247], a[64:67], v[36:39]
    buffer_load_dwordx4 v1, s[20:23], s45 offen offset:0 sc1 lds
    v_mfma_f32_16x16x32_bf16 v[40:43], a[244:247], a[112:115], v[40:43]
    s_waitcnt lgkmcnt(4)
    ds_read_b128 a[244:247], v1 offset:13312
    v_cvt_pk_bf16_f32 v104, v52, v53
    v_mfma_f32_16x16x32_bf16 v[20:23], a[248:251], a[20:23], v[20:23]
    ds_read_b128 a[128:131], v3 offset:8704
    v_cvt_pk_bf16_f32 v105, v54, v55
    v_mfma_f32_16x16x32_bf16 v[24:27], a[248:251], a[68:71], v[24:27]
    v_cvt_pk_bf16_f32 v108, v56, v57
    v_cvt_pk_bf16_f32 v109, v58, v59
    v_mfma_f32_16x16x32_bf16 v[28:31], a[248:251], a[116:119], v[28:31]
    s_waitcnt lgkmcnt(5)
    ds_read_b128 a[248:251], v1 offset:14336
    v_cvt_pk_bf16_f32 v110, v60, v61
    v_mfma_f32_16x16x32_bf16 v[32:35], a[252:255], a[20:23], v[32:35]
    buffer_load_dwordx4 v1, s[20:23], s45 offen offset:1024 sc1 lds
    s_add_u32 s45, s29, 73728
    v_mfma_f32_16x16x32_bf16 v[36:39], a[252:255], a[68:71], v[36:39]
    s_add_u32 m0, s29, 73728
    ds_read_b128 a[36:39], v3 offset:64
    v_cvt_pk_bf16_f32 v111, v62, v63
    v_mfma_f32_16x16x32_bf16 v[40:43], a[252:255], a[116:119], v[40:43]
    s_waitcnt lgkmcnt(5)
    ds_read_b128 a[252:255], v1 offset:15360
    v_cvt_pk_bf16_f32 v112, v64, v65
    v_mfma_f32_16x16x32_bf16 v[20:23], a[240:243], a[24:27], v[20:23]
    v_cvt_pk_bf16_f32 v113, v66, v67
    v_cvt_pk_bf16_f32 v118, v156, v160
    v_mfma_f32_16x16x32_bf16 v[24:27], a[240:243], a[72:75], v[24:27]
    ds_read_b128 a[84:87], v3 offset:4416
    v_cvt_pk_bf16_f32 v122, v157, v161
    v_mfma_f32_16x16x32_bf16 v[28:31], a[240:243], a[120:123], v[28:31]
    s_waitcnt lgkmcnt(5)
    ds_read_b128 a[240:243], v1 offset:16384
    v_cvt_pk_bf16_f32 v126, v158, v162
    v_mfma_f32_16x16x32_bf16 v[32:35], a[244:247], a[24:27], v[32:35]
    v_cvt_pk_bf16_f32 v130, v159, v163
    v_cvt_pk_bf16_f32 v134, v172, v176
    v_mfma_f32_16x16x32_bf16 v[36:39], a[244:247], a[72:75], v[36:39]
    ds_read_b128 a[132:135], v3 offset:8768
    v_cvt_pk_bf16_f32 v138, v173, v177
    v_mfma_f32_16x16x32_bf16 v[40:43], a[244:247], a[120:123], v[40:43]
    s_waitcnt lgkmcnt(5)
    ds_read_b128 a[244:247], v1 offset:17408
    v_cvt_pk_bf16_f32 v142, v174, v178
    v_mfma_f32_16x16x32_bf16 v[20:23], a[248:251], a[28:31], v[20:23]
    v_cvt_pk_bf16_f32 v146, v175, v179
    v_cvt_pk_bf16_f32 v214, v188, v192
    v_mfma_f32_16x16x32_bf16 v[24:27], a[248:251], a[76:79], v[24:27]
    ds_read_b128 a[40:43], v3 offset:128
    v_cvt_pk_bf16_f32 v218, v189, v193
    v_mfma_f32_16x16x32_bf16 v[28:31], a[248:251], a[124:127], v[28:31]
    s_waitcnt lgkmcnt(5)
    ds_read_b128 a[248:251], v1 offset:18432
    v_cvt_pk_bf16_f32 v222, v190, v194
    v_mfma_f32_16x16x32_bf16 v[32:35], a[252:255], a[28:31], v[32:35]
    v_cvt_pk_bf16_f32 v226, v191, v195
    v_cvt_pk_bf16_f32 v230, v204, v208
    v_mfma_f32_16x16x32_bf16 v[36:39], a[252:255], a[76:79], v[36:39]
    ds_read_b128 a[88:91], v3 offset:4480
    v_mfma_f32_16x16x32_bf16 v[40:43], a[252:255], a[124:127], v[40:43]
    s_waitcnt lgkmcnt(5)
    ds_read_b128 a[252:255], v1 offset:19456
    v_mfma_f32_16x16x32_bf16 v[20:23], a[240:243], a[32:35], v[20:23]
    buffer_load_dwordx4 v1, s[20:23], s45 offen offset:0 sc1 lds
    v_mfma_f32_16x16x32_bf16 v[24:27], a[240:243], a[80:83], v[24:27]
    ds_read_b128 a[136:139], v3 offset:8832
    v_mfma_f32_16x16x32_bf16 v[28:31], a[240:243], a[128:131], v[28:31]
    s_waitcnt lgkmcnt(5)
    ds_read_b128 a[240:243], v1 offset:20480
    v_mfma_f32_16x16x32_bf16 v[32:35], a[244:247], a[32:35], v[32:35]
    v_mfma_f32_16x16x32_bf16 v[36:39], a[244:247], a[80:83], v[36:39]
    ds_read_b128 a[44:47], v3 offset:192
    v_mfma_f32_16x16x32_bf16 v[40:43], a[244:247], a[128:131], v[40:43]
    s_waitcnt lgkmcnt(5)
    ds_read_b128 a[244:247], v1 offset:21504
    v_mfma_f32_16x16x32_bf16 v[20:23], a[248:251], a[36:39], v[20:23]
    buffer_load_dwordx4 v1, s[20:23], s45 offen offset:1024 sc1 lds
    v_mfma_f32_16x16x32_bf16 v[24:27], a[248:251], a[84:87], v[24:27]
    ds_read_b128 a[92:95], v3 offset:4544
    v_mfma_f32_16x16x32_bf16 v[28:31], a[248:251], a[132:135], v[28:31]
    s_waitcnt lgkmcnt(5)
    ds_read_b128 a[248:251], v1 offset:22528
    v_mfma_f32_16x16x32_bf16 v[32:35], a[252:255], a[36:39], v[32:35]
    v_mfma_f32_16x16x32_bf16 v[36:39], a[252:255], a[84:87], v[36:39]
    ds_read_b128 a[140:143], v3 offset:8896
    v_mfma_f32_16x16x32_bf16 v[40:43], a[252:255], a[132:135], v[40:43]
    s_waitcnt lgkmcnt(5)
    ds_read_b128 a[252:255], v1 offset:23552
    v_mfma_f32_16x16x32_bf16 v[20:23], a[240:243], a[40:43], v[20:23]
    buffer_load_dwordx4 v1, s[20:23], s45 offen offset:2048 sc1 lds
    v_mfma_f32_16x16x32_bf16 v[24:27], a[240:243], a[88:91], v[24:27]
    ds_read_u16 v114, v5 offset:706
    v_mfma_f32_16x16x32_bf16 v[28:31], a[240:243], a[136:139], v[28:31]
    s_waitcnt lgkmcnt(5)
    ds_read_b128 a[240:243], v1 offset:24576
    v_mfma_f32_16x16x32_bf16 v[32:35], a[244:247], a[40:43], v[32:35]
    v_mfma_f32_16x16x32_bf16 v[36:39], a[244:247], a[88:91], v[36:39]
    buffer_load_dwordx4 v1, s[20:23], s45 offen offset:3072 sc1 lds
    s_add_u32 s45, s29, 77824
    v_mfma_f32_16x16x32_bf16 v[40:43], a[244:247], a[136:139], v[40:43]
    s_waitcnt lgkmcnt(4)
    s_add_u32 m0, s29, 77824
    ds_read_b128 a[244:247], v1 offset:25600
    v_mfma_f32_16x16x32_bf16 v[20:23], a[248:251], a[44:47], v[20:23]
    v_mfma_f32_16x16x32_bf16 v[24:27], a[248:251], a[92:95], v[24:27]
    s_waitcnt lgkmcnt(4)
    v_mfma_f32_16x16x32_bf16 v[28:31], a[248:251], a[140:143], v[28:31]
    s_waitcnt lgkmcnt(3)
    ds_read_b128 a[248:251], v1 offset:26624
    v_mfma_f32_16x16x32_bf16 v[32:35], a[252:255], a[44:47], v[32:35]
    buffer_load_dwordx4 v1, s[20:23], s45 offen offset:0 sc1 lds
    v_mfma_f32_16x16x32_bf16 v[36:39], a[252:255], a[92:95], v[36:39]
    v_mfma_f32_16x16x32_bf16 v[40:43], a[252:255], a[140:143], v[40:43]
    v_mfma_f32_16x16x32_bf16 v[156:159], v[148:151], v[100:103], 0
    v_mfma_f32_16x16x32_bf16 v[172:175], v[164:167], v[100:103], 0
    buffer_load_dwordx4 v1, s[20:23], s45 offen offset:1024 sc1 lds
    v_mfma_f32_16x16x32_bf16 v[188:191], v[180:183], v[100:103], 0
    v_mfma_f32_16x16x32_bf16 v[204:207], v[196:199], v[100:103], 0
    v_mfma_f32_16x16x32_bf16 v[160:163], v[148:151], v[108:111], 0
    v_mfma_f32_16x16x32_bf16 v[176:179], v[164:167], v[108:111], 0
    v_mfma_f32_16x16x32_bf16 v[192:195], v[180:183], v[108:111], 0
    v_mfma_f32_16x16x32_bf16 v[208:211], v[196:199], v[108:111], 0
    v_mfma_f32_16x16x32_bf16 v[156:159], v[152:155], v[104:107], v[156:159]
    v_mfma_f32_16x16x32_bf16 v[172:175], v[168:171], v[104:107], v[172:175]
    v_mfma_f32_16x16x32_bf16 v[188:191], v[184:187], v[104:107], v[188:191]
    v_mfma_f32_16x16x32_bf16 v[204:207], v[200:203], v[104:107], v[204:207]
    s_waitcnt lgkmcnt(3)
    v_mfma_f32_16x16x32_bf16 v[160:163], v[152:155], v[112:115], v[160:163]
    v_mfma_f32_16x16x32_bf16 v[176:179], v[168:171], v[112:115], v[176:179]
    v_mfma_f32_16x16x32_bf16 v[192:195], v[184:187], v[112:115], v[192:195]
    v_mfma_f32_16x16x32_bf16 v[208:211], v[200:203], v[112:115], v[208:211]
    s_waitcnt lgkmcnt(2)
    v_mfma_f32_16x16x32_bf16 v[44:47], a[240:243], a[0:3], 0
    ds_read_b128 a[252:255], v1 offset:27648
    v_mfma_f32_16x16x32_bf16 v[48:51], a[240:243], a[48:51], 0
    v_cvt_pk_bf16_f32 v68, v20, v21
    v_cvt_pk_bf16_f32 v69, v22, v23
    v_mfma_f32_16x16x32_bf16 v[52:55], a[240:243], a[96:99], 0
    s_waitcnt lgkmcnt(2)
    ds_read_b128 a[240:243], v1 offset:28672
    v_cvt_pk_bf16_f32 v70, v32, v33
    v_mfma_f32_16x16x32_bf16 v[56:59], a[244:247], a[0:3], 0
    v_cvt_pk_bf16_f32 v71, v34, v35
    v_cvt_pk_bf16_f32 v76, v24, v25
    v_mfma_f32_16x16x32_bf16 v[60:63], a[244:247], a[48:51], 0
    v_cvt_pk_bf16_f32 v77, v26, v27
    v_cvt_pk_bf16_f32 v78, v36, v37
    v_mfma_f32_16x16x32_bf16 v[64:67], a[244:247], a[96:99], 0
    s_waitcnt lgkmcnt(2)
    ds_read_b128 a[244:247], v1 offset:29696
    v_cvt_pk_bf16_f32 v79, v38, v39
    v_mfma_f32_16x16x32_bf16 v[44:47], a[248:251], a[4:7], v[44:47]
    v_cvt_pk_bf16_f32 v84, v28, v29
    v_cvt_pk_bf16_f32 v85, v30, v31
    v_mfma_f32_16x16x32_bf16 v[48:51], a[248:251], a[52:55], v[48:51]
    v_cvt_pk_bf16_f32 v86, v40, v41
    v_cvt_pk_bf16_f32 v87, v42, v43
    v_mfma_f32_16x16x32_bf16 v[52:55], a[248:251], a[100:103], v[52:55]
    s_waitcnt lgkmcnt(2)
    ds_read_b128 a[248:251], v1 offset:30720
    v_cvt_pk_bf16_f32 v119, v156, v160
    v_mfma_f32_16x16x32_bf16 v[56:59], a[252:255], a[4:7], v[56:59]
    ds_read_b128 v[232:235], v4 offset:0
    v_cvt_pk_bf16_f32 v123, v157, v161
    v_mfma_f32_16x16x32_bf16 v[60:63], a[252:255], a[52:55], v[60:63]
    v_cvt_pk_bf16_f32 v127, v158, v162
    v_cvt_pk_bf16_f32 v131, v159, v163
    v_mfma_f32_16x16x32_bf16 v[64:67], a[252:255], a[100:103], v[64:67]
    s_waitcnt lgkmcnt(3)
    ds_read_b128 a[252:255], v1 offset:31744
    v_cvt_pk_bf16_f32 v135, v172, v176
    v_mfma_f32_16x16x32_bf16 v[44:47], a[240:243], a[8:11], v[44:47]
    v_cvt_pk_bf16_f32 v139, v173, v177
    v_cvt_pk_bf16_f32 v143, v174, v178
    v_mfma_f32_16x16x32_bf16 v[48:51], a[240:243], a[56:59], v[48:51]
    v_cvt_pk_bf16_f32 v147, v175, v179
    v_cvt_pk_bf16_f32 v215, v188, v192
    v_mfma_f32_16x16x32_bf16 v[52:55], a[240:243], a[104:107], v[52:55]
    s_waitcnt lgkmcnt(3)
    ds_read_b128 a[240:243], v1 offset:32768
    v_cvt_pk_bf16_f32 v219, v189, v193
    v_mfma_f32_16x16x32_bf16 v[56:59], a[244:247], a[8:11], v[56:59]
    v_cvt_pk_bf16_f32 v223, v190, v194
    v_cvt_pk_bf16_f32 v227, v191, v195
    v_mfma_f32_16x16x32_bf16 v[60:63], a[244:247], a[56:59], v[60:63]
    v_cvt_pk_bf16_f32 v231, v204, v208
    v_mfma_f32_16x16x32_bf16 v[64:67], a[244:247], a[104:107], v[64:67]
    s_waitcnt lgkmcnt(3)
    ds_read_b128 a[244:247], v1 offset:33792
    v_mfma_f32_16x16x32_bf16 v[44:47], a[248:251], a[12:15], v[44:47]
    buffer_store_dwordx4 v[116:119], v7, s[24:27], s34 offen offset:512 nt
    v_mfma_f32_16x16x32_bf16 v[48:51], a[248:251], a[60:63], v[48:51]
    v_mfma_f32_16x16x32_bf16 v[52:55], a[248:251], a[108:111], v[52:55]
    s_waitcnt lgkmcnt(2)
    ds_read_b128 a[248:251], v1 offset:34816
    v_mfma_f32_16x16x32_bf16 v[56:59], a[252:255], a[12:15], v[56:59]
    v_mfma_f32_16x16x32_bf16 v[60:63], a[252:255], a[60:63], v[60:63]
    buffer_store_dwordx4 v[120:123], v8, s[24:27], s34 offen offset:512 nt
    v_mfma_f32_16x16x32_bf16 v[64:67], a[252:255], a[108:111], v[64:67]
    s_waitcnt lgkmcnt(2)
    ds_read_b128 a[252:255], v1 offset:35840
    v_mfma_f32_16x16x32_bf16 v[44:47], a[240:243], a[16:19], v[44:47]
    v_mfma_f32_16x16x32_bf16 v[48:51], a[240:243], a[64:67], v[48:51]
    v_mfma_f32_16x16x32_bf16 v[52:55], a[240:243], a[112:115], v[52:55]
    s_waitcnt lgkmcnt(2)
    ds_read_b128 a[240:243], v1 offset:36864
    v_mfma_f32_16x16x32_bf16 v[56:59], a[244:247], a[16:19], v[56:59]
    buffer_store_dwordx4 v[124:127], v9, s[24:27], s34 offen offset:512 nt
    v_mfma_f32_16x16x32_bf16 v[60:63], a[244:247], a[64:67], v[60:63]
    v_mfma_f32_16x16x32_bf16 v[64:67], a[244:247], a[112:115], v[64:67]
    s_waitcnt lgkmcnt(2)
    ds_read_b128 a[244:247], v1 offset:37888
    v_mfma_f32_16x16x32_bf16 v[44:47], a[248:251], a[20:23], v[44:47]
    v_mfma_f32_16x16x32_bf16 v[48:51], a[248:251], a[68:71], v[48:51]
    buffer_store_dwordx4 v[128:131], v10, s[24:27], s34 offen offset:512 nt
    v_mfma_f32_16x16x32_bf16 v[52:55], a[248:251], a[116:119], v[52:55]
    s_waitcnt lgkmcnt(2)
    ds_read_b128 a[248:251], v1 offset:38912
    v_mfma_f32_16x16x32_bf16 v[56:59], a[252:255], a[20:23], v[56:59]
    v_mfma_f32_16x16x32_bf16 v[60:63], a[252:255], a[68:71], v[60:63]
    v_mfma_f32_16x16x32_bf16 v[64:67], a[252:255], a[116:119], v[64:67]
    s_waitcnt lgkmcnt(2)
    ds_read_b128 a[252:255], v1 offset:39936
    v_mfma_f32_16x16x32_bf16 v[44:47], a[240:243], a[24:27], v[44:47]
    buffer_store_dwordx4 v[132:135], v11, s[24:27], s34 offen offset:512 nt
    v_mfma_f32_16x16x32_bf16 v[48:51], a[240:243], a[72:75], v[48:51]
    v_mfma_f32_16x16x32_bf16 v[52:55], a[240:243], a[120:123], v[52:55]
    s_waitcnt lgkmcnt(2)
    ds_read_b128 a[240:243], v1 offset:40960
    v_mfma_f32_16x16x32_bf16 v[56:59], a[244:247], a[24:27], v[56:59]
    v_mfma_f32_16x16x32_bf16 v[60:63], a[244:247], a[72:75], v[60:63]
    buffer_store_dwordx4 v[136:139], v12, s[24:27], s34 offen offset:512 nt
    v_mfma_f32_16x16x32_bf16 v[64:67], a[244:247], a[120:123], v[64:67]
    s_waitcnt lgkmcnt(2)
    ds_read_b128 a[244:247], v1 offset:41984
    v_mfma_f32_16x16x32_bf16 v[44:47], a[248:251], a[28:31], v[44:47]
    v_mfma_f32_16x16x32_bf16 v[48:51], a[248:251], a[76:79], v[48:51]
    v_mfma_f32_16x16x32_bf16 v[52:55], a[248:251], a[124:127], v[52:55]
    s_waitcnt lgkmcnt(2)
    ds_read_b128 a[248:251], v1 offset:43008
    v_mfma_f32_16x16x32_bf16 v[56:59], a[252:255], a[28:31], v[56:59]
    buffer_store_dwordx4 v[140:143], v13, s[24:27], s34 offen offset:512 nt
    v_mfma_f32_16x16x32_bf16 v[60:63], a[252:255], a[76:79], v[60:63]
    v_mfma_f32_16x16x32_bf16 v[64:67], a[252:255], a[124:127], v[64:67]
    s_waitcnt lgkmcnt(2)
    ds_read_b128 a[252:255], v1 offset:44032
    v_mfma_f32_16x16x32_bf16 v[44:47], a[240:243], a[32:35], v[44:47]
    v_mfma_f32_16x16x32_bf16 v[48:51], a[240:243], a[80:83], v[48:51]
    buffer_store_dwordx4 v[144:147], v14, s[24:27], s34 offen offset:512 nt
    v_mfma_f32_16x16x32_bf16 v[52:55], a[240:243], a[128:131], v[52:55]
    s_waitcnt lgkmcnt(2)
    ds_read_b128 a[240:243], v1 offset:45056
    v_mfma_f32_16x16x32_bf16 v[56:59], a[244:247], a[32:35], v[56:59]
    v_mfma_f32_16x16x32_bf16 v[60:63], a[244:247], a[80:83], v[60:63]
    v_mfma_f32_16x16x32_bf16 v[64:67], a[244:247], a[128:131], v[64:67]
    s_waitcnt lgkmcnt(2)
    ds_read_b128 a[244:247], v1 offset:46080
    v_mfma_f32_16x16x32_bf16 v[44:47], a[248:251], a[36:39], v[44:47]
    buffer_store_dwordx4 v[212:215], v15, s[24:27], s34 offen offset:512 nt
    v_mfma_f32_16x16x32_bf16 v[48:51], a[248:251], a[84:87], v[48:51]
    v_mfma_f32_16x16x32_bf16 v[52:55], a[248:251], a[132:135], v[52:55]
    s_waitcnt lgkmcnt(2)
    ds_read_b128 a[248:251], v1 offset:47104
    v_mfma_f32_16x16x32_bf16 v[56:59], a[252:255], a[36:39], v[56:59]
    v_mfma_f32_16x16x32_bf16 v[60:63], a[252:255], a[84:87], v[60:63]
    buffer_store_dwordx4 v[216:219], v16, s[24:27], s34 offen offset:512 nt
    v_mfma_f32_16x16x32_bf16 v[64:67], a[252:255], a[132:135], v[64:67]
    s_waitcnt lgkmcnt(2)
    ds_read_b128 a[252:255], v1 offset:48128
    v_mfma_f32_16x16x32_bf16 v[44:47], a[240:243], a[40:43], v[44:47]
    v_mfma_f32_16x16x32_bf16 v[48:51], a[240:243], a[88:91], v[48:51]
    v_mfma_f32_16x16x32_bf16 v[52:55], a[240:243], a[136:139], v[52:55]
    s_waitcnt lgkmcnt(2)
    buffer_store_dwordx4 v[220:223], v17, s[24:27], s34 offen offset:512 nt
    v_mfma_f32_16x16x32_bf16 v[56:59], a[244:247], a[40:43], v[56:59]
    v_mfma_f32_16x16x32_bf16 v[60:63], a[244:247], a[88:91], v[60:63]
    v_mfma_f32_16x16x32_bf16 v[64:67], a[244:247], a[136:139], v[64:67]
    s_waitcnt lgkmcnt(1)
    v_mfma_f32_16x16x32_bf16 v[44:47], a[248:251], a[44:47], v[44:47]
    buffer_store_dwordx4 v[224:227], v18, s[24:27], s34 offen offset:512 nt
    v_mfma_f32_16x16x32_bf16 v[48:51], a[248:251], a[92:95], v[48:51]
    v_mfma_f32_16x16x32_bf16 v[52:55], a[248:251], a[140:143], v[52:55]
    s_waitcnt vmcnt(12) lgkmcnt(0)
    s_barrier
    ds_read_b128 a[240:243], v2 offset:0
    v_mfma_f32_16x16x32_bf16 v[56:59], a[252:255], a[44:47], v[56:59]
    ds_read_b128 a[244:247], v2 offset:1024
    v_mfma_f32_16x16x32_bf16 v[60:63], a[252:255], a[92:95], v[60:63]
    s_add_u32 s45, s29, 98304
    s_add_u32 m0, s29, 0
    ds_read_b128 a[248:251], v2 offset:2048
    v_mfma_f32_16x16x32_bf16 v[64:67], a[252:255], a[140:143], v[64:67]
    buffer_load_dwordx4 v1, s[20:23], s45 offen offset:0 sc1 lds
    v_mfma_f32_16x16x32_bf16 v[148:151], a[0:3], v[68:71], 0
    v_mfma_f32_16x16x32_bf16 v[152:155], a[48:51], v[68:71], 0
    v_mfma_f32_16x16x32_bf16 v[156:159], a[96:99], v[68:71], 0
    v_mfma_f32_16x16x32_bf16 v[160:163], v[232:235], v[68:71], 0
    buffer_load_dwordx4 v1, s[20:23], s45 offen offset:1024 sc1 lds
    v_mfma_f32_16x16x32_bf16 v[164:167], a[0:3], v[76:79], 0
    v_mfma_f32_16x16x32_bf16 v[168:171], a[48:51], v[76:79], 0
    v_mfma_f32_16x16x32_bf16 v[172:175], a[96:99], v[76:79], 0
    v_mfma_f32_16x16x32_bf16 v[176:179], v[232:235], v[76:79], 0
    buffer_load_dwordx4 v1, s[20:23], s45 offen offset:2048 sc1 lds
    v_mfma_f32_16x16x32_bf16 v[180:183], a[0:3], v[84:87], 0
    v_mfma_f32_16x16x32_bf16 v[184:187], a[48:51], v[84:87], 0
    v_mfma_f32_16x16x32_bf16 v[188:191], a[96:99], v[84:87], 0
    v_mfma_f32_16x16x32_bf16 v[192:195], v[232:235], v[84:87], 0
    s_waitcnt lgkmcnt(2)
    buffer_load_dwordx4 v1, s[20:23], s45 offen offset:3072 sc1 lds
    v_mfma_f32_16x16x32_bf16 v[20:23], a[240:243], a[0:3], 0
    s_add_u32 s45, s29, 102400
    s_add_u32 m0, s29, 4096
    ds_read_b128 a[252:255], v2 offset:3072
    v_mfma_f32_16x16x32_bf16 v[24:27], a[240:243], a[48:51], 0
    v_cvt_pk_bf16_f32 v68, v44, v45
    v_cvt_pk_bf16_f32 v69, v46, v47
    v_mfma_f32_16x16x32_bf16 v[28:31], a[240:243], a[96:99], 0
    s_waitcnt lgkmcnt(2)
    ds_read_b128 a[240:243], v2 offset:4096
    v_cvt_pk_bf16_f32 v70, v56, v57
    v_mfma_f32_16x16x32_bf16 v[32:35], a[244:247], a[0:3], 0
    buffer_load_dwordx4 v1, s[20:23], s45 offen offset:0 sc1 lds
    v_mfma_f32_16x16x32_bf16 v[36:39], a[244:247], a[48:51], 0
    v_cvt_pk_bf16_f32 v71, v58, v59
    v_cvt_pk_bf16_f32 v76, v48, v49
    v_mfma_f32_16x16x32_bf16 v[40:43], a[244:247], a[96:99], 0
    s_waitcnt lgkmcnt(2)
    ds_read_b128 a[244:247], v2 offset:5120
    v_cvt_pk_bf16_f32 v77, v50, v51
    v_mfma_f32_16x16x32_bf16 v[20:23], a[248:251], a[4:7], v[20:23]
    v_cvt_pk_bf16_f32 v78, v60, v61
    v_cvt_pk_bf16_f32 v79, v62, v63
    v_mfma_f32_16x16x32_bf16 v[24:27], a[248:251], a[52:55], v[24:27]
    buffer_load_dwordx4 v1, s[20:23], s45 offen offset:1024 sc1 lds
    s_add_u32 s45, s29, 122880
    v_mfma_f32_16x16x32_bf16 v[28:31], a[248:251], a[100:103], v[28:31]
    s_waitcnt lgkmcnt(2)
    s_add_u32 m0, s29, 24576
    ds_read_b128 a[248:251], v2 offset:6144
    v_mfma_f32_16x16x32_bf16 v[32:35], a[252:255], a[4:7], v[32:35]
    ds_read_b128 v[236:239], v4 offset:64
    v_cvt_pk_bf16_f32 v84, v52, v53
    v_mfma_f32_16x16x32_bf16 v[36:39], a[252:255], a[52:55], v[36:39]
    v_cvt_pk_bf16_f32 v85, v54, v55
    v_cvt_pk_bf16_f32 v86, v64, v65
    v_mfma_f32_16x16x32_bf16 v[40:43], a[252:255], a[100:103], v[40:43]
    s_waitcnt lgkmcnt(3)
    ds_read_b128 a[252:255], v2 offset:7168
    v_cvt_pk_bf16_f32 v87, v66, v67
    v_mfma_f32_16x16x32_bf16 v[20:23], a[240:243], a[8:11], v[20:23]
    buffer_load_dwordx4 v1, s[20:23], s45 offen offset:0 sc1 lds
    v_mfma_f32_16x16x32_bf16 v[24:27], a[240:243], a[56:59], v[24:27]
    v_mfma_f32_16x16x32_bf16 v[28:31], a[240:243], a[104:107], v[28:31]
    s_waitcnt lgkmcnt(3)
    ds_read_b128 a[240:243], v2 offset:8192
    v_mfma_f32_16x16x32_bf16 v[32:35], a[244:247], a[8:11], v[32:35]
    v_mfma_f32_16x16x32_bf16 v[36:39], a[244:247], a[56:59], v[36:39]
    buffer_load_dwordx4 v1, s[20:23], s45 offen offset:1024 sc1 lds
    v_mfma_f32_16x16x32_bf16 v[40:43], a[244:247], a[104:107], v[40:43]
    s_waitcnt lgkmcnt(3)
    ds_read_b128 a[244:247], v2 offset:9216
    v_mfma_f32_16x16x32_bf16 v[20:23], a[248:251], a[12:15], v[20:23]
    v_mfma_f32_16x16x32_bf16 v[24:27], a[248:251], a[60:63], v[24:27]
    v_mfma_f32_16x16x32_bf16 v[28:31], a[248:251], a[108:111], v[28:31]
    s_waitcnt lgkmcnt(2)
    ds_read_b128 a[248:251], v2 offset:10240
    v_mfma_f32_16x16x32_bf16 v[32:35], a[252:255], a[12:15], v[32:35]
    buffer_load_dwordx4 v1, s[20:23], s45 offen offset:2048 sc1 lds
    v_mfma_f32_16x16x32_bf16 v[36:39], a[252:255], a[60:63], v[36:39]
    v_mfma_f32_16x16x32_bf16 v[40:43], a[252:255], a[108:111], v[40:43]
    s_waitcnt lgkmcnt(2)
    ds_read_b128 a[252:255], v2 offset:11264
    v_mfma_f32_16x16x32_bf16 v[20:23], a[240:243], a[16:19], v[20:23]
    v_mfma_f32_16x16x32_bf16 v[24:27], a[240:243], a[64:67], v[24:27]
    buffer_load_dwordx4 v1, s[20:23], s45 offen offset:3072 sc1 lds
    s_add_u32 s45, s29, 126976
    v_mfma_f32_16x16x32_bf16 v[28:31], a[240:243], a[112:115], v[28:31]
    s_waitcnt lgkmcnt(2)
    s_add_u32 m0, s29, 28672
    ds_read_b128 a[240:243], v2 offset:12288
    v_mfma_f32_16x16x32_bf16 v[32:35], a[244:247], a[16:19], v[32:35]
    v_mfma_f32_16x16x32_bf16 v[36:39], a[244:247], a[64:67], v[36:39]
    v_mfma_f32_16x16x32_bf16 v[40:43], a[244:247], a[112:115], v[40:43]
    s_waitcnt lgkmcnt(2)
    ds_read_b128 a[244:247], v2 offset:13312
    v_mfma_f32_16x16x32_bf16 v[20:23], a[248:251], a[20:23], v[20:23]
    buffer_load_dwordx4 v1, s[20:23], s45 offen offset:0 sc1 lds
    v_mfma_f32_16x16x32_bf16 v[24:27], a[248:251], a[68:71], v[24:27]
    v_mfma_f32_16x16x32_bf16 v[28:31], a[248:251], a[116:119], v[28:31]
    s_waitcnt lgkmcnt(2)
    ds_read_b128 a[248:251], v2 offset:14336
    v_mfma_f32_16x16x32_bf16 v[32:35], a[252:255], a[20:23], v[32:35]
    v_mfma_f32_16x16x32_bf16 v[36:39], a[252:255], a[68:71], v[36:39]
    buffer_load_dwordx4 v1, s[20:23], s45 offen offset:1024 sc1 lds
    v_mfma_f32_16x16x32_bf16 v[40:43], a[252:255], a[116:119], v[40:43]
    s_waitcnt lgkmcnt(2)
    ds_read_b128 a[252:255], v2 offset:15360
    v_mfma_f32_16x16x32_bf16 v[20:23], a[240:243], a[24:27], v[20:23]
    v_mfma_f32_16x16x32_bf16 v[24:27], a[240:243], a[72:75], v[24:27]
    v_mfma_f32_16x16x32_bf16 v[28:31], a[240:243], a[120:123], v[28:31]
    s_waitcnt lgkmcnt(2)
    ds_read_b128 a[240:243], v2 offset:16384
    v_mfma_f32_16x16x32_bf16 v[32:35], a[244:247], a[24:27], v[32:35]
    buffer_store_dwordx4 v[228:231], v19, s[24:27], s34 offen offset:512 nt
    s_mov_b32 s34, s35
    v_mfma_f32_16x16x32_bf16 v[36:39], a[244:247], a[72:75], v[36:39]
    s_mov_b32 s26, 109734912
    v_mfma_f32_16x16x32_bf16 v[40:43], a[244:247], a[120:123], v[40:43]
    s_waitcnt lgkmcnt(2)
    ds_read_b128 a[244:247], v2 offset:17408
    v_mfma_f32_16x16x32_bf16 v[20:23], a[248:251], a[28:31], v[20:23]
    v_mfma_f32_16x16x32_bf16 v[24:27], a[248:251], a[76:79], v[24:27]
    v_mfma_f32_16x16x32_bf16 v[28:31], a[248:251], a[124:127], v[28:31]
    s_waitcnt lgkmcnt(2)
    ds_read_b128 a[248:251], v2 offset:18432
    v_mfma_f32_16x16x32_bf16 v[32:35], a[252:255], a[28:31], v[32:35]
    v_mfma_f32_16x16x32_bf16 v[36:39], a[252:255], a[76:79], v[36:39]
    v_mfma_f32_16x16x32_bf16 v[40:43], a[252:255], a[124:127], v[40:43]
    s_waitcnt lgkmcnt(2)
    ds_read_b128 a[252:255], v2 offset:19456
    v_mfma_f32_16x16x32_bf16 v[20:23], a[240:243], a[32:35], v[20:23]
    v_mfma_f32_16x16x32_bf16 v[24:27], a[240:243], a[80:83], v[24:27]
    v_mfma_f32_16x16x32_bf16 v[28:31], a[240:243], a[128:131], v[28:31]
    s_waitcnt lgkmcnt(2)
    ds_read_b128 a[240:243], v2 offset:20480
    v_mfma_f32_16x16x32_bf16 v[32:35], a[244:247], a[32:35], v[32:35]
    v_mfma_f32_16x16x32_bf16 v[36:39], a[244:247], a[80:83], v[36:39]
    v_mfma_f32_16x16x32_bf16 v[40:43], a[244:247], a[128:131], v[40:43]
    s_waitcnt lgkmcnt(2)
    ds_read_b128 a[244:247], v2 offset:21504
    v_mfma_f32_16x16x32_bf16 v[20:23], a[248:251], a[36:39], v[20:23]
    v_mfma_f32_16x16x32_bf16 v[24:27], a[248:251], a[84:87], v[24:27]
    v_mfma_f32_16x16x32_bf16 v[28:31], a[248:251], a[132:135], v[28:31]
    s_waitcnt lgkmcnt(2)
    ds_read_b128 a[248:251], v2 offset:22528
    v_mfma_f32_16x16x32_bf16 v[32:35], a[252:255], a[36:39], v[32:35]
    v_mfma_f32_16x16x32_bf16 v[36:39], a[252:255], a[84:87], v[36:39]
    v_mfma_f32_16x16x32_bf16 v[40:43], a[252:255], a[132:135], v[40:43]
    s_waitcnt lgkmcnt(2)
    ds_read_b128 a[252:255], v2 offset:23552
    v_mfma_f32_16x16x32_bf16 v[20:23], a[240:243], a[40:43], v[20:23]
    v_mfma_f32_16x16x32_bf16 v[24:27], a[240:243], a[88:91], v[24:27]
    v_mfma_f32_16x16x32_bf16 v[28:31], a[240:243], a[136:139], v[28:31]
    s_waitcnt lgkmcnt(2)
    ds_read_b128 a[240:243], v2 offset:24576
    v_mfma_f32_16x16x32_bf16 v[32:35], a[244:247], a[40:43], v[32:35]
    v_mfma_f32_16x16x32_bf16 v[36:39], a[244:247], a[88:91], v[36:39]
    v_mfma_f32_16x16x32_bf16 v[40:43], a[244:247], a[136:139], v[40:43]
    s_waitcnt lgkmcnt(2)
    ds_read_b128 a[244:247], v2 offset:25600
    v_mfma_f32_16x16x32_bf16 v[20:23], a[248:251], a[44:47], v[20:23]
    v_mfma_f32_16x16x32_bf16 v[24:27], a[248:251], a[92:95], v[24:27]
    v_mfma_f32_16x16x32_bf16 v[28:31], a[248:251], a[140:143], v[28:31]
    s_waitcnt lgkmcnt(2)
    ds_read_b128 a[248:251], v2 offset:26624
    v_mfma_f32_16x16x32_bf16 v[32:35], a[252:255], a[44:47], v[32:35]
    v_mfma_f32_16x16x32_bf16 v[36:39], a[252:255], a[92:95], v[36:39]
    s_add_u32 m0, s31, 0
    v_mfma_f32_16x16x32_bf16 v[40:43], a[252:255], a[140:143], v[40:43]
    buffer_load_dwordx4 v7, s[16:19], s33 offen offset:0 nt lds
    s_add_u32 m0, s31, 1088
    v_mfma_f32_16x16x32_bf16 v[148:151], a[4:7], v[68:71], v[148:151]
    v_mfma_f32_16x16x32_bf16 v[152:155], a[52:55], v[68:71], v[152:155]
    v_mfma_f32_16x16x32_bf16 v[156:159], a[100:103], v[68:71], v[156:159]
    v_mfma_f32_16x16x32_bf16 v[160:163], v[236:239], v[68:71], v[160:163]
    buffer_load_dwordx4 v8, s[16:19], s33 offen offset:0 nt lds
    s_add_u32 m0, s31, 2176
    v_mfma_f32_16x16x32_bf16 v[164:167], a[4:7], v[76:79], v[164:167]
    v_mfma_f32_16x16x32_bf16 v[168:171], a[52:55], v[76:79], v[168:171]
    v_mfma_f32_16x16x32_bf16 v[172:175], a[100:103], v[76:79], v[172:175]
    v_mfma_f32_16x16x32_bf16 v[176:179], v[236:239], v[76:79], v[176:179]
    buffer_load_dwordx4 v9, s[16:19], s33 offen offset:0 nt lds
    s_add_u32 m0, s31, 3264
    v_mfma_f32_16x16x32_bf16 v[180:183], a[4:7], v[84:87], v[180:183]
    v_mfma_f32_16x16x32_bf16 v[184:187], a[52:55], v[84:87], v[184:187]
    v_mfma_f32_16x16x32_bf16 v[188:191], a[100:103], v[84:87], v[188:191]
    v_mfma_f32_16x16x32_bf16 v[192:195], v[236:239], v[84:87], v[192:195]
    s_waitcnt lgkmcnt(2)
    buffer_load_dwordx4 v10, s[16:19], s33 offen offset:0 nt lds
    v_mfma_f32_16x16x32_bf16 v[44:47], a[240:243], a[0:3], 0
    ds_read_b128 a[252:255], v2 offset:27648
    v_mfma_f32_16x16x32_bf16 v[48:51], a[240:243], a[48:51], 0
    v_cvt_pk_bf16_f32 v68, v20, v21
    v_cvt_pk_bf16_f32 v69, v22, v23
    v_mfma_f32_16x16x32_bf16 v[52:55], a[240:243], a[96:99], 0
    s_waitcnt lgkmcnt(2)
    ds_read_b128 a[240:243], v2 offset:28672
    v_cvt_pk_bf16_f32 v70, v32, v33
    v_mfma_f32_16x16x32_bf16 v[56:59], a[244:247], a[0:3], 0
    v_cvt_pk_bf16_f32 v71, v34, v35
    v_cvt_pk_bf16_f32 v76, v24, v25
    v_mfma_f32_16x16x32_bf16 v[60:63], a[244:247], a[48:51], 0
    v_cvt_pk_bf16_f32 v77, v26, v27
    v_cvt_pk_bf16_f32 v78, v36, v37
    v_mfma_f32_16x16x32_bf16 v[64:67], a[244:247], a[96:99], 0
    s_waitcnt lgkmcnt(2)
    ds_read_b128 a[244:247], v2 offset:29696
    v_cvt_pk_bf16_f32 v79, v38, v39
    v_mfma_f32_16x16x32_bf16 v[44:47], a[248:251], a[4:7], v[44:47]
    v_cvt_pk_bf16_f32 v84, v28, v29
    v_cvt_pk_bf16_f32 v85, v30, v31
    v_mfma_f32_16x16x32_bf16 v[48:51], a[248:251], a[52:55], v[48:51]
    v_cvt_pk_bf16_f32 v86, v40, v41
    v_cvt_pk_bf16_f32 v87, v42, v43
    v_mfma_f32_16x16x32_bf16 v[52:55], a[248:251], a[100:103], v[52:55]
    s_waitcnt lgkmcnt(2)
    ds_read_b128 a[248:251], v2 offset:30720
    v_mfma_f32_16x16x32_bf16 v[56:59], a[252:255], a[4:7], v[56:59]
    ds_read_b128 v[240:243], v4 offset:128
    v_mfma_f32_16x16x32_bf16 v[60:63], a[252:255], a[52:55], v[60:63]
    v_mfma_f32_16x16x32_bf16 v[64:67], a[252:255], a[100:103], v[64:67]
    s_waitcnt lgkmcnt(3)
    ds_read_b128 a[252:255], v2 offset:31744
    v_mfma_f32_16x16x32_bf16 v[44:47], a[240:243], a[8:11], v[44:47]
    v_mfma_f32_16x16x32_bf16 v[48:51], a[240:243], a[56:59], v[48:51]
    v_mfma_f32_16x16x32_bf16 v[52:55], a[240:243], a[104:107], v[52:55]
    s_waitcnt lgkmcnt(3)
    ds_read_b128 a[240:243], v2 offset:32768
    v_mfma_f32_16x16x32_bf16 v[56:59], a[244:247], a[8:11], v[56:59]
    v_mfma_f32_16x16x32_bf16 v[60:63], a[244:247], a[56:59], v[60:63]
    v_mfma_f32_16x16x32_bf16 v[64:67], a[244:247], a[104:107], v[64:67]
    s_waitcnt lgkmcnt(3)
    ds_read_b128 a[244:247], v2 offset:33792
    v_mfma_f32_16x16x32_bf16 v[44:47], a[248:251], a[12:15], v[44:47]
    v_mfma_f32_16x16x32_bf16 v[48:51], a[248:251], a[60:63], v[48:51]
    v_mfma_f32_16x16x32_bf16 v[52:55], a[248:251], a[108:111], v[52:55]
    s_waitcnt lgkmcnt(2)
    ds_read_b128 a[248:251], v2 offset:34816
    v_mfma_f32_16x16x32_bf16 v[56:59], a[252:255], a[12:15], v[56:59]
    v_mfma_f32_16x16x32_bf16 v[60:63], a[252:255], a[60:63], v[60:63]
    v_mfma_f32_16x16x32_bf16 v[64:67], a[252:255], a[108:111], v[64:67]
    s_waitcnt lgkmcnt(2)
    ds_read_b128 a[252:255], v2 offset:35840
    v_mfma_f32_16x16x32_bf16 v[44:47], a[240:243], a[16:19], v[44:47]
    v_mfma_f32_16x16x32_bf16 v[48:51], a[240:243], a[64:67], v[48:51]
    v_mfma_f32_16x16x32_bf16 v[52:55], a[240:243], a[112:115], v[52:55]
    s_waitcnt lgkmcnt(2)
    ds_read_b128 a[240:243], v2 offset:36864
    v_mfma_f32_16x16x32_bf16 v[56:59], a[244:247], a[16:19], v[56:59]
    v_mfma_f32_16x16x32_bf16 v[60:63], a[244:247], a[64:67], v[60:63]
    v_mfma_f32_16x16x32_bf16 v[64:67], a[244:247], a[112:115], v[64:67]
    s_waitcnt lgkmcnt(2)
    ds_read_b128 a[244:247], v2 offset:37888
    v_mfma_f32_16x16x32_bf16 v[44:47], a[248:251], a[20:23], v[44:47]
    v_mfma_f32_16x16x32_bf16 v[48:51], a[248:251], a[68:71], v[48:51]
    v_mfma_f32_16x16x32_bf16 v[52:55], a[248:251], a[116:119], v[52:55]
    s_waitcnt lgkmcnt(2)
    ds_read_b128 a[248:251], v2 offset:38912
    v_mfma_f32_16x16x32_bf16 v[56:59], a[252:255], a[20:23], v[56:59]
    v_mfma_f32_16x16x32_bf16 v[60:63], a[252:255], a[68:71], v[60:63]
    v_mfma_f32_16x16x32_bf16 v[64:67], a[252:255], a[116:119], v[64:67]
    s_waitcnt lgkmcnt(2)
    ds_read_b128 a[252:255], v2 offset:39936
    v_mfma_f32_16x16x32_bf16 v[44:47], a[240:243], a[24:27], v[44:47]
    v_mfma_f32_16x16x32_bf16 v[48:51], a[240:243], a[72:75], v[48:51]
    v_mfma_f32_16x16x32_bf16 v[52:55], a[240:243], a[120:123], v[52:55]
    s_waitcnt lgkmcnt(2)
    ds_read_b128 a[240:243], v2 offset:40960
    v_mfma_f32_16x16x32_bf16 v[56:59], a[244:247], a[24:27], v[56:59]
    v_mfma_f32_16x16x32_bf16 v[60:63], a[244:247], a[72:75], v[60:63]
    v_mfma_f32_16x16x32_bf16 v[64:67], a[244:247], a[120:123], v[64:67]
    s_waitcnt lgkmcnt(2)
    ds_read_b128 a[244:247], v2 offset:41984
    v_mfma_f32_16x16x32_bf16 v[44:47], a[248:251], a[28:31], v[44:47]
    v_mfma_f32_16x16x32_bf16 v[48:51], a[248:251], a[76:79], v[48:51]
    v_mfma_f32_16x16x32_bf16 v[52:55], a[248:251], a[124:127], v[52:55]
    s_waitcnt lgkmcnt(2)
    ds_read_b128 a[248:251], v2 offset:43008
    v_mfma_f32_16x16x32_bf16 v[56:59], a[252:255], a[28:31], v[56:59]
    v_mfma_f32_16x16x32_bf16 v[60:63], a[252:255], a[76:79], v[60:63]
    v_mfma_f32_16x16x32_bf16 v[64:67], a[252:255], a[124:127], v[64:67]
    s_waitcnt lgkmcnt(2)
    ds_read_b128 a[252:255], v2 offset:44032
    v_mfma_f32_16x16x32_bf16 v[44:47], a[240:243], a[32:35], v[44:47]
    v_mfma_f32_16x16x32_bf16 v[48:51], a[240:243], a[80:83], v[48:51]
    v_mfma_f32_16x16x32_bf16 v[52:55], a[240:243], a[128:131], v[52:55]
    s_waitcnt lgkmcnt(2)
    ds_read_b128 a[240:243], v2 offset:45056
    v_mfma_f32_16x16x32_bf16 v[56:59], a[244:247], a[32:35], v[56:59]
    v_mfma_f32_16x16x32_bf16 v[60:63], a[244:247], a[80:83], v[60:63]
    v_mfma_f32_16x16x32_bf16 v[64:67], a[244:247], a[128:131], v[64:67]
    s_waitcnt lgkmcnt(2)
    ds_read_b128 a[244:247], v2 offset:46080
    v_mfma_f32_16x16x32_bf16 v[44:47], a[248:251], a[36:39], v[44:47]
    v_mfma_f32_16x16x32_bf16 v[48:51], a[248:251], a[84:87], v[48:51]
    v_mfma_f32_16x16x32_bf16 v[52:55], a[248:251], a[132:135], v[52:55]
    s_waitcnt lgkmcnt(2)
    ds_read_b128 a[248:251], v2 offset:47104
    v_mfma_f32_16x16x32_bf16 v[56:59], a[252:255], a[36:39], v[56:59]
    v_mfma_f32_16x16x32_bf16 v[60:63], a[252:255], a[84:87], v[60:63]
    v_mfma_f32_16x16x32_bf16 v[64:67], a[252:255], a[132:135], v[64:67]
    s_waitcnt lgkmcnt(2)
    ds_read_b128 a[252:255], v2 offset:48128
    v_mfma_f32_16x16x32_bf16 v[44:47], a[240:243], a[40:43], v[44:47]
    v_mfma_f32_16x16x32_bf16 v[48:51], a[240:243], a[88:91], v[48:51]
    v_mfma_f32_16x16x32_bf16 v[52:55], a[240:243], a[136:139], v[52:55]
    s_waitcnt lgkmcnt(2)
    v_mfma_f32_16x16x32_bf16 v[56:59], a[244:247], a[40:43], v[56:59]
    v_mfma_f32_16x16x32_bf16 v[60:63], a[244:247], a[88:91], v[60:63]
    v_mfma_f32_16x16x32_bf16 v[64:67], a[244:247], a[136:139], v[64:67]
    s_waitcnt lgkmcnt(1)
    v_mfma_f32_16x16x32_bf16 v[44:47], a[248:251], a[44:47], v[44:47]
    v_mfma_f32_16x16x32_bf16 v[48:51], a[248:251], a[92:95], v[48:51]
    v_mfma_f32_16x16x32_bf16 v[52:55], a[248:251], a[140:143], v[52:55]
    s_waitcnt vmcnt(5) lgkmcnt(0)
    s_barrier
    ds_read_b128 a[240:243], v1 offset:0
    v_mfma_f32_16x16x32_bf16 v[56:59], a[252:255], a[44:47], v[56:59]
    ds_read_b128 a[244:247], v1 offset:1024
    v_mfma_f32_16x16x32_bf16 v[60:63], a[252:255], a[92:95], v[60:63]
    s_add_u32 s45, s29, 147456
    s_add_u32 m0, s29, 49152
    ds_read_b128 a[248:251], v1 offset:2048
    v_mfma_f32_16x16x32_bf16 v[64:67], a[252:255], a[140:143], v[64:67]
    buffer_load_dwordx4 v1, s[20:23], s45 offen offset:0 sc1 lds
    v_mfma_f32_16x16x32_bf16 v[148:151], a[8:11], v[68:71], v[148:151]
    v_mfma_f32_16x16x32_bf16 v[152:155], a[56:59], v[68:71], v[152:155]
    v_mfma_f32_16x16x32_bf16 v[156:159], a[104:107], v[68:71], v[156:159]
    v_mfma_f32_16x16x32_bf16 v[160:163], v[240:243], v[68:71], v[160:163]
    buffer_load_dwordx4 v1, s[20:23], s45 offen offset:1024 sc1 lds
    v_mfma_f32_16x16x32_bf16 v[164:167], a[8:11], v[76:79], v[164:167]
    v_mfma_f32_16x16x32_bf16 v[168:171], a[56:59], v[76:79], v[168:171]
    v_mfma_f32_16x16x32_bf16 v[172:175], a[104:107], v[76:79], v[172:175]
    v_mfma_f32_16x16x32_bf16 v[176:179], v[240:243], v[76:79], v[176:179]
    buffer_load_dwordx4 v1, s[20:23], s45 offen offset:2048 sc1 lds
    v_mfma_f32_16x16x32_bf16 v[180:183], a[8:11], v[84:87], v[180:183]
    v_mfma_f32_16x16x32_bf16 v[184:187], a[56:59], v[84:87], v[184:187]
    v_mfma_f32_16x16x32_bf16 v[188:191], a[104:107], v[84:87], v[188:191]
    v_mfma_f32_16x16x32_bf16 v[192:195], v[240:243], v[84:87], v[192:195]
    s_waitcnt lgkmcnt(2)
    buffer_load_dwordx4 v1, s[20:23], s45 offen offset:3072 sc1 lds
    v_mfma_f32_16x16x32_bf16 v[20:23], a[240:243], a[0:3], 0
    s_add_u32 s45, s29, 151552
    s_add_u32 m0, s29, 53248
    ds_read_b128 a[252:255], v1 offset:3072
    v_mfma_f32_16x16x32_bf16 v[24:27], a[240:243], a[48:51], 0
    v_cvt_pk_bf16_f32 v68, v44, v45
    v_cvt_pk_bf16_f32 v69, v46, v47
    v_mfma_f32_16x16x32_bf16 v[28:31], a[240:243], a[96:99], 0
    s_waitcnt lgkmcnt(2)
    ds_read_b128 a[240:243], v1 offset:4096
    v_cvt_pk_bf16_f32 v70, v56, v57
    v_mfma_f32_16x16x32_bf16 v[32:35], a[244:247], a[0:3], 0
    buffer_load_dwordx4 v1, s[20:23], s45 offen offset:0 sc1 lds
    v_mfma_f32_16x16x32_bf16 v[36:39], a[244:247], a[48:51], 0
    v_cvt_pk_bf16_f32 v71, v58, v59
    v_cvt_pk_bf16_f32 v76, v48, v49
    v_mfma_f32_16x16x32_bf16 v[40:43], a[244:247], a[96:99], 0
    s_waitcnt lgkmcnt(2)
    ds_read_b128 a[244:247], v1 offset:5120
    v_cvt_pk_bf16_f32 v77, v50, v51
    v_mfma_f32_16x16x32_bf16 v[20:23], a[248:251], a[4:7], v[20:23]
    v_cvt_pk_bf16_f32 v78, v60, v61
    v_cvt_pk_bf16_f32 v79, v62, v63
    v_mfma_f32_16x16x32_bf16 v[24:27], a[248:251], a[52:55], v[24:27]
    buffer_load_dwordx4 v1, s[20:23], s45 offen offset:1024 sc1 lds
    s_add_u32 s45, s29, 172032
    v_mfma_f32_16x16x32_bf16 v[28:31], a[248:251], a[100:103], v[28:31]
    s_waitcnt lgkmcnt(2)
    s_add_u32 m0, s29, 73728
    ds_read_b128 a[248:251], v1 offset:6144
    v_mfma_f32_16x16x32_bf16 v[32:35], a[252:255], a[4:7], v[32:35]
    ds_read_b128 v[244:247], v4 offset:192
    v_cvt_pk_bf16_f32 v84, v52, v53
    v_mfma_f32_16x16x32_bf16 v[36:39], a[252:255], a[52:55], v[36:39]
    v_cvt_pk_bf16_f32 v85, v54, v55
    v_cvt_pk_bf16_f32 v86, v64, v65
    v_mfma_f32_16x16x32_bf16 v[40:43], a[252:255], a[100:103], v[40:43]
    s_waitcnt lgkmcnt(3)
    ds_read_b128 a[252:255], v1 offset:7168
    v_cvt_pk_bf16_f32 v87, v66, v67
    v_mfma_f32_16x16x32_bf16 v[20:23], a[240:243], a[8:11], v[20:23]
    buffer_load_dwordx4 v1, s[20:23], s45 offen offset:0 sc1 lds
    v_mfma_f32_16x16x32_bf16 v[24:27], a[240:243], a[56:59], v[24:27]
    v_mfma_f32_16x16x32_bf16 v[28:31], a[240:243], a[104:107], v[28:31]
    s_waitcnt lgkmcnt(3)
    ds_read_b128 a[240:243], v1 offset:8192
    v_mfma_f32_16x16x32_bf16 v[32:35], a[244:247], a[8:11], v[32:35]
    v_mfma_f32_16x16x32_bf16 v[36:39], a[244:247], a[56:59], v[36:39]
    buffer_load_dwordx4 v1, s[20:23], s45 offen offset:1024 sc1 lds
    v_mfma_f32_16x16x32_bf16 v[40:43], a[244:247], a[104:107], v[40:43]
    s_waitcnt lgkmcnt(3)
    ds_read_b128 a[244:247], v1 offset:9216
    v_mfma_f32_16x16x32_bf16 v[20:23], a[248:251], a[12:15], v[20:23]
    v_mfma_f32_16x16x32_bf16 v[24:27], a[248:251], a[60:63], v[24:27]
    v_mfma_f32_16x16x32_bf16 v[28:31], a[248:251], a[108:111], v[28:31]
    s_waitcnt lgkmcnt(2)
    ds_read_b128 a[248:251], v1 offset:10240
    v_mfma_f32_16x16x32_bf16 v[32:35], a[252:255], a[12:15], v[32:35]
    buffer_load_dwordx4 v1, s[20:23], s45 offen offset:2048 sc1 lds
    v_mfma_f32_16x16x32_bf16 v[36:39], a[252:255], a[60:63], v[36:39]
    v_mfma_f32_16x16x32_bf16 v[40:43], a[252:255], a[108:111], v[40:43]
    s_waitcnt lgkmcnt(2)
    ds_read_b128 a[252:255], v1 offset:11264
    v_mfma_f32_16x16x32_bf16 v[20:23], a[240:243], a[16:19], v[20:23]
    v_mfma_f32_16x16x32_bf16 v[24:27], a[240:243], a[64:67], v[24:27]
    buffer_load_dwordx4 v1, s[20:23], s45 offen offset:3072 sc1 lds
    s_add_u32 s45, s29, 176128
    v_mfma_f32_16x16x32_bf16 v[28:31], a[240:243], a[112:115], v[28:31]
    s_waitcnt lgkmcnt(2)
    s_add_u32 m0, s29, 77824
    ds_read_b128 a[240:243], v1 offset:12288
    v_mfma_f32_16x16x32_bf16 v[32:35], a[244:247], a[16:19], v[32:35]
    v_mfma_f32_16x16x32_bf16 v[36:39], a[244:247], a[64:67], v[36:39]
    v_mfma_f32_16x16x32_bf16 v[40:43], a[244:247], a[112:115], v[40:43]
    s_waitcnt lgkmcnt(2)
    ds_read_b128 a[244:247], v1 offset:13312
    v_mfma_f32_16x16x32_bf16 v[20:23], a[248:251], a[20:23], v[20:23]
    buffer_load_dwordx4 v1, s[20:23], s45 offen offset:0 sc1 lds
    v_mfma_f32_16x16x32_bf16 v[24:27], a[248:251], a[68:71], v[24:27]
    v_mfma_f32_16x16x32_bf16 v[28:31], a[248:251], a[116:119], v[28:31]
    s_waitcnt lgkmcnt(2)
    ds_read_b128 a[248:251], v1 offset:14336
    v_mfma_f32_16x16x32_bf16 v[32:35], a[252:255], a[20:23], v[32:35]
    v_mfma_f32_16x16x32_bf16 v[36:39], a[252:255], a[68:71], v[36:39]
    buffer_load_dwordx4 v1, s[20:23], s45 offen offset:1024 sc1 lds
    s_add_u32 m0, s31, 4352
    v_mfma_f32_16x16x32_bf16 v[40:43], a[252:255], a[116:119], v[40:43]
    s_waitcnt lgkmcnt(2)
    ds_read_b128 a[252:255], v1 offset:15360
    v_mfma_f32_16x16x32_bf16 v[20:23], a[240:243], a[24:27], v[20:23]
    v_mfma_f32_16x16x32_bf16 v[24:27], a[240:243], a[72:75], v[24:27]
    v_mfma_f32_16x16x32_bf16 v[28:31], a[240:243], a[120:123], v[28:31]
    s_waitcnt lgkmcnt(2)
    ds_read_b128 a[240:243], v1 offset:16384
    v_mfma_f32_16x16x32_bf16 v[32:35], a[244:247], a[24:27], v[32:35]
    buffer_load_dwordx4 v11, s[16:19], s33 offen offset:0 nt lds
    s_add_u32 m0, s31, 5440
    v_mfma_f32_16x16x32_bf16 v[36:39], a[244:247], a[72:75], v[36:39]
    v_mfma_f32_16x16x32_bf16 v[40:43], a[244:247], a[120:123], v[40:43]
    s_waitcnt lgkmcnt(2)
    ds_read_b128 a[244:247], v1 offset:17408
    v_mfma_f32_16x16x32_bf16 v[20:23], a[248:251], a[28:31], v[20:23]
    v_mfma_f32_16x16x32_bf16 v[24:27], a[248:251], a[76:79], v[24:27]
    buffer_load_dwordx4 v12, s[16:19], s33 offen offset:0 nt lds
    s_add_u32 m0, s31, 6528
    v_mfma_f32_16x16x32_bf16 v[28:31], a[248:251], a[124:127], v[28:31]
    s_waitcnt lgkmcnt(2)
    ds_read_b128 a[248:251], v1 offset:18432
    v_mfma_f32_16x16x32_bf16 v[32:35], a[252:255], a[28:31], v[32:35]
    v_mfma_f32_16x16x32_bf16 v[36:39], a[252:255], a[76:79], v[36:39]
    v_mfma_f32_16x16x32_bf16 v[40:43], a[252:255], a[124:127], v[40:43]
    s_waitcnt lgkmcnt(2)
    ds_read_b128 a[252:255], v1 offset:19456
    v_mfma_f32_16x16x32_bf16 v[20:23], a[240:243], a[32:35], v[20:23]
    buffer_load_dwordx4 v13, s[16:19], s33 offen offset:0 nt lds
    s_add_u32 m0, s31, 7616
    v_mfma_f32_16x16x32_bf16 v[24:27], a[240:243], a[80:83], v[24:27]
    v_mfma_f32_16x16x32_bf16 v[28:31], a[240:243], a[128:131], v[28:31]
    s_waitcnt lgkmcnt(2)
    ds_read_b128 a[240:243], v1 offset:20480
    v_mfma_f32_16x16x32_bf16 v[32:35], a[244:247], a[32:35], v[32:35]
    v_mfma_f32_16x16x32_bf16 v[36:39], a[244:247], a[80:83], v[36:39]
    buffer_load_dwordx4 v14, s[16:19], s33 offen offset:0 nt lds
    v_mfma_f32_16x16x32_bf16 v[40:43], a[244:247], a[128:131], v[40:43]
    s_waitcnt lgkmcnt(2)
    ds_read_b128 a[244:247], v1 offset:21504
    v_mfma_f32_16x16x32_bf16 v[20:23], a[248:251], a[36:39], v[20:23]
    v_mfma_f32_16x16x32_bf16 v[24:27], a[248:251], a[84:87], v[24:27]
    v_mfma_f32_16x16x32_bf16 v[28:31], a[248:251], a[132:135], v[28:31]
    s_waitcnt lgkmcnt(2)
    ds_read_b128 a[248:251], v1 offset:22528
    v_mfma_f32_16x16x32_bf16 v[32:35], a[252:255], a[36:39], v[32:35]
    v_mfma_f32_16x16x32_bf16 v[36:39], a[252:255], a[84:87], v[36:39]
    v_mfma_f32_16x16x32_bf16 v[40:43], a[252:255], a[132:135], v[40:43]
    s_waitcnt lgkmcnt(2)
    ds_read_b128 a[252:255], v1 offset:23552
    v_mfma_f32_16x16x32_bf16 v[20:23], a[240:243], a[40:43], v[20:23]
    v_mfma_f32_16x16x32_bf16 v[24:27], a[240:243], a[88:91], v[24:27]
    v_mfma_f32_16x16x32_bf16 v[28:31], a[240:243], a[136:139], v[28:31]
    s_waitcnt lgkmcnt(2)
    ds_read_b128 a[240:243], v1 offset:24576
    v_mfma_f32_16x16x32_bf16 v[32:35], a[244:247], a[40:43], v[32:35]
    v_mfma_f32_16x16x32_bf16 v[36:39], a[244:247], a[88:91], v[36:39]
    v_mfma_f32_16x16x32_bf16 v[40:43], a[244:247], a[136:139], v[40:43]
    s_waitcnt lgkmcnt(2)
    ds_read_b128 a[244:247], v1 offset:25600
    v_mfma_f32_16x16x32_bf16 v[20:23], a[248:251], a[44:47], v[20:23]
    v_mfma_f32_16x16x32_bf16 v[24:27], a[248:251], a[92:95], v[24:27]
    v_mfma_f32_16x16x32_bf16 v[28:31], a[248:251], a[140:143], v[28:31]
    s_waitcnt lgkmcnt(2)
    ds_read_b128 a[248:251], v1 offset:26624
    v_mfma_f32_16x16x32_bf16 v[32:35], a[252:255], a[44:47], v[32:35]
    v_mfma_f32_16x16x32_bf16 v[36:39], a[252:255], a[92:95], v[36:39]
    s_add_u32 m0, s31, 8704
    v_mfma_f32_16x16x32_bf16 v[40:43], a[252:255], a[140:143], v[40:43]
    buffer_load_dwordx4 v15, s[16:19], s33 offen offset:0 nt lds
    s_add_u32 m0, s31, 9792
    v_mfma_f32_16x16x32_bf16 v[148:151], a[12:15], v[68:71], v[148:151]
    v_mfma_f32_16x16x32_bf16 v[152:155], a[60:63], v[68:71], v[152:155]
    v_mfma_f32_16x16x32_bf16 v[156:159], a[108:111], v[68:71], v[156:159]
    v_mfma_f32_16x16x32_bf16 v[160:163], v[244:247], v[68:71], v[160:163]
    buffer_load_dwordx4 v16, s[16:19], s33 offen offset:0 nt lds
    s_add_u32 m0, s31, 10880
    v_mfma_f32_16x16x32_bf16 v[164:167], a[12:15], v[76:79], v[164:167]
    v_mfma_f32_16x16x32_bf16 v[168:171], a[60:63], v[76:79], v[168:171]
    v_mfma_f32_16x16x32_bf16 v[172:175], a[108:111], v[76:79], v[172:175]
    v_mfma_f32_16x16x32_bf16 v[176:179], v[244:247], v[76:79], v[176:179]
    buffer_load_dwordx4 v17, s[16:19], s33 offen offset:0 nt lds
    s_add_u32 m0, s31, 11968
    v_mfma_f32_16x16x32_bf16 v[180:183], a[12:15], v[84:87], v[180:183]
    v_mfma_f32_16x16x32_bf16 v[184:187], a[60:63], v[84:87], v[184:187]
    v_mfma_f32_16x16x32_bf16 v[188:191], a[108:111], v[84:87], v[188:191]
    v_mfma_f32_16x16x32_bf16 v[192:195], v[244:247], v[84:87], v[192:195]
    s_waitcnt lgkmcnt(2)
    buffer_load_dwordx4 v18, s[16:19], s33 offen offset:0 nt lds
    v_mfma_f32_16x16x32_bf16 v[44:47], a[240:243], a[0:3], 0
    ds_read_b128 a[252:255], v1 offset:27648
    v_mfma_f32_16x16x32_bf16 v[48:51], a[240:243], a[48:51], 0
    v_cvt_pk_bf16_f32 v68, v20, v21
    v_cvt_pk_bf16_f32 v69, v22, v23
    v_mfma_f32_16x16x32_bf16 v[52:55], a[240:243], a[96:99], 0
    s_waitcnt lgkmcnt(2)
    ds_read_b128 a[240:243], v1 offset:28672
    v_cvt_pk_bf16_f32 v70, v32, v33
    v_mfma_f32_16x16x32_bf16 v[56:59], a[244:247], a[0:3], 0
    v_cvt_pk_bf16_f32 v71, v34, v35
    v_cvt_pk_bf16_f32 v76, v24, v25
    v_mfma_f32_16x16x32_bf16 v[60:63], a[244:247], a[48:51], 0
    v_cvt_pk_bf16_f32 v77, v26, v27
    v_cvt_pk_bf16_f32 v78, v36, v37
    v_mfma_f32_16x16x32_bf16 v[64:67], a[244:247], a[96:99], 0
    s_waitcnt lgkmcnt(2)
    ds_read_b128 a[244:247], v1 offset:29696
    v_cvt_pk_bf16_f32 v79, v38, v39
    v_mfma_f32_16x16x32_bf16 v[44:47], a[248:251], a[4:7], v[44:47]
    v_cvt_pk_bf16_f32 v84, v28, v29
    v_cvt_pk_bf16_f32 v85, v30, v31
    v_mfma_f32_16x16x32_bf16 v[48:51], a[248:251], a[52:55], v[48:51]
    v_cvt_pk_bf16_f32 v86, v40, v41
    v_cvt_pk_bf16_f32 v87, v42, v43
    v_mfma_f32_16x16x32_bf16 v[52:55], a[248:251], a[100:103], v[52:55]
    s_waitcnt lgkmcnt(2)
    ds_read_b128 a[248:251], v1 offset:30720
    v_mfma_f32_16x16x32_bf16 v[56:59], a[252:255], a[4:7], v[56:59]
    ds_read_b128 v[232:235], v4 offset:256
    v_mfma_f32_16x16x32_bf16 v[60:63], a[252:255], a[52:55], v[60:63]
    v_mfma_f32_16x16x32_bf16 v[64:67], a[252:255], a[100:103], v[64:67]
    s_waitcnt lgkmcnt(3)
    ds_read_b128 a[252:255], v1 offset:31744
    v_mfma_f32_16x16x32_bf16 v[44:47], a[240:243], a[8:11], v[44:47]
    v_mfma_f32_16x16x32_bf16 v[48:51], a[240:243], a[56:59], v[48:51]
    v_mfma_f32_16x16x32_bf16 v[52:55], a[240:243], a[104:107], v[52:55]
    s_waitcnt lgkmcnt(3)
    ds_read_b128 a[240:243], v1 offset:32768
    v_mfma_f32_16x16x32_bf16 v[56:59], a[244:247], a[8:11], v[56:59]
    v_mfma_f32_16x16x32_bf16 v[60:63], a[244:247], a[56:59], v[60:63]
    v_mfma_f32_16x16x32_bf16 v[64:67], a[244:247], a[104:107], v[64:67]
    s_waitcnt lgkmcnt(3)
    ds_read_b128 a[244:247], v1 offset:33792
    v_mfma_f32_16x16x32_bf16 v[44:47], a[248:251], a[12:15], v[44:47]
    v_mfma_f32_16x16x32_bf16 v[48:51], a[248:251], a[60:63], v[48:51]
    v_mfma_f32_16x16x32_bf16 v[52:55], a[248:251], a[108:111], v[52:55]
    s_waitcnt lgkmcnt(2)
    ds_read_b128 a[248:251], v1 offset:34816
    v_mfma_f32_16x16x32_bf16 v[56:59], a[252:255], a[12:15], v[56:59]
    v_mfma_f32_16x16x32_bf16 v[60:63], a[252:255], a[60:63], v[60:63]
    v_mfma_f32_16x16x32_bf16 v[64:67], a[252:255], a[108:111], v[64:67]
    s_waitcnt lgkmcnt(2)
    ds_read_b128 a[252:255], v1 offset:35840
    v_mfma_f32_16x16x32_bf16 v[44:47], a[240:243], a[16:19], v[44:47]
    v_mfma_f32_16x16x32_bf16 v[48:51], a[240:243], a[64:67], v[48:51]
    v_mfma_f32_16x16x32_bf16 v[52:55], a[240:243], a[112:115], v[52:55]
    s_waitcnt lgkmcnt(2)
    ds_read_b128 a[240:243], v1 offset:36864
    v_mfma_f32_16x16x32_bf16 v[56:59], a[244:247], a[16:19], v[56:59]
    v_mfma_f32_16x16x32_bf16 v[60:63], a[244:247], a[64:67], v[60:63]
    v_mfma_f32_16x16x32_bf16 v[64:67], a[244:247], a[112:115], v[64:67]
    s_waitcnt lgkmcnt(2)
    ds_read_b128 a[244:247], v1 offset:37888
    v_mfma_f32_16x16x32_bf16 v[44:47], a[248:251], a[20:23], v[44:47]
    v_mfma_f32_16x16x32_bf16 v[48:51], a[248:251], a[68:71], v[48:51]
    v_mfma_f32_16x16x32_bf16 v[52:55], a[248:251], a[116:119], v[52:55]
    s_waitcnt lgkmcnt(2)
    ds_read_b128 a[248:251], v1 offset:38912
    v_mfma_f32_16x16x32_bf16 v[56:59], a[252:255], a[20:23], v[56:59]
    v_mfma_f32_16x16x32_bf16 v[60:63], a[252:255], a[68:71], v[60:63]
    v_mfma_f32_16x16x32_bf16 v[64:67], a[252:255], a[116:119], v[64:67]
    s_waitcnt lgkmcnt(2)
    ds_read_b128 a[252:255], v1 offset:39936
    v_mfma_f32_16x16x32_bf16 v[44:47], a[240:243], a[24:27], v[44:47]
    v_mfma_f32_16x16x32_bf16 v[48:51], a[240:243], a[72:75], v[48:51]
    v_mfma_f32_16x16x32_bf16 v[52:55], a[240:243], a[120:123], v[52:55]
    s_waitcnt lgkmcnt(2)
    ds_read_b128 a[240:243], v1 offset:40960
    v_mfma_f32_16x16x32_bf16 v[56:59], a[244:247], a[24:27], v[56:59]
    v_mfma_f32_16x16x32_bf16 v[60:63], a[244:247], a[72:75], v[60:63]
    v_mfma_f32_16x16x32_bf16 v[64:67], a[244:247], a[120:123], v[64:67]
    s_waitcnt lgkmcnt(2)
    ds_read_b128 a[244:247], v1 offset:41984
    v_mfma_f32_16x16x32_bf16 v[44:47], a[248:251], a[28:31], v[44:47]
    v_mfma_f32_16x16x32_bf16 v[48:51], a[248:251], a[76:79], v[48:51]
    v_mfma_f32_16x16x32_bf16 v[52:55], a[248:251], a[124:127], v[52:55]
    s_waitcnt lgkmcnt(2)
    ds_read_b128 a[248:251], v1 offset:43008
    v_mfma_f32_16x16x32_bf16 v[56:59], a[252:255], a[28:31], v[56:59]
    v_mfma_f32_16x16x32_bf16 v[60:63], a[252:255], a[76:79], v[60:63]
    v_mfma_f32_16x16x32_bf16 v[64:67], a[252:255], a[124:127], v[64:67]
    s_waitcnt lgkmcnt(2)
    ds_read_b128 a[252:255], v1 offset:44032
    v_mfma_f32_16x16x32_bf16 v[44:47], a[240:243], a[32:35], v[44:47]
    v_mfma_f32_16x16x32_bf16 v[48:51], a[240:243], a[80:83], v[48:51]
    v_mfma_f32_16x16x32_bf16 v[52:55], a[240:243], a[128:131], v[52:55]
    s_waitcnt lgkmcnt(2)
    ds_read_b128 a[240:243], v1 offset:45056
    v_mfma_f32_16x16x32_bf16 v[56:59], a[244:247], a[32:35], v[56:59]
    v_mfma_f32_16x16x32_bf16 v[60:63], a[244:247], a[80:83], v[60:63]
    v_mfma_f32_16x16x32_bf16 v[64:67], a[244:247], a[128:131], v[64:67]
    s_waitcnt lgkmcnt(2)
    ds_read_b128 a[244:247], v1 offset:46080
    v_mfma_f32_16x16x32_bf16 v[44:47], a[248:251], a[36:39], v[44:47]
    v_mfma_f32_16x16x32_bf16 v[48:51], a[248:251], a[84:87], v[48:51]
    v_mfma_f32_16x16x32_bf16 v[52:55], a[248:251], a[132:135], v[52:55]
    s_waitcnt lgkmcnt(2)
    ds_read_b128 a[248:251], v1 offset:47104
    v_mfma_f32_16x16x32_bf16 v[56:59], a[252:255], a[36:39], v[56:59]
    v_mfma_f32_16x16x32_bf16 v[60:63], a[252:255], a[84:87], v[60:63]
    v_mfma_f32_16x16x32_bf16 v[64:67], a[252:255], a[132:135], v[64:67]
    s_waitcnt lgkmcnt(2)
    ds_read_b128 a[252:255], v1 offset:48128
    v_mfma_f32_16x16x32_bf16 v[44:47], a[240:243], a[40:43], v[44:47]
    v_mfma_f32_16x16x32_bf16 v[48:51], a[240:243], a[88:91], v[48:51]
    v_mfma_f32_16x16x32_bf16 v[52:55], a[240:243], a[136:139], v[52:55]
    s_waitcnt lgkmcnt(2)
    v_mfma_f32_16x16x32_bf16 v[56:59], a[244:247], a[40:43], v[56:59]
    v_mfma_f32_16x16x32_bf16 v[60:63], a[244:247], a[88:91], v[60:63]
    v_mfma_f32_16x16x32_bf16 v[64:67], a[244:247], a[136:139], v[64:67]
    s_waitcnt lgkmcnt(1)
    v_mfma_f32_16x16x32_bf16 v[44:47], a[248:251], a[44:47], v[44:47]
    v_mfma_f32_16x16x32_bf16 v[48:51], a[248:251], a[92:95], v[48:51]
    v_mfma_f32_16x16x32_bf16 v[52:55], a[248:251], a[140:143], v[52:55]
    s_waitcnt vmcnt(8) lgkmcnt(0)
    s_barrier
    ds_read_b128 a[240:243], v2 offset:0
    v_mfma_f32_16x16x32_bf16 v[56:59], a[252:255], a[44:47], v[56:59]
    ds_read_b128 a[244:247], v2 offset:1024
    v_mfma_f32_16x16x32_bf16 v[60:63], a[252:255], a[92:95], v[60:63]
    s_add_u32 s45, s29, 196608
    s_add_u32 m0, s29, 0
    ds_read_b128 a[248:251], v2 offset:2048
    v_mfma_f32_16x16x32_bf16 v[64:67], a[252:255], a[140:143], v[64:67]
    buffer_load_dwordx4 v1, s[20:23], s45 offen offset:0 sc1 lds
    v_mfma_f32_16x16x32_bf16 v[148:151], a[16:19], v[68:71], v[148:151]
    v_mfma_f32_16x16x32_bf16 v[152:155], a[64:67], v[68:71], v[152:155]
    v_mfma_f32_16x16x32_bf16 v[156:159], a[112:115], v[68:71], v[156:159]
    v_mfma_f32_16x16x32_bf16 v[160:163], v[232:235], v[68:71], v[160:163]
    buffer_load_dwordx4 v1, s[20:23], s45 offen offset:1024 sc1 lds
    v_mfma_f32_16x16x32_bf16 v[164:167], a[16:19], v[76:79], v[164:167]
    v_mfma_f32_16x16x32_bf16 v[168:171], a[64:67], v[76:79], v[168:171]
    v_mfma_f32_16x16x32_bf16 v[172:175], a[112:115], v[76:79], v[172:175]
    v_mfma_f32_16x16x32_bf16 v[176:179], v[232:235], v[76:79], v[176:179]
    buffer_load_dwordx4 v1, s[20:23], s45 offen offset:2048 sc1 lds
    v_mfma_f32_16x16x32_bf16 v[180:183], a[16:19], v[84:87], v[180:183]
    v_mfma_f32_16x16x32_bf16 v[184:187], a[64:67], v[84:87], v[184:187]
    v_mfma_f32_16x16x32_bf16 v[188:191], a[112:115], v[84:87], v[188:191]
    v_mfma_f32_16x16x32_bf16 v[192:195], v[232:235], v[84:87], v[192:195]
    s_waitcnt lgkmcnt(2)
    buffer_load_dwordx4 v1, s[20:23], s45 offen offset:3072 sc1 lds
    v_mfma_f32_16x16x32_bf16 v[20:23], a[240:243], a[0:3], 0
    s_add_u32 s45, s29, 200704
    s_add_u32 m0, s29, 4096
    ds_read_b128 a[252:255], v2 offset:3072
    v_mfma_f32_16x16x32_bf16 v[24:27], a[240:243], a[48:51], 0
    v_cvt_pk_bf16_f32 v68, v44, v45
    v_cvt_pk_bf16_f32 v69, v46, v47
    v_mfma_f32_16x16x32_bf16 v[28:31], a[240:243], a[96:99], 0
    s_waitcnt lgkmcnt(2)
    ds_read_b128 a[240:243], v2 offset:4096
    v_cvt_pk_bf16_f32 v70, v56, v57
    v_mfma_f32_16x16x32_bf16 v[32:35], a[244:247], a[0:3], 0
    buffer_load_dwordx4 v1, s[20:23], s45 offen offset:0 sc1 lds
    v_mfma_f32_16x16x32_bf16 v[36:39], a[244:247], a[48:51], 0
    v_cvt_pk_bf16_f32 v71, v58, v59
    v_cvt_pk_bf16_f32 v76, v48, v49
    v_mfma_f32_16x16x32_bf16 v[40:43], a[244:247], a[96:99], 0
    s_waitcnt lgkmcnt(2)
    ds_read_b128 a[244:247], v2 offset:5120
    v_cvt_pk_bf16_f32 v77, v50, v51
    v_mfma_f32_16x16x32_bf16 v[20:23], a[248:251], a[4:7], v[20:23]
    v_cvt_pk_bf16_f32 v78, v60, v61
    v_cvt_pk_bf16_f32 v79, v62, v63
    v_mfma_f32_16x16x32_bf16 v[24:27], a[248:251], a[52:55], v[24:27]
    buffer_load_dwordx4 v1, s[20:23], s45 offen offset:1024 sc1 lds
    s_add_u32 s45, s29, 221184
    v_mfma_f32_16x16x32_bf16 v[28:31], a[248:251], a[100:103], v[28:31]
    s_waitcnt lgkmcnt(2)
    s_add_u32 m0, s29, 24576
    ds_read_b128 a[248:251], v2 offset:6144
    v_mfma_f32_16x16x32_bf16 v[32:35], a[252:255], a[4:7], v[32:35]
    ds_read_b128 v[236:239], v4 offset:320
    v_cvt_pk_bf16_f32 v84, v52, v53
    v_mfma_f32_16x16x32_bf16 v[36:39], a[252:255], a[52:55], v[36:39]
    v_cvt_pk_bf16_f32 v85, v54, v55
    v_cvt_pk_bf16_f32 v86, v64, v65
    v_mfma_f32_16x16x32_bf16 v[40:43], a[252:255], a[100:103], v[40:43]
    s_waitcnt lgkmcnt(3)
    ds_read_b128 a[252:255], v2 offset:7168
    v_cvt_pk_bf16_f32 v87, v66, v67
    v_mfma_f32_16x16x32_bf16 v[20:23], a[240:243], a[8:11], v[20:23]
    buffer_load_dwordx4 v1, s[20:23], s45 offen offset:0 sc1 lds
    v_mfma_f32_16x16x32_bf16 v[24:27], a[240:243], a[56:59], v[24:27]
    v_mfma_f32_16x16x32_bf16 v[28:31], a[240:243], a[104:107], v[28:31]
    s_waitcnt lgkmcnt(3)
    ds_read_b128 a[240:243], v2 offset:8192
    v_mfma_f32_16x16x32_bf16 v[32:35], a[244:247], a[8:11], v[32:35]
    v_mfma_f32_16x16x32_bf16 v[36:39], a[244:247], a[56:59], v[36:39]
    buffer_load_dwordx4 v1, s[20:23], s45 offen offset:1024 sc1 lds
    v_mfma_f32_16x16x32_bf16 v[40:43], a[244:247], a[104:107], v[40:43]
    s_waitcnt lgkmcnt(3)
    ds_read_b128 a[244:247], v2 offset:9216
    v_mfma_f32_16x16x32_bf16 v[20:23], a[248:251], a[12:15], v[20:23]
    v_mfma_f32_16x16x32_bf16 v[24:27], a[248:251], a[60:63], v[24:27]
    v_mfma_f32_16x16x32_bf16 v[28:31], a[248:251], a[108:111], v[28:31]
    s_waitcnt lgkmcnt(2)
    ds_read_b128 a[248:251], v2 offset:10240
    v_mfma_f32_16x16x32_bf16 v[32:35], a[252:255], a[12:15], v[32:35]
    buffer_load_dwordx4 v1, s[20:23], s45 offen offset:2048 sc1 lds
    v_mfma_f32_16x16x32_bf16 v[36:39], a[252:255], a[60:63], v[36:39]
    v_mfma_f32_16x16x32_bf16 v[40:43], a[252:255], a[108:111], v[40:43]
    s_waitcnt lgkmcnt(2)
    ds_read_b128 a[252:255], v2 offset:11264
    v_mfma_f32_16x16x32_bf16 v[20:23], a[240:243], a[16:19], v[20:23]
    v_mfma_f32_16x16x32_bf16 v[24:27], a[240:243], a[64:67], v[24:27]
    buffer_load_dwordx4 v1, s[20:23], s45 offen offset:3072 sc1 lds
    s_add_u32 s45, s29, 225280
    v_mfma_f32_16x16x32_bf16 v[28:31], a[240:243], a[112:115], v[28:31]
    s_waitcnt lgkmcnt(2)
    s_add_u32 m0, s29, 28672
    ds_read_b128 a[240:243], v2 offset:12288
    v_mfma_f32_16x16x32_bf16 v[32:35], a[244:247], a[16:19], v[32:35]
    v_mfma_f32_16x16x32_bf16 v[36:39], a[244:247], a[64:67], v[36:39]
    v_mfma_f32_16x16x32_bf16 v[40:43], a[244:247], a[112:115], v[40:43]
    s_waitcnt lgkmcnt(2)
    ds_read_b128 a[244:247], v2 offset:13312
    v_mfma_f32_16x16x32_bf16 v[20:23], a[248:251], a[20:23], v[20:23]
    buffer_load_dwordx4 v1, s[20:23], s45 offen offset:0 sc1 lds
    v_mfma_f32_16x16x32_bf16 v[24:27], a[248:251], a[68:71], v[24:27]
    v_mfma_f32_16x16x32_bf16 v[28:31], a[248:251], a[116:119], v[28:31]
    s_waitcnt lgkmcnt(2)
    ds_read_b128 a[248:251], v2 offset:14336
    v_mfma_f32_16x16x32_bf16 v[32:35], a[252:255], a[20:23], v[32:35]
    v_mfma_f32_16x16x32_bf16 v[36:39], a[252:255], a[68:71], v[36:39]
    buffer_load_dwordx4 v1, s[20:23], s45 offen offset:1024 sc1 lds
    v_mfma_f32_16x16x32_bf16 v[40:43], a[252:255], a[116:119], v[40:43]
    s_waitcnt lgkmcnt(2)
    ds_read_b128 a[252:255], v2 offset:15360
    v_mfma_f32_16x16x32_bf16 v[20:23], a[240:243], a[24:27], v[20:23]
    v_mfma_f32_16x16x32_bf16 v[24:27], a[240:243], a[72:75], v[24:27]
    v_mfma_f32_16x16x32_bf16 v[28:31], a[240:243], a[120:123], v[28:31]
    s_waitcnt lgkmcnt(2)
    ds_read_b128 a[240:243], v2 offset:16384
    v_mfma_f32_16x16x32_bf16 v[32:35], a[244:247], a[24:27], v[32:35]
    v_mfma_f32_16x16x32_bf16 v[36:39], a[244:247], a[72:75], v[36:39]
    v_mfma_f32_16x16x32_bf16 v[40:43], a[244:247], a[120:123], v[40:43]
    s_waitcnt lgkmcnt(2)
    ds_read_b128 a[244:247], v2 offset:17408
    v_mfma_f32_16x16x32_bf16 v[20:23], a[248:251], a[28:31], v[20:23]
    v_mfma_f32_16x16x32_bf16 v[24:27], a[248:251], a[76:79], v[24:27]
    v_mfma_f32_16x16x32_bf16 v[28:31], a[248:251], a[124:127], v[28:31]
    s_waitcnt lgkmcnt(2)
    ds_read_b128 a[248:251], v2 offset:18432
    v_mfma_f32_16x16x32_bf16 v[32:35], a[252:255], a[28:31], v[32:35]
    v_mfma_f32_16x16x32_bf16 v[36:39], a[252:255], a[76:79], v[36:39]
    v_mfma_f32_16x16x32_bf16 v[40:43], a[252:255], a[124:127], v[40:43]
    s_waitcnt lgkmcnt(2)
    ds_read_b128 a[252:255], v2 offset:19456
    v_mfma_f32_16x16x32_bf16 v[20:23], a[240:243], a[32:35], v[20:23]
    v_mfma_f32_16x16x32_bf16 v[24:27], a[240:243], a[80:83], v[24:27]
    v_mfma_f32_16x16x32_bf16 v[28:31], a[240:243], a[128:131], v[28:31]
    s_waitcnt lgkmcnt(2)
    ds_read_b128 a[240:243], v2 offset:20480
    v_mfma_f32_16x16x32_bf16 v[32:35], a[244:247], a[32:35], v[32:35]
    v_mfma_f32_16x16x32_bf16 v[36:39], a[244:247], a[80:83], v[36:39]
    v_mfma_f32_16x16x32_bf16 v[40:43], a[244:247], a[128:131], v[40:43]
    s_waitcnt lgkmcnt(2)
    ds_read_b128 a[244:247], v2 offset:21504
    v_mfma_f32_16x16x32_bf16 v[20:23], a[248:251], a[36:39], v[20:23]
    v_mfma_f32_16x16x32_bf16 v[24:27], a[248:251], a[84:87], v[24:27]
    v_mfma_f32_16x16x32_bf16 v[28:31], a[248:251], a[132:135], v[28:31]
    s_waitcnt lgkmcnt(2)
    ds_read_b128 a[248:251], v2 offset:22528
    v_mfma_f32_16x16x32_bf16 v[32:35], a[252:255], a[36:39], v[32:35]
    v_mfma_f32_16x16x32_bf16 v[36:39], a[252:255], a[84:87], v[36:39]
    v_mfma_f32_16x16x32_bf16 v[40:43], a[252:255], a[132:135], v[40:43]
    s_waitcnt lgkmcnt(2)
    ds_read_b128 a[252:255], v2 offset:23552
    v_mfma_f32_16x16x32_bf16 v[20:23], a[240:243], a[40:43], v[20:23]
    v_mfma_f32_16x16x32_bf16 v[24:27], a[240:243], a[88:91], v[24:27]
    v_mfma_f32_16x16x32_bf16 v[28:31], a[240:243], a[136:139], v[28:31]
    s_waitcnt lgkmcnt(2)
    ds_read_b128 a[240:243], v2 offset:24576
    v_mfma_f32_16x16x32_bf16 v[32:35], a[244:247], a[40:43], v[32:35]
    v_mfma_f32_16x16x32_bf16 v[36:39], a[244:247], a[88:91], v[36:39]
    v_mfma_f32_16x16x32_bf16 v[40:43], a[244:247], a[136:139], v[40:43]
    s_waitcnt lgkmcnt(2)
    ds_read_b128 a[244:247], v2 offset:25600
    v_mfma_f32_16x16x32_bf16 v[20:23], a[248:251], a[44:47], v[20:23]
    v_mfma_f32_16x16x32_bf16 v[24:27], a[248:251], a[92:95], v[24:27]
    v_mfma_f32_16x16x32_bf16 v[28:31], a[248:251], a[140:143], v[28:31]
    s_waitcnt lgkmcnt(2)
    ds_read_b128 a[248:251], v2 offset:26624
    v_mfma_f32_16x16x32_bf16 v[32:35], a[252:255], a[44:47], v[32:35]
    v_mfma_f32_16x16x32_bf16 v[36:39], a[252:255], a[92:95], v[36:39]
    s_add_u32 m0, s31, -256
    v_mfma_f32_16x16x32_bf16 v[40:43], a[252:255], a[140:143], v[40:43]
    v_mfma_f32_16x16x32_bf16 v[148:151], a[20:23], v[68:71], v[148:151]
    v_mfma_f32_16x16x32_bf16 v[152:155], a[68:71], v[68:71], v[152:155]
    v_mfma_f32_16x16x32_bf16 v[156:159], a[116:119], v[68:71], v[156:159]
    v_mfma_f32_16x16x32_bf16 v[160:163], v[236:239], v[68:71], v[160:163]
    v_mfma_f32_16x16x32_bf16 v[164:167], a[20:23], v[76:79], v[164:167]
    v_mfma_f32_16x16x32_bf16 v[168:171], a[68:71], v[76:79], v[168:171]
    v_mfma_f32_16x16x32_bf16 v[172:175], a[116:119], v[76:79], v[172:175]
    v_mfma_f32_16x16x32_bf16 v[176:179], v[236:239], v[76:79], v[176:179]
    v_mfma_f32_16x16x32_bf16 v[180:183], a[20:23], v[84:87], v[180:183]
    v_mfma_f32_16x16x32_bf16 v[184:187], a[68:71], v[84:87], v[184:187]
    v_mfma_f32_16x16x32_bf16 v[188:191], a[116:119], v[84:87], v[188:191]
    v_mfma_f32_16x16x32_bf16 v[192:195], v[236:239], v[84:87], v[192:195]
    s_waitcnt lgkmcnt(2)
    v_mfma_f32_16x16x32_bf16 v[44:47], a[240:243], a[0:3], 0
    ds_read_b128 a[252:255], v2 offset:27648
    v_mfma_f32_16x16x32_bf16 v[48:51], a[240:243], a[48:51], 0
    v_cvt_pk_bf16_f32 v68, v20, v21
    v_cvt_pk_bf16_f32 v69, v22, v23
    v_mfma_f32_16x16x32_bf16 v[52:55], a[240:243], a[96:99], 0
    s_waitcnt lgkmcnt(2)
    ds_read_b128 a[240:243], v2 offset:28672
    v_cvt_pk_bf16_f32 v70, v32, v33
    v_mfma_f32_16x16x32_bf16 v[56:59], a[244:247], a[0:3], 0
    ds_read_b128 a[144:147], v3 offset:0
    v_cvt_pk_bf16_f32 v71, v34, v35
    v_mfma_f32_16x16x32_bf16 v[60:63], a[244:247], a[48:51], 0
    v_cvt_pk_bf16_f32 v76, v24, v25
    v_cvt_pk_bf16_f32 v77, v26, v27
    v_mfma_f32_16x16x32_bf16 v[64:67], a[244:247], a[96:99], 0
    s_waitcnt lgkmcnt(3)
    ds_read_b128 a[244:247], v2 offset:29696
    v_cvt_pk_bf16_f32 v78, v36, v37
    v_mfma_f32_16x16x32_bf16 v[44:47], a[248:251], a[4:7], v[44:47]
    ds_read_b128 a[148:151], v3 offset:64
    v_cvt_pk_bf16_f32 v79, v38, v39
    v_mfma_f32_16x16x32_bf16 v[48:51], a[248:251], a[52:55], v[48:51]
    v_cvt_pk_bf16_f32 v84, v28, v29
    v_cvt_pk_bf16_f32 v85, v30, v31
    v_mfma_f32_16x16x32_bf16 v[52:55], a[248:251], a[100:103], v[52:55]
    s_waitcnt lgkmcnt(4)
    ds_read_b128 a[248:251], v2 offset:30720
    v_cvt_pk_bf16_f32 v86, v40, v41
    v_mfma_f32_16x16x32_bf16 v[56:59], a[252:255], a[4:7], v[56:59]
    ds_read_b128 a[152:155], v3 offset:128
    v_cvt_pk_bf16_f32 v87, v42, v43
    v_mfma_f32_16x16x32_bf16 v[60:63], a[252:255], a[52:55], v[60:63]
    v_mfma_f32_16x16x32_bf16 v[64:67], a[252:255], a[100:103], v[64:67]
    s_waitcnt lgkmcnt(5)
    ds_read_b128 a[252:255], v2 offset:31744
    v_mfma_f32_16x16x32_bf16 v[44:47], a[240:243], a[8:11], v[44:47]
    ds_read_b128 a[156:159], v3 offset:192
    v_mfma_f32_16x16x32_bf16 v[48:51], a[240:243], a[56:59], v[48:51]
    v_mfma_f32_16x16x32_bf16 v[52:55], a[240:243], a[104:107], v[52:55]
    s_waitcnt lgkmcnt(5)
    ds_read_b128 a[240:243], v2 offset:32768
    v_mfma_f32_16x16x32_bf16 v[56:59], a[244:247], a[8:11], v[56:59]
    ds_read_b128 v[240:243], v4 offset:384
    v_mfma_f32_16x16x32_bf16 v[60:63], a[244:247], a[56:59], v[60:63]
    v_mfma_f32_16x16x32_bf16 v[64:67], a[244:247], a[104:107], v[64:67]
    s_waitcnt lgkmcnt(5)
    ds_read_b128 a[244:247], v2 offset:33792
    v_mfma_f32_16x16x32_bf16 v[44:47], a[248:251], a[12:15], v[44:47]
    v_mfma_f32_16x16x32_bf16 v[48:51], a[248:251], a[60:63], v[48:51]
    v_mfma_f32_16x16x32_bf16 v[52:55], a[248:251], a[108:111], v[52:55]
    s_waitcnt lgkmcnt(4)
    ds_read_b128 a[248:251], v2 offset:34816
    v_mfma_f32_16x16x32_bf16 v[56:59], a[252:255], a[12:15], v[56:59]
    s_waitcnt lgkmcnt(4)
    buffer_load_dwordx4 v7, s[16:19], s33 offen offset:256 nt lds
    s_add_u32 m0, s31, 832
    v_mfma_f32_16x16x32_bf16 v[60:63], a[252:255], a[60:63], v[60:63]
    v_mfma_f32_16x16x32_bf16 v[64:67], a[252:255], a[108:111], v[64:67]
    s_waitcnt lgkmcnt(3)
    ds_read_b128 a[252:255], v2 offset:35840
    v_mfma_f32_16x16x32_bf16 v[44:47], a[240:243], a[16:19], v[44:47]
    v_mfma_f32_16x16x32_bf16 v[48:51], a[240:243], a[64:67], v[48:51]
    buffer_load_dwordx4 v8, s[16:19], s33 offen offset:256 nt lds
    s_add_u32 m0, s31, 1920
    v_mfma_f32_16x16x32_bf16 v[52:55], a[240:243], a[112:115], v[52:55]
    s_waitcnt lgkmcnt(2)
    ds_read_b128 a[240:243], v2 offset:36864
    v_mfma_f32_16x16x32_bf16 v[56:59], a[244:247], a[16:19], v[56:59]
    v_mfma_f32_16x16x32_bf16 v[60:63], a[244:247], a[64:67], v[60:63]
    v_mfma_f32_16x16x32_bf16 v[64:67], a[244:247], a[112:115], v[64:67]
    s_waitcnt lgkmcnt(2)
    ds_read_b128 a[244:247], v2 offset:37888
    v_mfma_f32_16x16x32_bf16 v[44:47], a[248:251], a[20:23], v[44:47]
    buffer_load_dwordx4 v9, s[16:19], s33 offen offset:256 nt lds
    s_add_u32 m0, s31, 3008
    v_mfma_f32_16x16x32_bf16 v[48:51], a[248:251], a[68:71], v[48:51]
    v_mfma_f32_16x16x32_bf16 v[52:55], a[248:251], a[116:119], v[52:55]
    s_waitcnt lgkmcnt(2)
    ds_read_b128 a[248:251], v2 offset:38912
    v_mfma_f32_16x16x32_bf16 v[56:59], a[252:255], a[20:23], v[56:59]
    v_mfma_f32_16x16x32_bf16 v[60:63], a[252:255], a[68:71], v[60:63]
    buffer_load_dwordx4 v10, s[16:19], s33 offen offset:256 nt lds
    v_mfma_f32_16x16x32_bf16 v[64:67], a[252:255], a[116:119], v[64:67]
    s_waitcnt lgkmcnt(2)
    ds_read_b128 a[252:255], v2 offset:39936
    v_mfma_f32_16x16x32_bf16 v[44:47], a[240:243], a[24:27], v[44:47]
    v_mfma_f32_16x16x32_bf16 v[48:51], a[240:243], a[72:75], v[48:51]
    v_mfma_f32_16x16x32_bf16 v[52:55], a[240:243], a[120:123], v[52:55]
    s_waitcnt lgkmcnt(2)
    ds_read_b128 a[240:243], v2 offset:40960
    v_mfma_f32_16x16x32_bf16 v[56:59], a[244:247], a[24:27], v[56:59]
    v_mfma_f32_16x16x32_bf16 v[60:63], a[244:247], a[72:75], v[60:63]
    v_mfma_f32_16x16x32_bf16 v[64:67], a[244:247], a[120:123], v[64:67]
    s_waitcnt lgkmcnt(2)
    ds_read_b128 a[244:247], v2 offset:41984
    v_mfma_f32_16x16x32_bf16 v[44:47], a[248:251], a[28:31], v[44:47]
    v_mfma_f32_16x16x32_bf16 v[48:51], a[248:251], a[76:79], v[48:51]
    v_mfma_f32_16x16x32_bf16 v[52:55], a[248:251], a[124:127], v[52:55]
    s_waitcnt lgkmcnt(2)
    ds_read_b128 a[248:251], v2 offset:43008
    v_mfma_f32_16x16x32_bf16 v[56:59], a[252:255], a[28:31], v[56:59]
    v_mfma_f32_16x16x32_bf16 v[60:63], a[252:255], a[76:79], v[60:63]
    v_mfma_f32_16x16x32_bf16 v[64:67], a[252:255], a[124:127], v[64:67]
    s_waitcnt lgkmcnt(2)
    ds_read_b128 a[252:255], v2 offset:44032
    v_mfma_f32_16x16x32_bf16 v[44:47], a[240:243], a[32:35], v[44:47]
    v_mfma_f32_16x16x32_bf16 v[48:51], a[240:243], a[80:83], v[48:51]
    v_mfma_f32_16x16x32_bf16 v[52:55], a[240:243], a[128:131], v[52:55]
    s_waitcnt lgkmcnt(2)
    ds_read_b128 a[240:243], v2 offset:45056
    v_mfma_f32_16x16x32_bf16 v[56:59], a[244:247], a[32:35], v[56:59]
    v_mfma_f32_16x16x32_bf16 v[60:63], a[244:247], a[80:83], v[60:63]
    v_mfma_f32_16x16x32_bf16 v[64:67], a[244:247], a[128:131], v[64:67]
    s_waitcnt lgkmcnt(2)
    ds_read_b128 a[244:247], v2 offset:46080
    v_mfma_f32_16x16x32_bf16 v[44:47], a[248:251], a[36:39], v[44:47]
    v_mfma_f32_16x16x32_bf16 v[48:51], a[248:251], a[84:87], v[48:51]
    v_mfma_f32_16x16x32_bf16 v[52:55], a[248:251], a[132:135], v[52:55]
    s_waitcnt lgkmcnt(2)
    ds_read_b128 a[248:251], v2 offset:47104
    v_mfma_f32_16x16x32_bf16 v[56:59], a[252:255], a[36:39], v[56:59]
    v_mfma_f32_16x16x32_bf16 v[60:63], a[252:255], a[84:87], v[60:63]
    v_mfma_f32_16x16x32_bf16 v[64:67], a[252:255], a[132:135], v[64:67]
    s_waitcnt lgkmcnt(2)
    ds_read_b128 a[252:255], v2 offset:48128
    v_mfma_f32_16x16x32_bf16 v[44:47], a[240:243], a[40:43], v[44:47]
    v_mfma_f32_16x16x32_bf16 v[48:51], a[240:243], a[88:91], v[48:51]
    v_mfma_f32_16x16x32_bf16 v[52:55], a[240:243], a[136:139], v[52:55]
    s_waitcnt lgkmcnt(2)
    v_mfma_f32_16x16x32_bf16 v[56:59], a[244:247], a[40:43], v[56:59]
    v_mfma_f32_16x16x32_bf16 v[60:63], a[244:247], a[88:91], v[60:63]
    v_mfma_f32_16x16x32_bf16 v[64:67], a[244:247], a[136:139], v[64:67]
    s_waitcnt lgkmcnt(1)
    v_mfma_f32_16x16x32_bf16 v[44:47], a[248:251], a[44:47], v[44:47]
    v_mfma_f32_16x16x32_bf16 v[48:51], a[248:251], a[92:95], v[48:51]
    v_mfma_f32_16x16x32_bf16 v[52:55], a[248:251], a[140:143], v[52:55]
    s_waitcnt vmcnt(4) lgkmcnt(0)
    s_barrier
    ds_read_b128 a[240:243], v1 offset:0
    v_mfma_f32_16x16x32_bf16 v[56:59], a[252:255], a[44:47], v[56:59]
    ds_read_b128 a[244:247], v1 offset:1024
    v_mfma_f32_16x16x32_bf16 v[60:63], a[252:255], a[92:95], v[60:63]
    s_add_u32 s45, s29, 245760
    s_add_u32 m0, s29, 49152
    ds_read_b128 a[248:251], v1 offset:2048
    v_mfma_f32_16x16x32_bf16 v[64:67], a[252:255], a[140:143], v[64:67]
    buffer_load_dwordx4 v1, s[20:23], s45 offen offset:0 sc1 lds
    v_mfma_f32_16x16x32_bf16 v[148:151], a[24:27], v[68:71], v[148:151]
    v_mfma_f32_16x16x32_bf16 v[152:155], a[72:75], v[68:71], v[152:155]
    v_mfma_f32_16x16x32_bf16 v[156:159], a[120:123], v[68:71], v[156:159]
    v_mfma_f32_16x16x32_bf16 v[160:163], v[240:243], v[68:71], v[160:163]
    buffer_load_dwordx4 v1, s[20:23], s45 offen offset:1024 sc1 lds
    v_mfma_f32_16x16x32_bf16 v[164:167], a[24:27], v[76:79], v[164:167]
    v_mfma_f32_16x16x32_bf16 v[168:171], a[72:75], v[76:79], v[168:171]
    v_mfma_f32_16x16x32_bf16 v[172:175], a[120:123], v[76:79], v[172:175]
    v_mfma_f32_16x16x32_bf16 v[176:179], v[240:243], v[76:79], v[176:179]
    buffer_load_dwordx4 v1, s[20:23], s45 offen offset:2048 sc1 lds
    v_mfma_f32_16x16x32_bf16 v[180:183], a[24:27], v[84:87], v[180:183]
    v_mfma_f32_16x16x32_bf16 v[184:187], a[72:75], v[84:87], v[184:187]
    v_mfma_f32_16x16x32_bf16 v[188:191], a[120:123], v[84:87], v[188:191]
    v_mfma_f32_16x16x32_bf16 v[192:195], v[240:243], v[84:87], v[192:195]
    s_waitcnt lgkmcnt(2)
    buffer_load_dwordx4 v1, s[20:23], s45 offen offset:3072 sc1 lds
    v_mfma_f32_16x16x32_bf16 v[20:23], a[240:243], a[0:3], 0
    s_add_u32 s45, s29, 249856
    s_add_u32 m0, s29, 53248
    ds_read_b128 a[252:255], v1 offset:3072
    v_mfma_f32_16x16x32_bf16 v[24:27], a[240:243], a[48:51], 0
    v_cvt_pk_bf16_f32 v68, v44, v45
    v_cvt_pk_bf16_f32 v69, v46, v47
    v_mfma_f32_16x16x32_bf16 v[28:31], a[240:243], a[96:99], 0
    s_waitcnt lgkmcnt(2)
    ds_read_b128 a[240:243], v1 offset:4096
    v_cvt_pk_bf16_f32 v70, v56, v57
    v_mfma_f32_16x16x32_bf16 v[32:35], a[244:247], a[0:3], 0
    buffer_load_dwordx4 v1, s[20:23], s45 offen offset:0 sc1 lds
    v_mfma_f32_16x16x32_bf16 v[36:39], a[244:247], a[48:51], 0
    ds_read_b128 a[176:179], v3 offset:4352
    v_cvt_pk_bf16_f32 v71, v58, v59
    v_mfma_f32_16x16x32_bf16 v[40:43], a[244:247], a[96:99], 0
    s_waitcnt lgkmcnt(3)
    ds_read_b128 a[244:247], v1 offset:5120
    v_cvt_pk_bf16_f32 v76, v48, v49
    v_mfma_f32_16x16x32_bf16 v[20:23], a[248:251], a[4:7], v[20:23]
    v_cvt_pk_bf16_f32 v77, v50, v51
    v_cvt_pk_bf16_f32 v78, v60, v61
    v_mfma_f32_16x16x32_bf16 v[24:27], a[248:251], a[52:55], v[24:27]
    buffer_load_dwordx4 v1, s[20:23], s45 offen offset:1024 sc1 lds
    s_add_u32 s45, s29, 270336
    v_mfma_f32_16x16x32_bf16 v[28:31], a[248:251], a[100:103], v[28:31]
    s_waitcnt lgkmcnt(3)
    s_add_u32 m0, s29, 73728
    ds_read_b128 a[248:251], v1 offset:6144
    v_mfma_f32_16x16x32_bf16 v[32:35], a[252:255], a[4:7], v[32:35]
    ds_read_b128 a[180:183], v3 offset:4416
    v_cvt_pk_bf16_f32 v79, v62, v63
    v_mfma_f32_16x16x32_bf16 v[36:39], a[252:255], a[52:55], v[36:39]
    v_cvt_pk_bf16_f32 v84, v52, v53
    v_cvt_pk_bf16_f32 v85, v54, v55
    v_mfma_f32_16x16x32_bf16 v[40:43], a[252:255], a[100:103], v[40:43]
    s_waitcnt lgkmcnt(4)
    ds_read_b128 a[252:255], v1 offset:7168
    v_cvt_pk_bf16_f32 v86, v64, v65
    v_mfma_f32_16x16x32_bf16 v[20:23], a[240:243], a[8:11], v[20:23]
    ds_read_b128 a[184:187], v3 offset:4480
    v_cvt_pk_bf16_f32 v87, v66, v67
    v_mfma_f32_16x16x32_bf16 v[24:27], a[240:243], a[56:59], v[24:27]
    buffer_load_dwordx4 v1, s[20:23], s45 offen offset:0 sc1 lds
    v_mfma_f32_16x16x32_bf16 v[28:31], a[240:243], a[104:107], v[28:31]
    s_waitcnt lgkmcnt(4)
    ds_read_b128 a[240:243], v1 offset:8192
    v_mfma_f32_16x16x32_bf16 v[32:35], a[244:247], a[8:11], v[32:35]
    ds_read_b128 a[188:191], v3 offset:4544
    v_mfma_f32_16x16x32_bf16 v[36:39], a[244:247], a[56:59], v[36:39]
    v_mfma_f32_16x16x32_bf16 v[40:43], a[244:247], a[104:107], v[40:43]
    s_waitcnt lgkmcnt(5)
    ds_read_b128 a[244:247], v1 offset:9216
    v_mfma_f32_16x16x32_bf16 v[20:23], a[248:251], a[12:15], v[20:23]
    buffer_load_dwordx4 v1, s[20:23], s45 offen offset:1024 sc1 lds
    v_mfma_f32_16x16x32_bf16 v[24:27], a[248:251], a[60:63], v[24:27]
    ds_read_b128 v[244:247], v4 offset:448
    v_mfma_f32_16x16x32_bf16 v[28:31], a[248:251], a[108:111], v[28:31]
    s_waitcnt lgkmcnt(5)
    ds_read_b128 a[248:251], v1 offset:10240
    v_mfma_f32_16x16x32_bf16 v[32:35], a[252:255], a[12:15], v[32:35]
    v_mfma_f32_16x16x32_bf16 v[36:39], a[252:255], a[60:63], v[36:39]
    buffer_load_dwordx4 v1, s[20:23], s45 offen offset:2048 sc1 lds
    v_mfma_f32_16x16x32_bf16 v[40:43], a[252:255], a[108:111], v[40:43]
    s_waitcnt lgkmcnt(4)
    ds_read_b128 a[252:255], v1 offset:11264
    v_mfma_f32_16x16x32_bf16 v[20:23], a[240:243], a[16:19], v[20:23]
    v_mfma_f32_16x16x32_bf16 v[24:27], a[240:243], a[64:67], v[24:27]
    v_mfma_f32_16x16x32_bf16 v[28:31], a[240:243], a[112:115], v[28:31]
    s_waitcnt lgkmcnt(3)
    ds_read_b128 a[240:243], v1 offset:12288
    v_mfma_f32_16x16x32_bf16 v[32:35], a[244:247], a[16:19], v[32:35]
    buffer_load_dwordx4 v1, s[20:23], s45 offen offset:3072 sc1 lds
    s_add_u32 s45, s29, 274432
    v_mfma_f32_16x16x32_bf16 v[36:39], a[244:247], a[64:67], v[36:39]
    s_add_u32 m0, s29, 77824
    v_mfma_f32_16x16x32_bf16 v[40:43], a[244:247], a[112:115], v[40:43]
    s_waitcnt lgkmcnt(2)
    ds_read_b128 a[244:247], v1 offset:13312
    v_mfma_f32_16x16x32_bf16 v[20:23], a[248:251], a[20:23], v[20:23]
    v_mfma_f32_16x16x32_bf16 v[24:27], a[248:251], a[68:71], v[24:27]
    buffer_load_dwordx4 v1, s[20:23], s45 offen offset:0 sc1 lds
    v_mfma_f32_16x16x32_bf16 v[28:31], a[248:251], a[116:119], v[28:31]
    s_waitcnt lgkmcnt(2)
    ds_read_b128 a[248:251], v1 offset:14336
    v_mfma_f32_16x16x32_bf16 v[32:35], a[252:255], a[20:23], v[32:35]
    v_mfma_f32_16x16x32_bf16 v[36:39], a[252:255], a[68:71], v[36:39]
    v_mfma_f32_16x16x32_bf16 v[40:43], a[252:255], a[116:119], v[40:43]
    s_waitcnt lgkmcnt(2)
    ds_read_b128 a[252:255], v1 offset:15360
    v_mfma_f32_16x16x32_bf16 v[20:23], a[240:243], a[24:27], v[20:23]
    buffer_load_dwordx4 v1, s[20:23], s45 offen offset:1024 sc1 lds
    s_add_u32 m0, s31, 4096
    v_mfma_f32_16x16x32_bf16 v[24:27], a[240:243], a[72:75], v[24:27]
    v_mfma_f32_16x16x32_bf16 v[28:31], a[240:243], a[120:123], v[28:31]
    s_waitcnt lgkmcnt(2)
    ds_read_b128 a[240:243], v1 offset:16384
    v_mfma_f32_16x16x32_bf16 v[32:35], a[244:247], a[24:27], v[32:35]
    v_mfma_f32_16x16x32_bf16 v[36:39], a[244:247], a[72:75], v[36:39]
    buffer_load_dwordx4 v11, s[16:19], s33 offen offset:256 nt lds
    s_add_u32 m0, s31, 5184
    v_mfma_f32_16x16x32_bf16 v[40:43], a[244:247], a[120:123], v[40:43]
    s_waitcnt lgkmcnt(2)
    ds_read_b128 a[244:247], v1 offset:17408
    v_mfma_f32_16x16x32_bf16 v[20:23], a[248:251], a[28:31], v[20:23]
    v_mfma_f32_16x16x32_bf16 v[24:27], a[248:251], a[76:79], v[24:27]
    v_mfma_f32_16x16x32_bf16 v[28:31], a[248:251], a[124:127], v[28:31]
    s_waitcnt lgkmcnt(2)
    ds_read_b128 a[248:251], v1 offset:18432
    v_mfma_f32_16x16x32_bf16 v[32:35], a[252:255], a[28:31], v[32:35]
    buffer_load_dwordx4 v12, s[16:19], s33 offen offset:256 nt lds
    s_add_u32 m0, s31, 6272
    v_mfma_f32_16x16x32_bf16 v[36:39], a[252:255], a[76:79], v[36:39]
    v_mfma_f32_16x16x32_bf16 v[40:43], a[252:255], a[124:127], v[40:43]
    s_waitcnt lgkmcnt(2)
    ds_read_b128 a[252:255], v1 offset:19456
    v_mfma_f32_16x16x32_bf16 v[20:23], a[240:243], a[32:35], v[20:23]
    v_mfma_f32_16x16x32_bf16 v[24:27], a[240:243], a[80:83], v[24:27]
    buffer_load_dwordx4 v13, s[16:19], s33 offen offset:256 nt lds
    s_add_u32 m0, s31, 7360
    v_mfma_f32_16x16x32_bf16 v[28:31], a[240:243], a[128:131], v[28:31]
    s_waitcnt lgkmcnt(2)
    ds_read_b128 a[240:243], v1 offset:20480
    v_mfma_f32_16x16x32_bf16 v[32:35], a[244:247], a[32:35], v[32:35]
    v_mfma_f32_16x16x32_bf16 v[36:39], a[244:247], a[80:83], v[36:39]
    v_mfma_f32_16x16x32_bf16 v[40:43], a[244:247], a[128:131], v[40:43]
    s_waitcnt lgkmcnt(2)
    ds_read_b128 a[244:247], v1 offset:21504
    v_mfma_f32_16x16x32_bf16 v[20:23], a[248:251], a[36:39], v[20:23]
    buffer_load_dwordx4 v14, s[16:19], s33 offen offset:256 nt lds
    v_mfma_f32_16x16x32_bf16 v[24:27], a[248:251], a[84:87], v[24:27]
    v_mfma_f32_16x16x32_bf16 v[28:31], a[248:251], a[132:135], v[28:31]
    s_waitcnt lgkmcnt(2)
    ds_read_b128 a[248:251], v1 offset:22528
    v_mfma_f32_16x16x32_bf16 v[32:35], a[252:255], a[36:39], v[32:35]
    v_mfma_f32_16x16x32_bf16 v[36:39], a[252:255], a[84:87], v[36:39]
    v_mfma_f32_16x16x32_bf16 v[40:43], a[252:255], a[132:135], v[40:43]
    s_waitcnt lgkmcnt(2)
    ds_read_b128 a[252:255], v1 offset:23552
    v_mfma_f32_16x16x32_bf16 v[20:23], a[240:243], a[40:43], v[20:23]
    v_mfma_f32_16x16x32_bf16 v[24:27], a[240:243], a[88:91], v[24:27]
    v_mfma_f32_16x16x32_bf16 v[28:31], a[240:243], a[136:139], v[28:31]
    s_waitcnt lgkmcnt(2)
    ds_read_b128 a[240:243], v1 offset:24576
    v_mfma_f32_16x16x32_bf16 v[32:35], a[244:247], a[40:43], v[32:35]
    v_mfma_f32_16x16x32_bf16 v[36:39], a[244:247], a[88:91], v[36:39]
    v_mfma_f32_16x16x32_bf16 v[40:43], a[244:247], a[136:139], v[40:43]
    s_waitcnt lgkmcnt(2)
    ds_read_b128 a[244:247], v1 offset:25600
    v_mfma_f32_16x16x32_bf16 v[20:23], a[248:251], a[44:47], v[20:23]
    v_mfma_f32_16x16x32_bf16 v[24:27], a[248:251], a[92:95], v[24:27]
    v_mfma_f32_16x16x32_bf16 v[28:31], a[248:251], a[140:143], v[28:31]
    s_waitcnt lgkmcnt(2)
    ds_read_b128 a[248:251], v1 offset:26624
    v_mfma_f32_16x16x32_bf16 v[32:35], a[252:255], a[44:47], v[32:35]
    v_mfma_f32_16x16x32_bf16 v[36:39], a[252:255], a[92:95], v[36:39]
    s_add_u32 m0, s31, 8448
    v_mfma_f32_16x16x32_bf16 v[40:43], a[252:255], a[140:143], v[40:43]
    v_mfma_f32_16x16x32_bf16 v[148:151], a[28:31], v[68:71], v[148:151]
    v_mfma_f32_16x16x32_bf16 v[152:155], a[76:79], v[68:71], v[152:155]
    v_mfma_f32_16x16x32_bf16 v[156:159], a[124:127], v[68:71], v[156:159]
    v_mfma_f32_16x16x32_bf16 v[160:163], v[244:247], v[68:71], v[160:163]
    v_mfma_f32_16x16x32_bf16 v[164:167], a[28:31], v[76:79], v[164:167]
    v_mfma_f32_16x16x32_bf16 v[168:171], a[76:79], v[76:79], v[168:171]
    v_mfma_f32_16x16x32_bf16 v[172:175], a[124:127], v[76:79], v[172:175]
    v_mfma_f32_16x16x32_bf16 v[176:179], v[244:247], v[76:79], v[176:179]
    v_mfma_f32_16x16x32_bf16 v[180:183], a[28:31], v[84:87], v[180:183]
    v_mfma_f32_16x16x32_bf16 v[184:187], a[76:79], v[84:87], v[184:187]
    v_mfma_f32_16x16x32_bf16 v[188:191], a[124:127], v[84:87], v[188:191]
    v_mfma_f32_16x16x32_bf16 v[192:195], v[244:247], v[84:87], v[192:195]
    s_waitcnt lgkmcnt(2)
    v_mfma_f32_16x16x32_bf16 v[44:47], a[240:243], a[0:3], 0
    ds_read_b128 a[252:255], v1 offset:27648
    v_mfma_f32_16x16x32_bf16 v[48:51], a[240:243], a[48:51], 0
    v_cvt_pk_bf16_f32 v68, v20, v21
    v_cvt_pk_bf16_f32 v69, v22, v23
    v_mfma_f32_16x16x32_bf16 v[52:55], a[240:243], a[96:99], 0
    s_waitcnt lgkmcnt(2)
    ds_read_b128 a[240:243], v1 offset:28672
    v_cvt_pk_bf16_f32 v70, v32, v33
    v_mfma_f32_16x16x32_bf16 v[56:59], a[244:247], a[0:3], 0
    ds_read_b128 a[208:211], v3 offset:8704
    v_cvt_pk_bf16_f32 v71, v34, v35
    v_mfma_f32_16x16x32_bf16 v[60:63], a[244:247], a[48:51], 0
    v_cvt_pk_bf16_f32 v76, v24, v25
    v_cvt_pk_bf16_f32 v77, v26, v27
    v_mfma_f32_16x16x32_bf16 v[64:67], a[244:247], a[96:99], 0
    s_waitcnt lgkmcnt(3)
    ds_read_b128 a[244:247], v1 offset:29696
    v_cvt_pk_bf16_f32 v78, v36, v37
    v_mfma_f32_16x16x32_bf16 v[44:47], a[248:251], a[4:7], v[44:47]
    ds_read_b128 a[212:215], v3 offset:8768
    v_cvt_pk_bf16_f32 v79, v38, v39
    v_mfma_f32_16x16x32_bf16 v[48:51], a[248:251], a[52:55], v[48:51]
    v_cvt_pk_bf16_f32 v84, v28, v29
    v_cvt_pk_bf16_f32 v85, v30, v31
    v_mfma_f32_16x16x32_bf16 v[52:55], a[248:251], a[100:103], v[52:55]
    s_waitcnt lgkmcnt(4)
    ds_read_b128 a[248:251], v1 offset:30720
    v_cvt_pk_bf16_f32 v86, v40, v41
    v_mfma_f32_16x16x32_bf16 v[56:59], a[252:255], a[4:7], v[56:59]
    ds_read_b128 a[216:219], v3 offset:8832
    v_cvt_pk_bf16_f32 v87, v42, v43
    v_mfma_f32_16x16x32_bf16 v[60:63], a[252:255], a[52:55], v[60:63]
    v_mfma_f32_16x16x32_bf16 v[64:67], a[252:255], a[100:103], v[64:67]
    s_waitcnt lgkmcnt(5)
    ds_read_b128 a[252:255], v1 offset:31744
    v_mfma_f32_16x16x32_bf16 v[44:47], a[240:243], a[8:11], v[44:47]
    ds_read_b128 a[220:223], v3 offset:8896
    v_mfma_f32_16x16x32_bf16 v[48:51], a[240:243], a[56:59], v[48:51]
    v_mfma_f32_16x16x32_bf16 v[52:55], a[240:243], a[104:107], v[52:55]
    s_waitcnt lgkmcnt(5)
    ds_read_b128 a[240:243], v1 offset:32768
    v_mfma_f32_16x16x32_bf16 v[56:59], a[244:247], a[8:11], v[56:59]
    ds_read_b128 v[232:235], v4 offset:512
    v_mfma_f32_16x16x32_bf16 v[60:63], a[244:247], a[56:59], v[60:63]
    v_mfma_f32_16x16x32_bf16 v[64:67], a[244:247], a[104:107], v[64:67]
    s_waitcnt lgkmcnt(5)
    ds_read_b128 a[244:247], v1 offset:33792
    v_mfma_f32_16x16x32_bf16 v[44:47], a[248:251], a[12:15], v[44:47]
    v_mfma_f32_16x16x32_bf16 v[48:51], a[248:251], a[60:63], v[48:51]
    v_mfma_f32_16x16x32_bf16 v[52:55], a[248:251], a[108:111], v[52:55]
    s_waitcnt lgkmcnt(4)
    ds_read_b128 a[248:251], v1 offset:34816
    v_mfma_f32_16x16x32_bf16 v[56:59], a[252:255], a[12:15], v[56:59]
    s_waitcnt lgkmcnt(4)
    buffer_load_dwordx4 v15, s[16:19], s33 offen offset:256 nt lds
    s_add_u32 m0, s31, 9536
    v_mfma_f32_16x16x32_bf16 v[60:63], a[252:255], a[60:63], v[60:63]
    v_mfma_f32_16x16x32_bf16 v[64:67], a[252:255], a[108:111], v[64:67]
    s_waitcnt lgkmcnt(3)
    ds_read_b128 a[252:255], v1 offset:35840
    v_mfma_f32_16x16x32_bf16 v[44:47], a[240:243], a[16:19], v[44:47]
    v_mfma_f32_16x16x32_bf16 v[48:51], a[240:243], a[64:67], v[48:51]
    buffer_load_dwordx4 v16, s[16:19], s33 offen offset:256 nt lds
    s_add_u32 m0, s31, 10624
    v_mfma_f32_16x16x32_bf16 v[52:55], a[240:243], a[112:115], v[52:55]
    s_waitcnt lgkmcnt(2)
    ds_read_b128 a[240:243], v1 offset:36864
    v_mfma_f32_16x16x32_bf16 v[56:59], a[244:247], a[16:19], v[56:59]
    v_mfma_f32_16x16x32_bf16 v[60:63], a[244:247], a[64:67], v[60:63]
    v_mfma_f32_16x16x32_bf16 v[64:67], a[244:247], a[112:115], v[64:67]
    s_waitcnt lgkmcnt(2)
    ds_read_b128 a[244:247], v1 offset:37888
    v_mfma_f32_16x16x32_bf16 v[44:47], a[248:251], a[20:23], v[44:47]
    buffer_load_dwordx4 v17, s[16:19], s33 offen offset:256 nt lds
    s_add_u32 m0, s31, 11712
    v_mfma_f32_16x16x32_bf16 v[48:51], a[248:251], a[68:71], v[48:51]
    v_mfma_f32_16x16x32_bf16 v[52:55], a[248:251], a[116:119], v[52:55]
    s_waitcnt lgkmcnt(2)
    ds_read_b128 a[248:251], v1 offset:38912
    v_mfma_f32_16x16x32_bf16 v[56:59], a[252:255], a[20:23], v[56:59]
    v_mfma_f32_16x16x32_bf16 v[60:63], a[252:255], a[68:71], v[60:63]
    buffer_load_dwordx4 v18, s[16:19], s33 offen offset:256 nt lds
    v_mfma_f32_16x16x32_bf16 v[64:67], a[252:255], a[116:119], v[64:67]
    s_waitcnt lgkmcnt(2)
    ds_read_b128 a[252:255], v1 offset:39936
    v_mfma_f32_16x16x32_bf16 v[44:47], a[240:243], a[24:27], v[44:47]
    v_mfma_f32_16x16x32_bf16 v[48:51], a[240:243], a[72:75], v[48:51]
    v_mfma_f32_16x16x32_bf16 v[52:55], a[240:243], a[120:123], v[52:55]
    s_waitcnt lgkmcnt(2)
    ds_read_b128 a[240:243], v1 offset:40960
    v_mfma_f32_16x16x32_bf16 v[56:59], a[244:247], a[24:27], v[56:59]
    v_mfma_f32_16x16x32_bf16 v[60:63], a[244:247], a[72:75], v[60:63]
    v_mfma_f32_16x16x32_bf16 v[64:67], a[244:247], a[120:123], v[64:67]
    s_waitcnt lgkmcnt(2)
    ds_read_b128 a[244:247], v1 offset:41984
    v_mfma_f32_16x16x32_bf16 v[44:47], a[248:251], a[28:31], v[44:47]
    v_mfma_f32_16x16x32_bf16 v[48:51], a[248:251], a[76:79], v[48:51]
    v_mfma_f32_16x16x32_bf16 v[52:55], a[248:251], a[124:127], v[52:55]
    s_waitcnt lgkmcnt(2)
    ds_read_b128 a[248:251], v1 offset:43008
    v_mfma_f32_16x16x32_bf16 v[56:59], a[252:255], a[28:31], v[56:59]
    v_mfma_f32_16x16x32_bf16 v[60:63], a[252:255], a[76:79], v[60:63]
    v_mfma_f32_16x16x32_bf16 v[64:67], a[252:255], a[124:127], v[64:67]
    s_waitcnt lgkmcnt(2)
    ds_read_b128 a[252:255], v1 offset:44032
    v_mfma_f32_16x16x32_bf16 v[44:47], a[240:243], a[32:35], v[44:47]
    v_mfma_f32_16x16x32_bf16 v[48:51], a[240:243], a[80:83], v[48:51]
    v_mfma_f32_16x16x32_bf16 v[52:55], a[240:243], a[128:131], v[52:55]
    s_waitcnt lgkmcnt(2)
    ds_read_b128 a[240:243], v1 offset:45056
    v_mfma_f32_16x16x32_bf16 v[56:59], a[244:247], a[32:35], v[56:59]
    v_mfma_f32_16x16x32_bf16 v[60:63], a[244:247], a[80:83], v[60:63]
    v_mfma_f32_16x16x32_bf16 v[64:67], a[244:247], a[128:131], v[64:67]
    s_waitcnt lgkmcnt(2)
    ds_read_b128 a[244:247], v1 offset:46080
    v_mfma_f32_16x16x32_bf16 v[44:47], a[248:251], a[36:39], v[44:47]
    v_mfma_f32_16x16x32_bf16 v[48:51], a[248:251], a[84:87], v[48:51]
    v_mfma_f32_16x16x32_bf16 v[52:55], a[248:251], a[132:135], v[52:55]
    s_waitcnt lgkmcnt(2)
    ds_read_b128 a[248:251], v1 offset:47104
    v_mfma_f32_16x16x32_bf16 v[56:59], a[252:255], a[36:39], v[56:59]
    v_mfma_f32_16x16x32_bf16 v[60:63], a[252:255], a[84:87], v[60:63]
    v_mfma_f32_16x16x32_bf16 v[64:67], a[252:255], a[132:135], v[64:67]
    s_waitcnt lgkmcnt(2)
    ds_read_b128 a[252:255], v1 offset:48128
    v_mfma_f32_16x16x32_bf16 v[44:47], a[240:243], a[40:43], v[44:47]
    v_mfma_f32_16x16x32_bf16 v[48:51], a[240:243], a[88:91], v[48:51]
    v_mfma_f32_16x16x32_bf16 v[52:55], a[240:243], a[136:139], v[52:55]
    s_waitcnt lgkmcnt(2)
    v_mfma_f32_16x16x32_bf16 v[56:59], a[244:247], a[40:43], v[56:59]
    v_mfma_f32_16x16x32_bf16 v[60:63], a[244:247], a[88:91], v[60:63]
    v_mfma_f32_16x16x32_bf16 v[64:67], a[244:247], a[136:139], v[64:67]
    s_waitcnt lgkmcnt(1)
    v_mfma_f32_16x16x32_bf16 v[44:47], a[248:251], a[44:47], v[44:47]
    v_mfma_f32_16x16x32_bf16 v[48:51], a[248:251], a[92:95], v[48:51]
    v_mfma_f32_16x16x32_bf16 v[52:55], a[248:251], a[140:143], v[52:55]
    s_waitcnt vmcnt(8) lgkmcnt(0)
    s_barrier
    ds_read_b128 a[240:243], v2 offset:0
    v_mfma_f32_16x16x32_bf16 v[56:59], a[252:255], a[44:47], v[56:59]
    ds_read_b128 a[244:247], v2 offset:1024
    v_mfma_f32_16x16x32_bf16 v[60:63], a[252:255], a[92:95], v[60:63]
    s_add_u32 s45, s29, 294912
    s_add_u32 m0, s29, 0
    ds_read_b128 a[248:251], v2 offset:2048
    v_mfma_f32_16x16x32_bf16 v[64:67], a[252:255], a[140:143], v[64:67]
    buffer_load_ubyte v0, off, s[48:51], s37 sc1
    v_mfma_f32_16x16x32_bf16 v[148:151], a[32:35], v[68:71], v[148:151]
    v_mfma_f32_16x16x32_bf16 v[152:155], a[80:83], v[68:71], v[152:155]
    v_mfma_f32_16x16x32_bf16 v[156:159], a[128:131], v[68:71], v[156:159]
    v_mfma_f32_16x16x32_bf16 v[160:163], v[232:235], v[68:71], v[160:163]
    buffer_load_dwordx4 v1, s[20:23], s45 offen offset:0 sc1 lds
    v_mfma_f32_16x16x32_bf16 v[164:167], a[32:35], v[76:79], v[164:167]
    v_mfma_f32_16x16x32_bf16 v[168:171], a[80:83], v[76:79], v[168:171]
    v_mfma_f32_16x16x32_bf16 v[172:175], a[128:131], v[76:79], v[172:175]
    v_mfma_f32_16x16x32_bf16 v[176:179], v[232:235], v[76:79], v[176:179]
    buffer_load_dwordx4 v1, s[20:23], s45 offen offset:1024 sc1 lds
    v_mfma_f32_16x16x32_bf16 v[180:183], a[32:35], v[84:87], v[180:183]
    v_mfma_f32_16x16x32_bf16 v[184:187], a[80:83], v[84:87], v[184:187]
    v_mfma_f32_16x16x32_bf16 v[188:191], a[128:131], v[84:87], v[188:191]
    v_mfma_f32_16x16x32_bf16 v[192:195], v[232:235], v[84:87], v[192:195]
    s_waitcnt lgkmcnt(2)
    buffer_load_dwordx4 v1, s[20:23], s45 offen offset:2048 sc1 lds
    v_mfma_f32_16x16x32_bf16 v[20:23], a[240:243], a[0:3], 0
    ds_read_b128 a[252:255], v2 offset:3072
    v_mfma_f32_16x16x32_bf16 v[24:27], a[240:243], a[48:51], 0
    v_cvt_pk_bf16_f32 v68, v44, v45
    v_cvt_pk_bf16_f32 v69, v46, v47
    v_mfma_f32_16x16x32_bf16 v[28:31], a[240:243], a[96:99], 0
    s_waitcnt lgkmcnt(2)
    ds_read_b128 a[240:243], v2 offset:4096
    v_cvt_pk_bf16_f32 v70, v56, v57
    v_mfma_f32_16x16x32_bf16 v[32:35], a[244:247], a[0:3], 0
    buffer_load_dwordx4 v1, s[20:23], s45 offen offset:3072 sc1 lds
    s_add_u32 s45, s29, 299008
    v_mfma_f32_16x16x32_bf16 v[36:39], a[244:247], a[48:51], 0
    s_add_u32 m0, s29, 4096
    v_cvt_pk_bf16_f32 v71, v58, v59
    v_cvt_pk_bf16_f32 v76, v48, v49
    v_mfma_f32_16x16x32_bf16 v[40:43], a[244:247], a[96:99], 0
    s_waitcnt lgkmcnt(2)
    ds_read_b128 a[244:247], v2 offset:5120
    v_cvt_pk_bf16_f32 v77, v50, v51
    v_mfma_f32_16x16x32_bf16 v[20:23], a[248:251], a[4:7], v[20:23]
    v_cvt_pk_bf16_f32 v78, v60, v61
    v_cvt_pk_bf16_f32 v79, v62, v63
    v_mfma_f32_16x16x32_bf16 v[24:27], a[248:251], a[52:55], v[24:27]
    buffer_load_dwordx4 v1, s[20:23], s45 offen offset:0 sc1 lds
    v_mfma_f32_16x16x32_bf16 v[28:31], a[248:251], a[100:103], v[28:31]
    s_waitcnt lgkmcnt(2)
    ds_read_b128 a[248:251], v2 offset:6144
    v_cvt_pk_bf16_f32 v84, v52, v53
    v_mfma_f32_16x16x32_bf16 v[32:35], a[252:255], a[4:7], v[32:35]
    ds_read_b128 v[236:239], v4 offset:576
    v_cvt_pk_bf16_f32 v85, v54, v55
    v_mfma_f32_16x16x32_bf16 v[36:39], a[252:255], a[52:55], v[36:39]
    v_cvt_pk_bf16_f32 v86, v64, v65
    v_cvt_pk_bf16_f32 v87, v66, v67
    v_mfma_f32_16x16x32_bf16 v[40:43], a[252:255], a[100:103], v[40:43]
    s_waitcnt lgkmcnt(3)
    ds_read_b128 a[252:255], v2 offset:7168
    v_mfma_f32_16x16x32_bf16 v[20:23], a[240:243], a[8:11], v[20:23]
    buffer_load_dwordx4 v1, s[20:23], s45 offen offset:1024 sc1 lds
    s_add_u32 s45, s29, 319488
    v_mfma_f32_16x16x32_bf16 v[24:27], a[240:243], a[56:59], v[24:27]
    s_add_u32 m0, s29, 24576
    v_mfma_f32_16x16x32_bf16 v[28:31], a[240:243], a[104:107], v[28:31]
    s_waitcnt lgkmcnt(3)
    ds_read_b128 a[240:243], v2 offset:8192
    v_mfma_f32_16x16x32_bf16 v[32:35], a[244:247], a[8:11], v[32:35]
    v_mfma_f32_16x16x32_bf16 v[36:39], a[244:247], a[56:59], v[36:39]
    buffer_load_dwordx4 v1, s[20:23], s45 offen offset:0 sc1 lds
    v_mfma_f32_16x16x32_bf16 v[40:43], a[244:247], a[104:107], v[40:43]
    s_waitcnt lgkmcnt(3)
    ds_read_b128 a[244:247], v2 offset:9216
    v_mfma_f32_16x16x32_bf16 v[20:23], a[248:251], a[12:15], v[20:23]
    v_mfma_f32_16x16x32_bf16 v[24:27], a[248:251], a[60:63], v[24:27]
    v_mfma_f32_16x16x32_bf16 v[28:31], a[248:251], a[108:111], v[28:31]
    s_waitcnt lgkmcnt(2)
    ds_read_b128 a[248:251], v2 offset:10240
    v_mfma_f32_16x16x32_bf16 v[32:35], a[252:255], a[12:15], v[32:35]
    buffer_load_dwordx4 v1, s[20:23], s45 offen offset:1024 sc1 lds
    v_mfma_f32_16x16x32_bf16 v[36:39], a[252:255], a[60:63], v[36:39]
    v_mfma_f32_16x16x32_bf16 v[40:43], a[252:255], a[108:111], v[40:43]
    s_waitcnt lgkmcnt(2)
    ds_read_b128 a[252:255], v2 offset:11264
    v_mfma_f32_16x16x32_bf16 v[20:23], a[240:243], a[16:19], v[20:23]
    v_mfma_f32_16x16x32_bf16 v[24:27], a[240:243], a[64:67], v[24:27]
    buffer_load_dwordx4 v1, s[20:23], s45 offen offset:2048 sc1 lds
    v_mfma_f32_16x16x32_bf16 v[28:31], a[240:243], a[112:115], v[28:31]
    s_waitcnt lgkmcnt(2)
    ds_read_b128 a[240:243], v2 offset:12288
    v_mfma_f32_16x16x32_bf16 v[32:35], a[244:247], a[16:19], v[32:35]
    v_mfma_f32_16x16x32_bf16 v[36:39], a[244:247], a[64:67], v[36:39]
    v_mfma_f32_16x16x32_bf16 v[40:43], a[244:247], a[112:115], v[40:43]
    s_waitcnt lgkmcnt(2)
    ds_read_b128 a[244:247], v2 offset:13312
    v_mfma_f32_16x16x32_bf16 v[20:23], a[248:251], a[20:23], v[20:23]
    buffer_load_dwordx4 v1, s[20:23], s45 offen offset:3072 sc1 lds
    s_add_u32 s45, s29, 323584
    v_mfma_f32_16x16x32_bf16 v[24:27], a[248:251], a[68:71], v[24:27]
    s_add_u32 m0, s29, 28672
    v_mfma_f32_16x16x32_bf16 v[28:31], a[248:251], a[116:119], v[28:31]
    s_waitcnt lgkmcnt(2)
    ds_read_b128 a[248:251], v2 offset:14336
    v_mfma_f32_16x16x32_bf16 v[32:35], a[252:255], a[20:23], v[32:35]
    v_mfma_f32_16x16x32_bf16 v[36:39], a[252:255], a[68:71], v[36:39]
    buffer_load_dwordx4 v1, s[20:23], s45 offen offset:0 sc1 lds
    v_mfma_f32_16x16x32_bf16 v[40:43], a[252:255], a[116:119], v[40:43]
    s_waitcnt lgkmcnt(2)
    ds_read_b128 a[252:255], v2 offset:15360
    v_mfma_f32_16x16x32_bf16 v[20:23], a[240:243], a[24:27], v[20:23]
    v_mfma_f32_16x16x32_bf16 v[24:27], a[240:243], a[72:75], v[24:27]
    v_mfma_f32_16x16x32_bf16 v[28:31], a[240:243], a[120:123], v[28:31]
    s_waitcnt lgkmcnt(2)
    ds_read_b128 a[240:243], v2 offset:16384
    v_mfma_f32_16x16x32_bf16 v[32:35], a[244:247], a[24:27], v[32:35]
    buffer_load_dwordx4 v1, s[20:23], s45 offen offset:1024 sc1 lds
    s_add_u32 s40, s36, 0
    v_mfma_f32_16x16x32_bf16 v[36:39], a[244:247], a[72:75], v[36:39]
    s_add_u32 m0, s32, 768
    v_mfma_f32_16x16x32_bf16 v[40:43], a[244:247], a[120:123], v[40:43]
    s_waitcnt lgkmcnt(2)
    ds_read_b128 a[244:247], v2 offset:17408
    v_mfma_f32_16x16x32_bf16 v[20:23], a[248:251], a[28:31], v[20:23]
    v_mfma_f32_16x16x32_bf16 v[24:27], a[248:251], a[76:79], v[24:27]
    v_mfma_f32_16x16x32_bf16 v[28:31], a[248:251], a[124:127], v[28:31]
    s_waitcnt lgkmcnt(2)
    ds_read_b128 a[248:251], v2 offset:18432
    v_mfma_f32_16x16x32_bf16 v[32:35], a[252:255], a[28:31], v[32:35]
    v_mfma_f32_16x16x32_bf16 v[36:39], a[252:255], a[76:79], v[36:39]
    v_mfma_f32_16x16x32_bf16 v[40:43], a[252:255], a[124:127], v[40:43]
    s_waitcnt lgkmcnt(2)
    ds_read_b128 a[252:255], v2 offset:19456
    v_mfma_f32_16x16x32_bf16 v[20:23], a[240:243], a[32:35], v[20:23]
    v_mfma_f32_16x16x32_bf16 v[24:27], a[240:243], a[80:83], v[24:27]
    v_mfma_f32_16x16x32_bf16 v[28:31], a[240:243], a[128:131], v[28:31]
    s_waitcnt lgkmcnt(2)
    ds_read_b128 a[240:243], v2 offset:20480
    v_mfma_f32_16x16x32_bf16 v[32:35], a[244:247], a[32:35], v[32:35]
    v_mfma_f32_16x16x32_bf16 v[36:39], a[244:247], a[80:83], v[36:39]
    v_mfma_f32_16x16x32_bf16 v[40:43], a[244:247], a[128:131], v[40:43]
    ds_read_b128 a[244:247], v2 offset:21504
    s_waitcnt vmcnt(12)
    v_readfirstlane_b32 s60, v0
    s_nop 1
    s_cmp_ge_u32 s60, 1
    s_cbranch_scc0 L_slow_q
L_back_q:
    s_waitcnt lgkmcnt(3)
    v_mfma_f32_16x16x32_bf16 v[20:23], a[248:251], a[36:39], v[20:23]
    s_mov_b64 exec, s[42:43]
    buffer_load_dwordx4 v1, s[20:23], s40 offen sc1 lds
    s_mov_b64 exec, -1
    v_mfma_f32_16x16x32_bf16 v[24:27], a[248:251], a[84:87], v[24:27]
    v_mfma_f32_16x16x32_bf16 v[28:31], a[248:251], a[132:135], v[28:31]
    s_waitcnt lgkmcnt(2)
    ds_read_b128 a[248:251], v2 offset:22528
    v_mfma_f32_16x16x32_bf16 v[32:35], a[252:255], a[36:39], v[32:35]
    v_mfma_f32_16x16x32_bf16 v[36:39], a[252:255], a[84:87], v[36:39]
    v_mfma_f32_16x16x32_bf16 v[40:43], a[252:255], a[132:135], v[40:43]
    s_waitcnt lgkmcnt(2)
    ds_read_b128 a[252:255], v2 offset:23552
    v_mfma_f32_16x16x32_bf16 v[20:23], a[240:243], a[40:43], v[20:23]
    v_mfma_f32_16x16x32_bf16 v[24:27], a[240:243], a[88:91], v[24:27]
    v_mfma_f32_16x16x32_bf16 v[28:31], a[240:243], a[136:139], v[28:31]
    s_waitcnt lgkmcnt(2)
    ds_read_b128 a[240:243], v2 offset:24576
    v_mfma_f32_16x16x32_bf16 v[32:35], a[244:247], a[40:43], v[32:35]
    v_mfma_f32_16x16x32_bf16 v[36:39], a[244:247], a[88:91], v[36:39]
    v_mfma_f32_16x16x32_bf16 v[40:43], a[244:247], a[136:139], v[40:43]
    s_waitcnt lgkmcnt(2)
    ds_read_b128 a[244:247], v2 offset:25600
    v_mfma_f32_16x16x32_bf16 v[20:23], a[248:251], a[44:47], v[20:23]
    v_mfma_f32_16x16x32_bf16 v[24:27], a[248:251], a[92:95], v[24:27]
    v_mfma_f32_16x16x32_bf16 v[28:31], a[248:251], a[140:143], v[28:31]
    s_waitcnt lgkmcnt(2)
    ds_read_b128 a[248:251], v2 offset:26624
    v_mfma_f32_16x16x32_bf16 v[32:35], a[252:255], a[44:47], v[32:35]
    v_mfma_f32_16x16x32_bf16 v[36:39], a[252:255], a[92:95], v[36:39]
    s_add_u32 m0, s31, -512
    v_mfma_f32_16x16x32_bf16 v[40:43], a[252:255], a[140:143], v[40:43]
    v_mfma_f32_16x16x32_bf16 v[148:151], a[36:39], v[68:71], v[148:151]
    v_mfma_f32_16x16x32_bf16 v[152:155], a[84:87], v[68:71], v[152:155]
    v_mfma_f32_16x16x32_bf16 v[156:159], a[132:135], v[68:71], v[156:159]
    v_mfma_f32_16x16x32_bf16 v[160:163], v[236:239], v[68:71], v[160:163]
    v_mfma_f32_16x16x32_bf16 v[164:167], a[36:39], v[76:79], v[164:167]
    v_mfma_f32_16x16x32_bf16 v[168:171], a[84:87], v[76:79], v[168:171]
    v_mfma_f32_16x16x32_bf16 v[172:175], a[132:135], v[76:79], v[172:175]
    v_mfma_f32_16x16x32_bf16 v[176:179], v[236:239], v[76:79], v[176:179]
    v_mfma_f32_16x16x32_bf16 v[180:183], a[36:39], v[84:87], v[180:183]
    v_mfma_f32_16x16x32_bf16 v[184:187], a[84:87], v[84:87], v[184:187]
    v_mfma_f32_16x16x32_bf16 v[188:191], a[132:135], v[84:87], v[188:191]
    v_mfma_f32_16x16x32_bf16 v[192:195], v[236:239], v[84:87], v[192:195]
    s_waitcnt lgkmcnt(2)
    v_mfma_f32_16x16x32_bf16 v[44:47], a[240:243], a[0:3], 0
    ds_read_b128 a[252:255], v2 offset:27648
    v_mfma_f32_16x16x32_bf16 v[48:51], a[240:243], a[48:51], 0
    v_cvt_pk_bf16_f32 v68, v20, v21
    v_cvt_pk_bf16_f32 v69, v22, v23
    v_mfma_f32_16x16x32_bf16 v[52:55], a[240:243], a[96:99], 0
    s_waitcnt lgkmcnt(2)
    ds_read_b128 a[240:243], v2 offset:28672
    v_cvt_pk_bf16_f32 v70, v32, v33
    v_mfma_f32_16x16x32_bf16 v[56:59], a[244:247], a[0:3], 0
    ds_read_b128 a[160:163], v3 offset:0
    v_cvt_pk_bf16_f32 v71, v34, v35
    v_mfma_f32_16x16x32_bf16 v[60:63], a[244:247], a[48:51], 0
    v_cvt_pk_bf16_f32 v76, v24, v25
    v_cvt_pk_bf16_f32 v77, v26, v27
    v_mfma_f32_16x16x32_bf16 v[64:67], a[244:247], a[96:99], 0
    s_waitcnt lgkmcnt(3)
    ds_read_b128 a[244:247], v2 offset:29696
    v_cvt_pk_bf16_f32 v78, v36, v37
    v_mfma_f32_16x16x32_bf16 v[44:47], a[248:251], a[4:7], v[44:47]
    ds_read_b128 a[164:167], v3 offset:64
    v_cvt_pk_bf16_f32 v79, v38, v39
    v_mfma_f32_16x16x32_bf16 v[48:51], a[248:251], a[52:55], v[48:51]
    v_cvt_pk_bf16_f32 v84, v28, v29
    v_cvt_pk_bf16_f32 v85, v30, v31
    v_mfma_f32_16x16x32_bf16 v[52:55], a[248:251], a[100:103], v[52:55]
    s_waitcnt lgkmcnt(4)
    ds_read_b128 a[248:251], v2 offset:30720
    v_cvt_pk_bf16_f32 v86, v40, v41
    v_mfma_f32_16x16x32_bf16 v[56:59], a[252:255], a[4:7], v[56:59]
    ds_read_b128 a[168:171], v3 offset:128
    v_cvt_pk_bf16_f32 v87, v42, v43
    v_mfma_f32_16x16x32_bf16 v[60:63], a[252:255], a[52:55], v[60:63]
    v_mfma_f32_16x16x32_bf16 v[64:67], a[252:255], a[100:103], v[64:67]
    s_waitcnt lgkmcnt(5)
    ds_read_b128 a[252:255], v2 offset:31744
    v_mfma_f32_16x16x32_bf16 v[44:47], a[240:243], a[8:11], v[44:47]
    ds_read_b128 a[172:175], v3 offset:192
    v_mfma_f32_16x16x32_bf16 v[48:51], a[240:243], a[56:59], v[48:51]
    v_mfma_f32_16x16x32_bf16 v[52:55], a[240:243], a[104:107], v[52:55]
    s_waitcnt lgkmcnt(5)
    ds_read_b128 a[240:243], v2 offset:32768
    v_mfma_f32_16x16x32_bf16 v[56:59], a[244:247], a[8:11], v[56:59]
    ds_read_b128 v[240:243], v4 offset:640
    v_mfma_f32_16x16x32_bf16 v[60:63], a[244:247], a[56:59], v[60:63]
    v_mfma_f32_16x16x32_bf16 v[64:67], a[244:247], a[104:107], v[64:67]
    s_waitcnt lgkmcnt(5)
    ds_read_b128 a[244:247], v2 offset:33792
    v_mfma_f32_16x16x32_bf16 v[44:47], a[248:251], a[12:15], v[44:47]
    v_mfma_f32_16x16x32_bf16 v[48:51], a[248:251], a[60:63], v[48:51]
    v_mfma_f32_16x16x32_bf16 v[52:55], a[248:251], a[108:111], v[52:55]
    s_waitcnt lgkmcnt(4)
    ds_read_b128 a[248:251], v2 offset:34816
    v_mfma_f32_16x16x32_bf16 v[56:59], a[252:255], a[12:15], v[56:59]
    s_waitcnt lgkmcnt(4)
    buffer_load_dwordx4 v7, s[16:19], s33 offen offset:512 nt lds
    s_add_u32 m0, s31, 576
    v_mfma_f32_16x16x32_bf16 v[60:63], a[252:255], a[60:63], v[60:63]
    ds_read_b128 v[232:235], v4 offset:0
    v_mfma_f32_16x16x32_bf16 v[64:67], a[252:255], a[108:111], v[64:67]
    s_waitcnt lgkmcnt(4)
    ds_read_b128 a[252:255], v2 offset:35840
    v_mfma_f32_16x16x32_bf16 v[44:47], a[240:243], a[16:19], v[44:47]
    ds_read_b128 v[236:239], v4 offset:64
    v_mfma_f32_16x16x32_bf16 v[48:51], a[240:243], a[64:67], v[48:51]
    buffer_load_dwordx4 v8, s[16:19], s33 offen offset:512 nt lds
    s_add_u32 m0, s31, 1664
    v_mfma_f32_16x16x32_bf16 v[52:55], a[240:243], a[112:115], v[52:55]
    s_waitcnt lgkmcnt(4)
    ds_read_b128 a[240:243], v2 offset:36864
    v_mfma_f32_16x16x32_bf16 v[56:59], a[244:247], a[16:19], v[56:59]
    ds_read_b128 v[244:247], v4 offset:192
    v_mfma_f32_16x16x32_bf16 v[60:63], a[244:247], a[64:67], v[60:63]
    v_mfma_f32_16x16x32_bf16 v[64:67], a[244:247], a[112:115], v[64:67]
    s_waitcnt lgkmcnt(5)
    ds_read_b128 a[244:247], v2 offset:37888
    v_mfma_f32_16x16x32_bf16 v[44:47], a[248:251], a[20:23], v[44:47]
    buffer_load_dwordx4 v9, s[16:19], s33 offen offset:512 nt lds
    s_add_u32 m0, s31, 2752
    v_mfma_f32_16x16x32_bf16 v[48:51], a[248:251], a[68:71], v[48:51]
    v_mfma_f32_16x16x32_bf16 v[52:55], a[248:251], a[116:119], v[52:55]
    s_waitcnt lgkmcnt(4)
    ds_read_b128 a[248:251], v2 offset:38912
    v_mfma_f32_16x16x32_bf16 v[56:59], a[252:255], a[20:23], v[56:59]
    v_mfma_f32_16x16x32_bf16 v[60:63], a[252:255], a[68:71], v[60:63]
    buffer_load_dwordx4 v10, s[16:19], s33 offen offset:512 nt lds
    v_mfma_f32_16x16x32_bf16 v[64:67], a[252:255], a[116:119], v[64:67]
    s_waitcnt lgkmcnt(3)
    ds_read_b128 a[252:255], v2 offset:39936
    v_mfma_f32_16x16x32_bf16 v[44:47], a[240:243], a[24:27], v[44:47]
    v_mfma_f32_16x16x32_bf16 v[48:51], a[240:243], a[72:75], v[48:51]
    v_mfma_f32_16x16x32_bf16 v[52:55], a[240:243], a[120:123], v[52:55]
    s_waitcnt lgkmcnt(2)
    ds_read_b128 a[240:243], v2 offset:40960
    v_mfma_f32_16x16x32_bf16 v[56:59], a[244:247], a[24:27], v[56:59]
    v_mfma_f32_16x16x32_bf16 v[60:63], a[244:247], a[72:75], v[60:63]
    v_mfma_f32_16x16x32_bf16 v[64:67], a[244:247], a[120:123], v[64:67]
    s_waitcnt lgkmcnt(2)
    ds_read_b128 a[244:247], v2 offset:41984
    v_mfma_f32_16x16x32_bf16 v[44:47], a[248:251], a[28:31], v[44:47]
    v_mfma_f32_16x16x32_bf16 v[48:51], a[248:251], a[76:79], v[48:51]
    v_mfma_f32_16x16x32_bf16 v[52:55], a[248:251], a[124:127], v[52:55]
    s_waitcnt lgkmcnt(2)
    ds_read_b128 a[248:251], v2 offset:43008
    v_mfma_f32_16x16x32_bf16 v[56:59], a[252:255], a[28:31], v[56:59]
    s_waitcnt vmcnt(4)
    ds_read_b128 v[116:119], v4 offset:768
    v_mfma_f32_16x16x32_bf16 v[60:63], a[252:255], a[76:79], v[60:63]
    v_mfma_f32_16x16x32_bf16 v[64:67], a[252:255], a[124:127], v[64:67]
    s_waitcnt lgkmcnt(3)
    ds_read_b128 a[252:255], v2 offset:44032
    v_mfma_f32_16x16x32_bf16 v[44:47], a[240:243], a[32:35], v[44:47]
    ds_read_b128 v[120:123], v4 offset:832
    v_mfma_f32_16x16x32_bf16 v[48:51], a[240:243], a[80:83], v[48:51]
    v_mfma_f32_16x16x32_bf16 v[52:55], a[240:243], a[128:131], v[52:55]
    s_waitcnt lgkmcnt(4)
    ds_read_b128 a[240:243], v2 offset:45056
    v_mfma_f32_16x16x32_bf16 v[56:59], a[244:247], a[32:35], v[56:59]
    ds_read_b128 v[124:127], v4 offset:896
    v_mfma_f32_16x16x32_bf16 v[60:63], a[244:247], a[80:83], v[60:63]
    v_mfma_f32_16x16x32_bf16 v[64:67], a[244:247], a[128:131], v[64:67]
    s_waitcnt lgkmcnt(5)
    ds_read_b128 a[244:247], v2 offset:46080
    v_mfma_f32_16x16x32_bf16 v[44:47], a[248:251], a[36:39], v[44:47]
    ds_read_b128 v[128:131], v4 offset:960
    v_mfma_f32_16x16x32_bf16 v[48:51], a[248:251], a[84:87], v[48:51]
    v_mfma_f32_16x16x32_bf16 v[52:55], a[248:251], a[132:135], v[52:55]
    s_waitcnt lgkmcnt(5)
    ds_read_b128 a[248:251], v2 offset:47104
    v_mfma_f32_16x16x32_bf16 v[56:59], a[252:255], a[36:39], v[56:59]
    ds_read_b128 v[132:135], v4 offset:1024
    v_mfma_f32_16x16x32_bf16 v[60:63], a[252:255], a[84:87], v[60:63]
    v_mfma_f32_16x16x32_bf16 v[64:67], a[252:255], a[132:135], v[64:67]
    s_waitcnt lgkmcnt(5)
    ds_read_b128 a[252:255], v2 offset:48128
    v_mfma_f32_16x16x32_bf16 v[44:47], a[240:243], a[40:43], v[44:47]
    ds_read_b128 v[136:139], v4 offset:1088
    v_mfma_f32_16x16x32_bf16 v[48:51], a[240:243], a[88:91], v[48:51]
    v_mfma_f32_16x16x32_bf16 v[52:55], a[240:243], a[136:139], v[52:55]
    s_waitcnt lgkmcnt(5)
    v_mfma_f32_16x16x32_bf16 v[56:59], a[244:247], a[40:43], v[56:59]
    ds_read_b128 v[140:143], v4 offset:1152
    v_mfma_f32_16x16x32_bf16 v[60:63], a[244:247], a[88:91], v[60:63]
    v_mfma_f32_16x16x32_bf16 v[64:67], a[244:247], a[136:139], v[64:67]
    s_waitcnt lgkmcnt(4)
    v_mfma_f32_16x16x32_bf16 v[44:47], a[248:251], a[44:47], v[44:47]
    ds_read_b128 v[144:147], v4 offset:1216
    v_mfma_f32_16x16x32_bf16 v[48:51], a[248:251], a[92:95], v[48:51]
    v_mfma_f32_16x16x32_bf16 v[52:55], a[248:251], a[140:143], v[52:55]
    s_waitcnt lgkmcnt(3)
    s_barrier
    ds_read_b128 a[240:243], v1 offset:0
    v_mfma_f32_16x16x32_bf16 v[56:59], a[252:255], a[44:47], v[56:59]
    ds_read_b128 a[244:247], v1 offset:1024
    v_mfma_f32_16x16x32_bf16 v[60:63], a[252:255], a[92:95], v[60:63]
    s_add_u32 s45, s29, 344064
    s_add_u32 m0, s29, 49152
    ds_read_b128 a[248:251], v1 offset:2048
    v_mfma_f32_16x16x32_bf16 v[64:67], a[252:255], a[140:143], v[64:67]
    buffer_load_dwordx4 v1, s[20:23], s45 offen offset:0 sc1 lds
    v_mfma_f32_16x16x32_bf16 v[148:151], a[40:43], v[68:71], v[148:151]
    ds_read_b128 v[212:215], v4 offset:1280
    v_mfma_f32_16x16x32_bf16 v[152:155], a[88:91], v[68:71], v[152:155]
    v_mfma_f32_16x16x32_bf16 v[156:159], a[136:139], v[68:71], v[156:159]
    v_mfma_f32_16x16x32_bf16 v[160:163], v[240:243], v[68:71], v[160:163]
    buffer_load_dwordx4 v1, s[20:23], s45 offen offset:1024 sc1 lds
    v_mfma_f32_16x16x32_bf16 v[164:167], a[40:43], v[76:79], v[164:167]
    ds_read_b128 v[216:219], v4 offset:1344
    v_mfma_f32_16x16x32_bf16 v[168:171], a[88:91], v[76:79], v[168:171]
    v_cvt_pk_bf16_f32 v68, v44, v45
    v_cvt_pk_bf16_f32 v69, v46, v47
    v_mfma_f32_16x16x32_bf16 v[172:175], a[136:139], v[76:79], v[172:175]
    v_cvt_pk_bf16_f32 v70, v56, v57
    v_cvt_pk_bf16_f32 v71, v58, v59
    v_mfma_f32_16x16x32_bf16 v[176:179], v[240:243], v[76:79], v[176:179]
    buffer_load_dwordx4 v1, s[20:23], s45 offen offset:2048 sc1 lds
    v_mfma_f32_16x16x32_bf16 v[180:183], a[40:43], v[84:87], v[180:183]
    ds_read_b128 v[220:223], v4 offset:1408
    v_mfma_f32_16x16x32_bf16 v[184:187], a[88:91], v[84:87], v[184:187]
    v_cvt_pk_bf16_f32 v76, v48, v49
    v_cvt_pk_bf16_f32 v77, v50, v51
    v_mfma_f32_16x16x32_bf16 v[188:191], a[136:139], v[84:87], v[188:191]
    v_cvt_pk_bf16_f32 v78, v60, v61
    v_cvt_pk_bf16_f32 v79, v62, v63
    v_mfma_f32_16x16x32_bf16 v[192:195], v[240:243], v[84:87], v[192:195]
    ds_read_b128 v[240:243], v4 offset:128
    v_mfma_f32_16x16x32_bf16 v[196:199], a[0:3], v[116:119], 0
    buffer_load_dwordx4 v1, s[20:23], s45 offen offset:3072 sc1 lds
    s_add_u32 s45, s29, 348160
    v_mfma_f32_16x16x32_bf16 v[200:203], a[48:51], v[116:119], 0
    s_add_u32 m0, s29, 53248
    ds_read_b128 v[224:227], v4 offset:1472
    v_cvt_pk_bf16_f32 v84, v52, v53
    v_mfma_f32_16x16x32_bf16 v[204:207], a[96:99], v[116:119], 0
    v_cvt_pk_bf16_f32 v85, v54, v55
    v_cvt_pk_bf16_f32 v86, v64, v65
    v_mfma_f32_16x16x32_bf16 v[208:211], v[232:235], v[116:119], 0
    ds_read_b128 v[232:235], v4 offset:256
    v_cvt_pk_bf16_f32 v87, v66, v67
    v_mfma_f32_16x16x32_bf16 v[196:199], a[4:7], v[120:123], v[196:199]
    buffer_load_dwordx4 v1, s[20:23], s45 offen offset:0 sc1 lds
    v_mfma_f32_16x16x32_bf16 v[200:203], a[52:55], v[120:123], v[200:203]
    v_mfma_f32_16x16x32_bf16 v[204:207], a[100:103], v[120:123], v[204:207]
    v_mfma_f32_16x16x32_bf16 v[208:211], v[236:239], v[120:123], v[208:211]
    ds_read_b128 v[236:239], v4 offset:320
    v_mfma_f32_16x16x32_bf16 v[196:199], a[8:11], v[124:127], v[196:199]
    buffer_load_dwordx4 v1, s[20:23], s45 offen offset:1024 sc1 lds
    s_add_u32 s45, s29, 368640
    v_mfma_f32_16x16x32_bf16 v[200:203], a[56:59], v[124:127], v[200:203]
    s_add_u32 m0, s29, 73728
    v_mfma_f32_16x16x32_bf16 v[204:207], a[104:107], v[124:127], v[204:207]
    s_waitcnt lgkmcnt(3)
    v_mfma_f32_16x16x32_bf16 v[208:211], v[240:243], v[124:127], v[208:211]
    ds_read_b128 v[240:243], v4 offset:384
    v_mfma_f32_16x16x32_bf16 v[196:199], a[12:15], v[128:131], v[196:199]
    buffer_load_dwordx4 v1, s[20:23], s45 offen offset:0 sc1 lds
    v_mfma_f32_16x16x32_bf16 v[200:203], a[60:63], v[128:131], v[200:203]
    v_mfma_f32_16x16x32_bf16 v[204:207], a[108:111], v[128:131], v[204:207]
    v_mfma_f32_16x16x32_bf16 v[208:211], v[244:247], v[128:131], v[208:211]
    ds_read_b128 v[244:247], v4 offset:448
    v_mfma_f32_16x16x32_bf16 v[196:199], a[16:19], v[132:135], v[196:199]
    buffer_load_dwordx4 v1, s[20:23], s45 offen offset:1024 sc1 lds
    v_mfma_f32_16x16x32_bf16 v[200:203], a[64:67], v[132:135], v[200:203]
    v_mfma_f32_16x16x32_bf16 v[204:207], a[112:115], v[132:135], v[204:207]
    s_waitcnt lgkmcnt(3)
    v_mfma_f32_16x16x32_bf16 v[208:211], v[232:235], v[132:135], v[208:211]
    ds_read_b128 v[232:235], v4 offset:512
    v_mfma_f32_16x16x32_bf16 v[196:199], a[20:23], v[136:139], v[196:199]
    buffer_load_dwordx4 v1, s[20:23], s45 offen offset:2048 sc1 lds
    v_mfma_f32_16x16x32_bf16 v[200:203], a[68:71], v[136:139], v[200:203]
    v_mfma_f32_16x16x32_bf16 v[204:207], a[116:119], v[136:139], v[204:207]
    s_waitcnt lgkmcnt(3)
    v_mfma_f32_16x16x32_bf16 v[208:211], v[236:239], v[136:139], v[208:211]
    ds_read_b128 v[236:239], v4 offset:576
    v_mfma_f32_16x16x32_bf16 v[196:199], a[24:27], v[140:143], v[196:199]
    buffer_load_dwordx4 v1, s[20:23], s45 offen offset:3072 sc1 lds
    s_add_u32 s45, s29, 372736
    v_mfma_f32_16x16x32_bf16 v[200:203], a[72:75], v[140:143], v[200:203]
    s_add_u32 m0, s29, 77824
    v_mfma_f32_16x16x32_bf16 v[204:207], a[120:123], v[140:143], v[204:207]
    s_waitcnt lgkmcnt(3)
    v_mfma_f32_16x16x32_bf16 v[208:211], v[240:243], v[140:143], v[208:211]
    ds_read_b128 v[240:243], v4 offset:640
    v_mfma_f32_16x16x32_bf16 v[196:199], a[28:31], v[144:147], v[196:199]
    buffer_load_dwordx4 v1, s[20:23], s45 offen offset:0 sc1 lds
    v_mfma_f32_16x16x32_bf16 v[200:203], a[76:79], v[144:147], v[200:203]
    v_mfma_f32_16x16x32_bf16 v[204:207], a[124:127], v[144:147], v[204:207]
    s_waitcnt lgkmcnt(3)
    v_mfma_f32_16x16x32_bf16 v[208:211], v[244:247], v[144:147], v[208:211]
    ds_read_b128 v[244:247], v4 offset:704
    v_mfma_f32_16x16x32_bf16 v[196:199], a[32:35], v[212:215], v[196:199]
    buffer_load_dwordx4 v1, s[20:23], s45 offen offset:1024 sc1 lds
    s_add_u32 m0, s31, 3840
    v_mfma_f32_16x16x32_bf16 v[200:203], a[80:83], v[212:215], v[200:203]
    v_mfma_f32_16x16x32_bf16 v[204:207], a[128:131], v[212:215], v[204:207]
    s_waitcnt lgkmcnt(3)
    v_mfma_f32_16x16x32_bf16 v[208:211], v[232:235], v[212:215], v[208:211]
    v_mfma_f32_16x16x32_bf16 v[196:199], a[36:39], v[216:219], v[196:199]
    v_mfma_f32_16x16x32_bf16 v[200:203], a[84:87], v[216:219], v[200:203]
    v_mfma_f32_16x16x32_bf16 v[204:207], a[132:135], v[216:219], v[204:207]
    s_waitcnt lgkmcnt(2)
    v_mfma_f32_16x16x32_bf16 v[208:211], v[236:239], v[216:219], v[208:211]
    v_mfma_f32_16x16x32_bf16 v[196:199], a[40:43], v[220:223], v[196:199]
    v_mfma_f32_16x16x32_bf16 v[200:203], a[88:91], v[220:223], v[200:203]
    v_mfma_f32_16x16x32_bf16 v[204:207], a[136:139], v[220:223], v[204:207]
    s_waitcnt lgkmcnt(1)
    v_mfma_f32_16x16x32_bf16 v[208:211], v[240:243], v[220:223], v[208:211]
    v_mfma_f32_16x16x32_bf16 v[196:199], a[44:47], v[224:227], v[196:199]
    v_mfma_f32_16x16x32_bf16 v[200:203], a[92:95], v[224:227], v[200:203]
    v_mfma_f32_16x16x32_bf16 v[204:207], a[140:143], v[224:227], v[204:207]
    s_waitcnt lgkmcnt(0)
    v_mfma_f32_16x16x32_bf16 v[208:211], v[244:247], v[224:227], v[208:211]
    v_mfma_f32_16x16x32_bf16 v[148:151], a[44:47], v[68:71], v[148:151]
    v_mfma_f32_16x16x32_bf16 v[152:155], a[92:95], v[68:71], v[152:155]
    v_mfma_f32_16x16x32_bf16 v[156:159], a[140:143], v[68:71], v[156:159]
    v_mfma_f32_16x16x32_bf16 v[160:163], v[244:247], v[68:71], v[160:163]
    v_mfma_f32_16x16x32_bf16 v[164:167], a[44:47], v[76:79], v[164:167]
    v_mfma_f32_16x16x32_bf16 v[168:171], a[92:95], v[76:79], v[168:171]
    v_mfma_f32_16x16x32_bf16 v[172:175], a[140:143], v[76:79], v[172:175]
    v_mfma_f32_16x16x32_bf16 v[176:179], v[244:247], v[76:79], v[176:179]
    v_mfma_f32_16x16x32_bf16 v[180:183], a[44:47], v[84:87], v[180:183]
    v_mfma_f32_16x16x32_bf16 v[184:187], a[92:95], v[84:87], v[184:187]
    v_mfma_f32_16x16x32_bf16 v[188:191], a[140:143], v[84:87], v[188:191]
    v_mfma_f32_16x16x32_bf16 v[192:195], v[244:247], v[84:87], v[192:195]
    v_mfma_f32_16x16x32_bf16 v[20:23], a[0:3], a[240:243], 0
    ds_read_b128 a[252:255], v1 offset:3072
    v_mfma_f32_16x16x32_bf16 v[24:27], a[48:51], a[240:243], 0
    v_mfma_f32_16x16x32_bf16 v[28:31], a[96:99], a[240:243], 0
    ds_read_b128 a[240:243], v1 offset:4096
    v_mfma_f32_16x16x32_bf16 v[32:35], a[0:3], a[244:247], 0
    ds_read_b128 a[192:195], v3 offset:4352
    v_mfma_f32_16x16x32_bf16 v[36:39], a[48:51], a[244:247], 0
    v_mfma_f32_16x16x32_bf16 v[40:43], a[96:99], a[244:247], 0
    ds_read_b128 a[244:247], v1 offset:5120
    v_mfma_f32_16x16x32_bf16 v[20:23], a[4:7], a[248:251], v[20:23]
    ds_read_b128 a[196:199], v3 offset:4416
    v_mfma_f32_16x16x32_bf16 v[24:27], a[52:55], a[248:251], v[24:27]
    v_mfma_f32_16x16x32_bf16 v[28:31], a[100:103], a[248:251], v[28:31]
    s_waitcnt lgkmcnt(4)
    ds_read_b128 a[248:251], v1 offset:6144
    v_max3_f32 v248, v148, v149, v150
    v_mfma_f32_16x16x32_bf16 v[32:35], a[4:7], a[252:255], v[32:35]
    ds_read_b128 a[200:203], v3 offset:4480
    v_max3_f32 v249, v164, v165, v166
    v_mfma_f32_16x16x32_bf16 v[36:39], a[52:55], a[252:255], v[36:39]
    v_max3_f32 v250, v180, v181, v182
    v_max3_f32 v251, v196, v197, v198
    v_mfma_f32_16x16x32_bf16 v[40:43], a[100:103], a[252:255], v[40:43]
    s_waitcnt lgkmcnt(5)
    ds_read_b128 a[252:255], v1 offset:7168
    v_max3_f32 v248, v248, v151, v152
    v_mfma_f32_16x16x32_bf16 v[20:23], a[8:11], a[240:243], v[20:23]
    ds_read_b128 a[204:207], v3 offset:4544
    v_max3_f32 v249, v249, v167, v168
    v_mfma_f32_16x16x32_bf16 v[24:27], a[56:59], a[240:243], v[24:27]
    v_max3_f32 v250, v250, v183, v184
    v_max3_f32 v251, v251, v199, v200
    v_mfma_f32_16x16x32_bf16 v[28:31], a[104:107], a[240:243], v[28:31]
    s_waitcnt lgkmcnt(5)
    ds_read_b128 a[240:243], v1 offset:8192
    v_max3_f32 v248, v248, v153, v154
    v_mfma_f32_16x16x32_bf16 v[32:35], a[8:11], a[244:247], v[32:35]
    v_max3_f32 v249, v249, v169, v170
    v_max3_f32 v250, v250, v185, v186
    v_mfma_f32_16x16x32_bf16 v[36:39], a[56:59], a[244:247], v[36:39]
    v_max3_f32 v251, v251, v201, v202
    v_max3_f32 v248, v248, v155, v156
    v_mfma_f32_16x16x32_bf16 v[40:43], a[104:107], a[244:247], v[40:43]
    s_waitcnt lgkmcnt(4)
    ds_read_b128 a[244:247], v1 offset:9216
    v_max3_f32 v249, v249, v171, v172
    v_mfma_f32_16x16x32_bf16 v[20:23], a[12:15], a[248:251], v[20:23]
    v_max3_f32 v250, v250, v187, v188
    v_max3_f32 v251, v251, v203, v204
    v_mfma_f32_16x16x32_bf16 v[24:27], a[60:63], a[248:251], v[24:27]
    v_add_f32 v160, v160, v6
    v_max3_f32 v248, v248, v157, v158
    v_mfma_f32_16x16x32_bf16 v[28:31], a[108:111], a[248:251], v[28:31]
    s_waitcnt lgkmcnt(3)
    ds_read_b128 a[248:251], v1 offset:10240
    v_add_f32 v176, v176, v6
    v_mfma_f32_16x16x32_bf16 v[32:35], a[12:15], a[252:255], v[32:35]
    s_waitcnt lgkmcnt(3)
    buffer_load_dwordx4 v11, s[16:19], s33 offen offset:512 nt lds
    s_add_u32 m0, s31, 4928
    v_mfma_f32_16x16x32_bf16 v[36:39], a[60:63], a[252:255], v[36:39]
    v_max3_f32 v249, v249, v173, v174
    v_add_f32 v192, v192, v6
    v_mfma_f32_16x16x32_bf16 v[40:43], a[108:111], a[252:255], v[40:43]
    s_waitcnt lgkmcnt(2)
    ds_read_b128 a[252:255], v1 offset:11264
    v_max3_f32 v250, v250, v189, v190
    v_mfma_f32_16x16x32_bf16 v[20:23], a[16:19], a[240:243], v[20:23]
    v_add_f32 v208, v208, v6
    v_max3_f32 v251, v251, v205, v206
    v_mfma_f32_16x16x32_bf16 v[24:27], a[64:67], a[240:243], v[24:27]
    buffer_load_dwordx4 v12, s[16:19], s33 offen offset:512 nt lds
    s_add_u32 m0, s31, 6016
    v_mfma_f32_16x16x32_bf16 v[28:31], a[112:115], a[240:243], v[28:31]
    s_waitcnt lgkmcnt(2)
    ds_read_b128 a[240:243], v1 offset:12288
    v_max3_f32 v248, v248, v159, v160
    v_mfma_f32_16x16x32_bf16 v[32:35], a[16:19], a[244:247], v[32:35]
    v_max3_f32 v249, v249, v175, v176
    v_max3_f32 v250, v250, v191, v192
    v_mfma_f32_16x16x32_bf16 v[36:39], a[64:67], a[244:247], v[36:39]
    v_max3_f32 v251, v251, v207, v208
    v_mfma_f32_16x16x32_bf16 v[40:43], a[112:115], a[244:247], v[40:43]
    s_waitcnt lgkmcnt(2)
    ds_read_b128 a[244:247], v1 offset:13312
    v_permlane32_swap_b32 v248, v249
    v_mfma_f32_16x16x32_bf16 v[20:23], a[20:23], a[248:251], v[20:23]
    buffer_load_dwordx4 v13, s[16:19], s33 offen offset:512 nt lds
    s_add_u32 m0, s31, 7104
    v_mfma_f32_16x16x32_bf16 v[24:27], a[68:71], a[248:251], v[24:27]
    v_permlane32_swap_b32 v250, v251
    v_max_f32 v248, v248, v249
    v_mfma_f32_16x16x32_bf16 v[28:31], a[116:119], a[248:251], v[28:31]
    s_waitcnt lgkmcnt(2)
    ds_read_b128 a[248:251], v1 offset:14336
    v_max_f32 v250, v250, v251
    v_mfma_f32_16x16x32_bf16 v[32:35], a[20:23], a[252:255], v[32:35]
    v_mfma_f32_16x16x32_bf16 v[36:39], a[68:71], a[252:255], v[36:39]
    buffer_load_dwordx4 v14, s[16:19], s33 offen offset:512 nt lds
    v_mfma_f32_16x16x32_bf16 v[40:43], a[116:119], a[252:255], v[40:43]
    s_waitcnt lgkmcnt(2)
    ds_read_b128 a[252:255], v1 offset:15360
    v_permlane16_swap_b32 v248, v250
    v_mfma_f32_16x16x32_bf16 v[20:23], a[24:27], a[240:243], v[20:23]
    v_max_f32 v248, v248, v250
    v_mfma_f32_16x16x32_bf16 v[24:27], a[72:75], a[240:243], v[24:27]
    v_mov_b32 v250, v248
    v_mfma_f32_16x16x32_bf16 v[28:31], a[120:123], a[240:243], v[28:31]
    s_waitcnt lgkmcnt(2)
    ds_read_b128 a[240:243], v1 offset:16384
    v_mfma_f32_16x16x32_bf16 v[32:35], a[24:27], a[244:247], v[32:35]
    v_permlane16_swap_b32 v248, v250
    v_mfma_f32_16x16x32_bf16 v[36:39], a[72:75], a[244:247], v[36:39]
    v_mov_b32 v249, v248
    v_mov_b32 v251, v250
    v_mfma_f32_16x16x32_bf16 v[40:43], a[120:123], a[244:247], v[40:43]
    s_waitcnt lgkmcnt(2)
    ds_read_b128 a[244:247], v1 offset:17408
    v_mfma_f32_16x16x32_bf16 v[20:23], a[28:31], a[248:251], v[20:23]
    v_permlane32_swap_b32 v248, v249
    v_permlane32_swap_b32 v250, v251
    v_mfma_f32_16x16x32_bf16 v[24:27], a[76:79], a[248:251], v[24:27]
    v_sub_f32 v148, v148, v248
    v_sub_f32 v149, v149, v248
    v_mfma_f32_16x16x32_bf16 v[28:31], a[124:127], a[248:251], v[28:31]
    s_waitcnt lgkmcnt(2)
    ds_read_b128 a[248:251], v1 offset:18432
    v_sub_f32 v164, v164, v249
    v_mfma_f32_16x16x32_bf16 v[32:35], a[28:31], a[252:255], v[32:35]
    v_sub_f32 v165, v165, v249
    v_sub_f32 v180, v180, v250
    v_mfma_f32_16x16x32_bf16 v[36:39], a[76:79], a[252:255], v[36:39]
    v_sub_f32 v181, v181, v250
    v_sub_f32 v196, v196, v251
    v_mfma_f32_16x16x32_bf16 v[40:43], a[124:127], a[252:255], v[40:43]
    s_waitcnt lgkmcnt(2)
    ds_read_b128 a[252:255], v1 offset:19456
    v_sub_f32 v197, v197, v251
    v_mfma_f32_16x16x32_bf16 v[20:23], a[32:35], a[240:243], v[20:23]
    v_exp_f32 v148, v148
    v_mfma_f32_16x16x32_bf16 v[24:27], a[80:83], a[240:243], v[24:27]
    v_exp_f32 v149, v149
    v_mfma_f32_16x16x32_bf16 v[28:31], a[128:131], a[240:243], v[28:31]
    s_waitcnt lgkmcnt(2)
    ds_read_b128 a[240:243], v1 offset:20480
    v_sub_f32 v150, v150, v248
    v_mfma_f32_16x16x32_bf16 v[32:35], a[32:35], a[244:247], v[32:35]
    v_exp_f32 v164, v164
    v_mfma_f32_16x16x32_bf16 v[36:39], a[80:83], a[244:247], v[36:39]
    v_exp_f32 v165, v165
    v_mfma_f32_16x16x32_bf16 v[40:43], a[128:131], a[244:247], v[40:43]
    s_waitcnt lgkmcnt(2)
    ds_read_b128 a[244:247], v1 offset:21504
    v_sub_f32 v166, v166, v249
    v_mfma_f32_16x16x32_bf16 v[20:23], a[36:39], a[248:251], v[20:23]
    v_exp_f32 v180, v180
    v_mfma_f32_16x16x32_bf16 v[24:27], a[84:87], a[248:251], v[24:27]
    v_exp_f32 v181, v181
    v_mfma_f32_16x16x32_bf16 v[28:31], a[132:135], a[248:251], v[28:31]
    s_waitcnt lgkmcnt(2)
    ds_read_b128 a[248:251], v1 offset:22528
    v_sub_f32 v182, v182, v250
    v_mfma_f32_16x16x32_bf16 v[32:35], a[36:39], a[252:255], v[32:35]
    v_exp_f32 v196, v196
    v_mfma_f32_16x16x32_bf16 v[36:39], a[84:87], a[252:255], v[36:39]
    v_exp_f32 v197, v197
    v_mfma_f32_16x16x32_bf16 v[40:43], a[132:135], a[252:255], v[40:43]
    s_waitcnt lgkmcnt(2)
    ds_read_b128 a[252:255], v1 offset:23552
    v_sub_f32 v198, v198, v251
    v_mfma_f32_16x16x32_bf16 v[20:23], a[40:43], a[240:243], v[20:23]
    v_exp_f32 v150, v150
    v_mfma_f32_16x16x32_bf16 v[24:27], a[88:91], a[240:243], v[24:27]
    v_sub_f32 v151, v151, v248
    v_add_f32 v252, v148, v149
    v_mfma_f32_16x16x32_bf16 v[28:31], a[136:139], a[240:243], v[28:31]
    s_waitcnt lgkmcnt(2)
    ds_read_b128 a[240:243], v1 offset:24576
    v_sub_f32 v167, v167, v249
    v_mfma_f32_16x16x32_bf16 v[32:35], a[40:43], a[244:247], v[32:35]
    v_exp_f32 v166, v166
    v_mfma_f32_16x16x32_bf16 v[36:39], a[88:91], a[244:247], v[36:39]
    v_add_f32 v253, v164, v165
    v_sub_f32 v183, v183, v250
    v_mfma_f32_16x16x32_bf16 v[40:43], a[136:139], a[244:247], v[40:43]
    s_waitcnt lgkmcnt(2)
    ds_read_b128 a[244:247], v1 offset:25600
    v_add_f32 v254, v180, v181
    v_mfma_f32_16x16x32_bf16 v[20:23], a[44:47], a[248:251], v[20:23]
    v_exp_f32 v182, v182
    v_mfma_f32_16x16x32_bf16 v[24:27], a[92:95], a[248:251], v[24:27]
    s_add_u32 m0, s31, 8192
    v_exp_f32 v198, v198
    v_mfma_f32_16x16x32_bf16 v[28:31], a[140:143], a[248:251], v[28:31]
    s_waitcnt lgkmcnt(2)
    ds_read_b128 a[248:251], v1 offset:26624
    v_sub_f32 v199, v199, v251
    v_mfma_f32_16x16x32_bf16 v[32:35], a[44:47], a[252:255], v[32:35]
    buffer_load_ubyte v0, off, s[48:51], s37 sc1
    v_mfma_f32_16x16x32_bf16 v[36:39], a[92:95], a[252:255], v[36:39]
    v_add_f32 v255, v196, v197
    v_sub_f32 v152, v152, v248
    v_mfma_f32_16x16x32_bf16 v[40:43], a[140:143], a[252:255], v[40:43]
    s_waitcnt lgkmcnt(2)
    v_exp_f32 v151, v151
    v_mfma_f32_16x16x32_bf16 v[44:47], a[0:3], a[240:243], 0
    ds_read_b128 a[252:255], v1 offset:27648
    v_add_f32 v252, v252, v150
    v_mfma_f32_16x16x32_bf16 v[48:51], a[48:51], a[240:243], 0
    v_exp_f32 v167, v167
    v_mfma_f32_16x16x32_bf16 v[52:55], a[96:99], a[240:243], 0
    s_waitcnt lgkmcnt(2)
    ds_read_b128 a[240:243], v1 offset:28672
    v_sub_f32 v168, v168, v249
    v_mfma_f32_16x16x32_bf16 v[56:59], a[0:3], a[244:247], 0
    ds_read_b128 a[224:227], v3 offset:8704
    v_add_f32 v253, v253, v166
    v_mfma_f32_16x16x32_bf16 v[60:63], a[48:51], a[244:247], 0
    v_exp_f32 v183, v183
    v_mfma_f32_16x16x32_bf16 v[64:67], a[96:99], a[244:247], 0
    s_waitcnt lgkmcnt(3)
    ds_read_b128 a[244:247], v1 offset:29696
    v_cvt_pk_bf16_f32 v68, v20, v21
    v_mfma_f32_16x16x32_bf16 v[44:47], a[4:7], a[248:251], v[44:47]
    ds_read_b128 a[228:231], v3 offset:8768
    v_cvt_pk_bf16_f32 v69, v22, v23
    v_mfma_f32_16x16x32_bf16 v[48:51], a[52:55], a[248:251], v[48:51]
    v_cvt_pk_bf16_f32 v70, v24, v25
    v_cvt_pk_bf16_f32 v71, v26, v27
    v_mfma_f32_16x16x32_bf16 v[52:55], a[100:103], a[248:251], v[52:55]
    s_waitcnt lgkmcnt(4)
    ds_read_b128 a[248:251], v1 offset:30720
    v_cvt_pk_bf16_f32 v72, v28, v29
    v_mfma_f32_16x16x32_bf16 v[56:59], a[4:7], a[252:255], v[56:59]
    ds_read_b128 a[232:235], v3 offset:8832
    v_cvt_pk_bf16_f32 v73, v30, v31
    v_mfma_f32_16x16x32_bf16 v[60:63], a[52:55], a[252:255], v[60:63]
    v_cvt_pk_bf16_f32 v76, v32, v33
    v_cvt_pk_bf16_f32 v77, v34, v35
    v_mfma_f32_16x16x32_bf16 v[64:67], a[100:103], a[252:255], v[64:67]
    s_waitcnt lgkmcnt(5)
    ds_read_b128 a[252:255], v1 offset:31744
    v_cvt_pk_bf16_f32 v78, v36, v37
    v_mfma_f32_16x16x32_bf16 v[44:47], a[8:11], a[240:243], v[44:47]
    ds_read_b128 a[236:239], v3 offset:8896
    v_cvt_pk_bf16_f32 v79, v38, v39
    v_mfma_f32_16x16x32_bf16 v[48:51], a[56:59], a[240:243], v[48:51]
    v_cvt_pk_bf16_f32 v80, v40, v41
    v_cvt_pk_bf16_f32 v81, v42, v43
    v_mfma_f32_16x16x32_bf16 v[52:55], a[104:107], a[240:243], v[52:55]
    s_waitcnt lgkmcnt(5)
    ds_read_b128 a[240:243], v1 offset:32768
    v_sub_f32 v184, v184, v250
    v_mfma_f32_16x16x32_bf16 v[56:59], a[8:11], a[244:247], v[56:59]
    v_add_f32 v254, v254, v182
    v_sub_f32 v200, v200, v251
    v_mfma_f32_16x16x32_bf16 v[60:63], a[56:59], a[244:247], v[60:63]
    v_exp_f32 v199, v199
    v_mfma_f32_16x16x32_bf16 v[64:67], a[104:107], a[244:247], v[64:67]
    s_waitcnt lgkmcnt(4)
    ds_read_b128 a[244:247], v1 offset:33792
    v_add_f32 v255, v255, v198
    v_mfma_f32_16x16x32_bf16 v[44:47], a[12:15], a[248:251], v[44:47]
    v_exp_f32 v152, v152
    v_mfma_f32_16x16x32_bf16 v[48:51], a[60:63], a[248:251], v[48:51]
    v_sub_f32 v153, v153, v248
    v_add_f32 v252, v252, v151
    v_mfma_f32_16x16x32_bf16 v[52:55], a[108:111], a[248:251], v[52:55]
    s_waitcnt lgkmcnt(3)
    ds_read_b128 a[248:251], v1 offset:34816
    v_sub_f32 v169, v169, v249
    v_mfma_f32_16x16x32_bf16 v[56:59], a[12:15], a[252:255], v[56:59]
    s_waitcnt lgkmcnt(3)
    buffer_load_dwordx4 v15, s[16:19], s33 offen offset:512 nt lds
    s_add_u32 m0, s31, 9280
    v_mfma_f32_16x16x32_bf16 v[60:63], a[60:63], a[252:255], v[60:63]
    v_exp_f32 v168, v168
    v_mfma_f32_16x16x32_bf16 v[64:67], a[108:111], a[252:255], v[64:67]
    s_waitcnt lgkmcnt(2)
    ds_read_b128 a[252:255], v1 offset:35840
    v_add_f32 v253, v253, v167
    v_mfma_f32_16x16x32_bf16 v[44:47], a[16:19], a[240:243], v[44:47]
    v_exp_f32 v184, v184
    v_mfma_f32_16x16x32_bf16 v[48:51], a[64:67], a[240:243], v[48:51]
    buffer_load_dwordx4 v16, s[16:19], s33 offen offset:512 nt lds
    s_add_u32 m0, s31, 10368
    v_mfma_f32_16x16x32_bf16 v[52:55], a[112:115], a[240:243], v[52:55]
    s_waitcnt lgkmcnt(2)
    ds_read_b128 a[240:243], v1 offset:36864
    v_sub_f32 v185, v185, v250
    v_mfma_f32_16x16x32_bf16 v[56:59], a[16:19], a[244:247], v[56:59]
    v_add_f32 v254, v254, v183
    v_sub_f32 v201, v201, v251
    v_mfma_f32_16x16x32_bf16 v[60:63], a[64:67], a[244:247], v[60:63]
    v_exp_f32 v200, v200
    v_mfma_f32_16x16x32_bf16 v[64:67], a[112:115], a[244:247], v[64:67]
    s_waitcnt lgkmcnt(2)
    ds_read_b128 a[244:247], v1 offset:37888
    v_add_f32 v255, v255, v199
    v_mfma_f32_16x16x32_bf16 v[44:47], a[20:23], a[248:251], v[44:47]
    buffer_load_dwordx4 v17, s[16:19], s33 offen offset:512 nt lds
    s_add_u32 m0, s31, 11456
    v_mfma_f32_16x16x32_bf16 v[48:51], a[68:71], a[248:251], v[48:51]
    v_exp_f32 v153, v153
    v_mfma_f32_16x16x32_bf16 v[52:55], a[116:119], a[248:251], v[52:55]
    s_waitcnt lgkmcnt(2)
    ds_read_b128 a[248:251], v1 offset:38912
    v_sub_f32 v154, v154, v248
    v_mfma_f32_16x16x32_bf16 v[56:59], a[20:23], a[252:255], v[56:59]
    v_add_f32 v252, v252, v152
    v_sub_f32 v170, v170, v249
    v_mfma_f32_16x16x32_bf16 v[60:63], a[68:71], a[252:255], v[60:63]
    buffer_load_dwordx4 v18, s[16:19], s33 offen offset:512 nt lds
    v_mfma_f32_16x16x32_bf16 v[64:67], a[116:119], a[252:255], v[64:67]
    s_waitcnt lgkmcnt(2)
    ds_read_b128 a[252:255], v1 offset:39936
    v_add_f32 v253, v253, v168
    v_mfma_f32_16x16x32_bf16 v[44:47], a[24:27], a[240:243], v[44:47]
    v_exp_f32 v169, v169
    v_mfma_f32_16x16x32_bf16 v[48:51], a[72:75], a[240:243], v[48:51]
    v_exp_f32 v185, v185
    v_mfma_f32_16x16x32_bf16 v[52:55], a[120:123], a[240:243], v[52:55]
    s_waitcnt lgkmcnt(2)
    ds_read_b128 a[240:243], v1 offset:40960
    v_sub_f32 v186, v186, v250
    v_mfma_f32_16x16x32_bf16 v[56:59], a[24:27], a[244:247], v[56:59]
    v_add_f32 v254, v254, v184
    v_sub_f32 v202, v202, v251
    v_mfma_f32_16x16x32_bf16 v[60:63], a[72:75], a[244:247], v[60:63]
    v_exp_f32 v201, v201
    v_mfma_f32_16x16x32_bf16 v[64:67], a[120:123], a[244:247], v[64:67]
    s_waitcnt lgkmcnt(2)
    ds_read_b128 a[244:247], v1 offset:41984
    v_add_f32 v255, v255, v200
    v_mfma_f32_16x16x32_bf16 v[44:47], a[28:31], a[248:251], v[44:47]
    v_exp_f32 v154, v154
    v_mfma_f32_16x16x32_bf16 v[48:51], a[76:79], a[248:251], v[48:51]
    v_sub_f32 v155, v155, v248
    v_add_f32 v252, v252, v153
    v_mfma_f32_16x16x32_bf16 v[52:55], a[124:127], a[248:251], v[52:55]
    s_waitcnt lgkmcnt(2)
    ds_read_b128 a[248:251], v1 offset:43008
    v_sub_f32 v171, v171, v249
    v_mfma_f32_16x16x32_bf16 v[56:59], a[28:31], a[252:255], v[56:59]
    v_exp_f32 v170, v170
    v_mfma_f32_16x16x32_bf16 v[60:63], a[76:79], a[252:255], v[60:63]
    v_add_f32 v253, v253, v169
    v_sub_f32 v187, v187, v250
    v_mfma_f32_16x16x32_bf16 v[64:67], a[124:127], a[252:255], v[64:67]
    s_waitcnt lgkmcnt(2)
    ds_read_b128 a[252:255], v1 offset:44032
    v_add_f32 v254, v254, v185
    v_mfma_f32_16x16x32_bf16 v[44:47], a[32:35], a[240:243], v[44:47]
    v_exp_f32 v186, v186
    v_mfma_f32_16x16x32_bf16 v[48:51], a[80:83], a[240:243], v[48:51]
    v_exp_f32 v202, v202
    v_mfma_f32_16x16x32_bf16 v[52:55], a[128:131], a[240:243], v[52:55]
    s_waitcnt lgkmcnt(2)
    ds_read_b128 a[240:243], v1 offset:45056
    v_sub_f32 v203, v203, v251
    v_mfma_f32_16x16x32_bf16 v[56:59], a[32:35], a[244:247], v[56:59]
    v_add_f32 v255, v255, v201
    v_sub_f32 v156, v156, v248
    v_mfma_f32_16x16x32_bf16 v[60:63], a[80:83], a[244:247], v[60:63]
    v_exp_f32 v155, v155
    v_mfma_f32_16x16x32_bf16 v[64:67], a[128:131], a[244:247], v[64:67]
    s_waitcnt lgkmcnt(2)
    ds_read_b128 a[244:247], v1 offset:46080
    v_add_f32 v252, v252, v154
    v_mfma_f32_16x16x32_bf16 v[44:47], a[36:39], a[248:251], v[44:47]
    v_exp_f32 v171, v171
    v_mfma_f32_16x16x32_bf16 v[48:51], a[84:87], a[248:251], v[48:51]
    v_sub_f32 v172, v172, v249
    v_add_f32 v253, v253, v170
    v_mfma_f32_16x16x32_bf16 v[52:55], a[132:135], a[248:251], v[52:55]
    s_waitcnt lgkmcnt(2)
    ds_read_b128 a[248:251], v1 offset:47104
    v_sub_f32 v188, v188, v250
    v_mfma_f32_16x16x32_bf16 v[56:59], a[36:39], a[252:255], v[56:59]
    v_exp_f32 v187, v187
    v_mfma_f32_16x16x32_bf16 v[60:63], a[84:87], a[252:255], v[60:63]
    v_add_f32 v254, v254, v186
    v_sub_f32 v204, v204, v251
    v_mfma_f32_16x16x32_bf16 v[64:67], a[132:135], a[252:255], v[64:67]
    s_waitcnt lgkmcnt(2)
    ds_read_b128 a[252:255], v1 offset:48128
    v_add_f32 v255, v255, v202
    v_mfma_f32_16x16x32_bf16 v[44:47], a[40:43], a[240:243], v[44:47]
    v_exp_f32 v203, v203
    v_mfma_f32_16x16x32_bf16 v[48:51], a[88:91], a[240:243], v[48:51]
    v_exp_f32 v156, v156
    v_mfma_f32_16x16x32_bf16 v[52:55], a[136:139], a[240:243], v[52:55]
    s_waitcnt lgkmcnt(2)
    v_sub_f32 v157, v157, v248
    v_add_f32 v252, v252, v155
    v_mfma_f32_16x16x32_bf16 v[56:59], a[40:43], a[244:247], v[56:59]
    v_exp_f32 v172, v172
    v_mfma_f32_16x16x32_bf16 v[60:63], a[88:91], a[244:247], v[60:63]
    v_sub_f32 v173, v173, v249
    v_add_f32 v253, v253, v171
    v_mfma_f32_16x16x32_bf16 v[64:67], a[136:139], a[244:247], v[64:67]
    s_waitcnt vmcnt(9) lgkmcnt(0)
    s_barrier
    ds_read_b128 a[240:243], v2 offset:0
    v_mfma_f32_16x16x32_bf16 v[44:47], a[44:47], a[248:251], v[44:47]
    ds_read_b128 a[244:247], v2 offset:1024
    v_sub_f32 v189, v189, v250
    v_mfma_f32_16x16x32_bf16 v[48:51], a[92:95], a[248:251], v[48:51]
    s_add_u32 s41, s36, 768
    s_add_u32 m0, s32, 1536
    v_add_f32 v254, v254, v187
    v_mfma_f32_16x16x32_bf16 v[52:55], a[140:143], a[248:251], v[52:55]
    ds_read_b128 a[248:251], v2 offset:2048
    v_sub_f32 v205, v205, v251
    v_mfma_f32_16x16x32_bf16 v[56:59], a[44:47], a[252:255], v[56:59]
    v_exp_f32 v188, v188
    v_mfma_f32_16x16x32_bf16 v[60:63], a[92:95], a[252:255], v[60:63]
    v_exp_f32 v204, v204
    v_mfma_f32_16x16x32_bf16 v[64:67], a[140:143], a[252:255], v[64:67]
    s_waitcnt lgkmcnt(2)
    v_add_f32 v255, v255, v203
    v_sub_f32 v158, v158, v248
    v_mfma_f32_16x16x32_bf16 v[20:23], a[0:3], a[240:243], 0
    ds_read_b128 a[252:255], v2 offset:3072
    v_add_f32 v252, v252, v156
    v_mfma_f32_16x16x32_bf16 v[24:27], a[48:51], a[240:243], 0
    v_exp_f32 v157, v157
    v_mfma_f32_16x16x32_bf16 v[28:31], a[96:99], a[240:243], 0
    ds_read_b128 a[240:243], v2 offset:4096
    s_waitcnt vmcnt(4)
    v_readfirstlane_b32 s60, v0
    s_nop 1
    s_cmp_ge_u32 s60, 2
    s_cbranch_scc0 L_slow_va
L_back_va:
    s_waitcnt lgkmcnt(3)
    v_mfma_f32_16x16x32_bf16 v[32:35], a[0:3], a[244:247], 0
    s_mov_b32 exec_hi, 0
    buffer_load_dwordx4 v1, s[20:23], s41 offen sc1 lds
    s_mov_b64 exec, -1
    s_add_u32 s45, s29, 393216
    v_mfma_f32_16x16x32_bf16 v[36:39], a[48:51], a[244:247], 0
    s_add_u32 m0, s29, 0
    v_exp_f32 v173, v173
    v_mfma_f32_16x16x32_bf16 v[40:43], a[96:99], a[244:247], 0
    s_waitcnt lgkmcnt(2)
    ds_read_b128 a[244:247], v2 offset:5120
    v_cvt_pk_bf16_f32 v84, v44, v45
    v_mfma_f32_16x16x32_bf16 v[20:23], a[4:7], a[248:251], v[20:23]
    v_cvt_pk_bf16_f32 v85, v46, v47
    v_cvt_pk_bf16_f32 v86, v48, v49
    v_mfma_f32_16x16x32_bf16 v[24:27], a[52:55], a[248:251], v[24:27]
    buffer_load_dwordx4 v1, s[20:23], s45 offen offset:0 sc1 lds
    v_mfma_f32_16x16x32_bf16 v[28:31], a[100:103], a[248:251], v[28:31]
    s_waitcnt lgkmcnt(2)
    ds_read_b128 a[248:251], v2 offset:6144
    v_cvt_pk_bf16_f32 v87, v50, v51
    v_mfma_f32_16x16x32_bf16 v[32:35], a[4:7], a[252:255], v[32:35]
    v_cvt_pk_bf16_f32 v88, v52, v53
    v_cvt_pk_bf16_f32 v89, v54, v55
    v_mfma_f32_16x16x32_bf16 v[36:39], a[52:55], a[252:255], v[36:39]
    v_cvt_pk_bf16_f32 v92, v56, v57
    v_cvt_pk_bf16_f32 v93, v58, v59
    v_mfma_f32_16x16x32_bf16 v[40:43], a[100:103], a[252:255], v[40:43]
    s_waitcnt lgkmcnt(2)
    ds_read_b128 a[252:255], v2 offset:7168
    v_cvt_pk_bf16_f32 v94, v60, v61
    v_mfma_f32_16x16x32_bf16 v[20:23], a[8:11], a[240:243], v[20:23]
    buffer_load_dwordx4 v1, s[20:23], s45 offen offset:1024 sc1 lds
    v_mfma_f32_16x16x32_bf16 v[24:27], a[56:59], a[240:243], v[24:27]
    v_cvt_pk_bf16_f32 v95, v62, v63
    v_cvt_pk_bf16_f32 v96, v64, v65
    v_mfma_f32_16x16x32_bf16 v[28:31], a[104:107], a[240:243], v[28:31]
    s_waitcnt lgkmcnt(2)
    ds_read_b128 a[240:243], v2 offset:8192
    v_cvt_pk_bf16_f32 v97, v66, v67
    v_mfma_f32_16x16x32_bf16 v[32:35], a[8:11], a[244:247], v[32:35]
    v_sub_f32 v174, v174, v249
    v_add_f32 v253, v253, v172
    v_mfma_f32_16x16x32_bf16 v[36:39], a[56:59], a[244:247], v[36:39]
    buffer_load_dwordx4 v1, s[20:23], s45 offen offset:2048 sc1 lds
    v_mfma_f32_16x16x32_bf16 v[40:43], a[104:107], a[244:247], v[40:43]
    s_waitcnt lgkmcnt(2)
    ds_read_b128 a[244:247], v2 offset:9216
    v_sub_f32 v190, v190, v250
    v_mfma_f32_16x16x32_bf16 v[20:23], a[12:15], a[248:251], v[20:23]
    v_exp_f32 v189, v189
    v_mfma_f32_16x16x32_bf16 v[24:27], a[60:63], a[248:251], v[24:27]
    v_add_f32 v254, v254, v188
    v_sub_f32 v206, v206, v251
    v_mfma_f32_16x16x32_bf16 v[28:31], a[108:111], a[248:251], v[28:31]
    s_waitcnt lgkmcnt(2)
    ds_read_b128 a[248:251], v2 offset:10240
    v_add_f32 v255, v255, v204
    v_mfma_f32_16x16x32_bf16 v[32:35], a[12:15], a[252:255], v[32:35]
    buffer_load_dwordx4 v1, s[20:23], s45 offen offset:3072 sc1 lds
    s_add_u32 s45, s29, 397312
    v_mfma_f32_16x16x32_bf16 v[36:39], a[60:63], a[252:255], v[36:39]
    s_add_u32 m0, s29, 4096
    v_exp_f32 v205, v205
    v_mfma_f32_16x16x32_bf16 v[40:43], a[108:111], a[252:255], v[40:43]
    s_waitcnt lgkmcnt(2)
    ds_read_b128 a[252:255], v2 offset:11264
    v_sub_f32 v159, v159, v248
    v_mfma_f32_16x16x32_bf16 v[20:23], a[16:19], a[240:243], v[20:23]
    v_exp_f32 v158, v158
    v_mfma_f32_16x16x32_bf16 v[24:27], a[64:67], a[240:243], v[24:27]
    buffer_load_dwordx4 v1, s[20:23], s45 offen offset:0 sc1 lds
    v_mfma_f32_16x16x32_bf16 v[28:31], a[112:115], a[240:243], v[28:31]
    s_waitcnt lgkmcnt(2)
    ds_read_b128 a[240:243], v2 offset:12288
    v_add_f32 v252, v252, v157
    v_mfma_f32_16x16x32_bf16 v[32:35], a[16:19], a[244:247], v[32:35]
    v_exp_f32 v174, v174
    v_mfma_f32_16x16x32_bf16 v[36:39], a[64:67], a[244:247], v[36:39]
    v_sub_f32 v175, v175, v249
    v_add_f32 v253, v253, v173
    v_mfma_f32_16x16x32_bf16 v[40:43], a[112:115], a[244:247], v[40:43]
    s_waitcnt lgkmcnt(2)
    ds_read_b128 a[244:247], v2 offset:13312
    v_sub_f32 v191, v191, v250
    v_mfma_f32_16x16x32_bf16 v[20:23], a[20:23], a[248:251], v[20:23]
    buffer_load_dwordx4 v1, s[20:23], s45 offen offset:1024 sc1 lds
    s_add_u32 s45, s29, 417792
    v_mfma_f32_16x16x32_bf16 v[24:27], a[68:71], a[248:251], v[24:27]
    s_add_u32 m0, s29, 24576
    v_exp_f32 v190, v190
    v_mfma_f32_16x16x32_bf16 v[28:31], a[116:119], a[248:251], v[28:31]
    s_waitcnt lgkmcnt(2)
    ds_read_b128 a[248:251], v2 offset:14336
    v_add_f32 v254, v254, v189
    v_mfma_f32_16x16x32_bf16 v[32:35], a[20:23], a[252:255], v[32:35]
    v_exp_f32 v206, v206
    v_mfma_f32_16x16x32_bf16 v[36:39], a[68:71], a[252:255], v[36:39]
    buffer_load_dwordx4 v1, s[20:23], s45 offen offset:0 sc1 lds
    v_mfma_f32_16x16x32_bf16 v[40:43], a[116:119], a[252:255], v[40:43]
    s_waitcnt lgkmcnt(2)
    ds_read_b128 a[252:255], v2 offset:15360
    v_sub_f32 v207, v207, v251
    v_mfma_f32_16x16x32_bf16 v[20:23], a[24:27], a[240:243], v[20:23]
    v_add_f32 v255, v255, v205
    v_sub_f32 v160, v160, v248
    v_mfma_f32_16x16x32_bf16 v[24:27], a[72:75], a[240:243], v[24:27]
    v_exp_f32 v159, v159
    v_mfma_f32_16x16x32_bf16 v[28:31], a[120:123], a[240:243], v[28:31]
    s_waitcnt lgkmcnt(2)
    ds_read_b128 a[240:243], v2 offset:16384
    v_add_f32 v252, v252, v158
    v_mfma_f32_16x16x32_bf16 v[32:35], a[24:27], a[244:247], v[32:35]
    buffer_load_dwordx4 v1, s[20:23], s45 offen offset:1024 sc1 lds
    v_mfma_f32_16x16x32_bf16 v[36:39], a[72:75], a[244:247], v[36:39]
    v_exp_f32 v175, v175
    v_mfma_f32_16x16x32_bf16 v[40:43], a[120:123], a[244:247], v[40:43]
    s_waitcnt lgkmcnt(2)
    ds_read_b128 a[244:247], v2 offset:17408
    v_sub_f32 v176, v176, v249
    v_mfma_f32_16x16x32_bf16 v[20:23], a[28:31], a[248:251], v[20:23]
    v_add_f32 v253, v253, v174
    v_sub_f32 v192, v192, v250
    v_mfma_f32_16x16x32_bf16 v[24:27], a[76:79], a[248:251], v[24:27]
    buffer_load_dwordx4 v1, s[20:23], s45 offen offset:2048 sc1 lds
    v_mfma_f32_16x16x32_bf16 v[28:31], a[124:127], a[248:251], v[28:31]
    s_waitcnt lgkmcnt(2)
    ds_read_b128 a[248:251], v2 offset:18432
    v_add_f32 v254, v254, v190
    v_mfma_f32_16x16x32_bf16 v[32:35], a[28:31], a[252:255], v[32:35]
    v_exp_f32 v191, v191
    v_mfma_f32_16x16x32_bf16 v[36:39], a[76:79], a[252:255], v[36:39]
    v_exp_f32 v207, v207
    v_mfma_f32_16x16x32_bf16 v[40:43], a[124:127], a[252:255], v[40:43]
    s_waitcnt lgkmcnt(2)
    ds_read_b128 a[252:255], v2 offset:19456
    v_sub_f32 v208, v208, v251
    v_mfma_f32_16x16x32_bf16 v[20:23], a[32:35], a[240:243], v[20:23]
    buffer_load_dwordx4 v1, s[20:23], s45 offen offset:3072 sc1 lds
    s_add_u32 s45, s29, 421888
    v_mfma_f32_16x16x32_bf16 v[24:27], a[80:83], a[240:243], v[24:27]
    s_add_u32 m0, s29, 28672
    v_add_f32 v255, v255, v206
    v_add_f32 v252, v252, v159
    v_mfma_f32_16x16x32_bf16 v[28:31], a[128:131], a[240:243], v[28:31]
    s_waitcnt lgkmcnt(2)
    ds_read_b128 a[240:243], v2 offset:20480
    v_add_f32 v253, v253, v175
    v_mfma_f32_16x16x32_bf16 v[32:35], a[32:35], a[244:247], v[32:35]
    v_exp_f32 v160, v160
    v_mfma_f32_16x16x32_bf16 v[36:39], a[80:83], a[244:247], v[36:39]
    buffer_load_dwordx4 v1, s[20:23], s45 offen offset:0 sc1 lds
    v_mfma_f32_16x16x32_bf16 v[40:43], a[128:131], a[244:247], v[40:43]
    s_waitcnt lgkmcnt(2)
    ds_read_b128 a[244:247], v2 offset:21504
    v_add_f32 v254, v254, v191
    v_mfma_f32_16x16x32_bf16 v[20:23], a[36:39], a[248:251], v[20:23]
    v_exp_f32 v176, v176
    v_mfma_f32_16x16x32_bf16 v[24:27], a[84:87], a[248:251], v[24:27]
    v_exp_f32 v192, v192
    v_mfma_f32_16x16x32_bf16 v[28:31], a[132:135], a[248:251], v[28:31]
    s_waitcnt lgkmcnt(2)
    ds_read_b128 a[248:251], v2 offset:22528
    v_add_f32 v255, v255, v207
    v_mfma_f32_16x16x32_bf16 v[32:35], a[36:39], a[252:255], v[32:35]
    buffer_load_dwordx4 v1, s[20:23], s45 offen offset:1024 sc1 lds
    s_add_u32 s40, s33, 1746432
    v_mfma_f32_16x16x32_bf16 v[36:39], a[84:87], a[252:255], v[36:39]
    s_add_u32 m0, s32, 0
    v_exp_f32 v208, v208
    v_mfma_f32_16x16x32_bf16 v[40:43], a[132:135], a[252:255], v[40:43]
    s_waitcnt lgkmcnt(2)
    ds_read_b128 a[252:255], v2 offset:23552
    s_mov_b64 exec, s[42:43]
    buffer_load_dwordx4 v1, s[16:19], s40 offen nt lds
    s_mov_b64 exec, -1
    v_mfma_f32_16x16x32_bf16 v[20:23], a[40:43], a[240:243], v[20:23]
    v_add_f32 v252, v252, v160
    v_add_f32 v253, v253, v176
    v_mfma_f32_16x16x32_bf16 v[24:27], a[88:91], a[240:243], v[24:27]
    v_add_f32 v254, v254, v192
    v_add_f32 v255, v255, v208
    v_mfma_f32_16x16x32_bf16 v[28:31], a[136:139], a[240:243], v[28:31]
    s_waitcnt lgkmcnt(2)
    ds_read_b128 a[240:243], v2 offset:24576
    v_permlane32_swap_b32 v252, v253
    v_mfma_f32_16x16x32_bf16 v[32:35], a[40:43], a[244:247], v[32:35]
    v_permlane32_swap_b32 v254, v255
    v_add_f32 v252, v252, v253
    v_mfma_f32_16x16x32_bf16 v[36:39], a[88:91], a[244:247], v[36:39]
    v_add_f32 v254, v254, v255
    v_mfma_f32_16x16x32_bf16 v[40:43], a[136:139], a[244:247], v[40:43]
    s_waitcnt lgkmcnt(2)
    ds_read_b128 a[244:247], v2 offset:25600
    v_mfma_f32_16x16x32_bf16 v[20:23], a[44:47], a[248:251], v[20:23]
    v_permlane16_swap_b32 v252, v254
    v_mfma_f32_16x16x32_bf16 v[24:27], a[92:95], a[248:251], v[24:27]
    v_add_f32 v252, v252, v254
    v_mfma_f32_16x16x32_bf16 v[28:31], a[140:143], a[248:251], v[28:31]
    s_waitcnt lgkmcnt(2)
    ds_read_b128 a[248:251], v2 offset:26624
    v_mfma_f32_16x16x32_bf16 v[32:35], a[44:47], a[252:255], v[32:35]
    v_rcp_f32 v252, v252
    v_mfma_f32_16x16x32_bf16 v[36:39], a[92:95], a[252:255], v[36:39]
    v_mov_b32 v254, v252
    v_mfma_f32_16x16x32_bf16 v[40:43], a[140:143], a[252:255], v[40:43]
    s_waitcnt lgkmcnt(2)
    v_mfma_f32_16x16x32_bf16 v[44:47], a[0:3], a[240:243], 0
    ds_read_b128 a[252:255], v2 offset:27648
    v_permlane16_swap_b32 v252, v254
    v_mfma_f32_16x16x32_bf16 v[48:51], a[48:51], a[240:243], 0
    v_mov_b32 v255, v254
    v_mov_b32 v253, v252
    v_mfma_f32_16x16x32_bf16 v[52:55], a[96:99], a[240:243], 0
    s_waitcnt lgkmcnt(2)
    ds_read_b128 a[240:243], v2 offset:28672
    v_mfma_f32_16x16x32_bf16 v[56:59], a[0:3], a[244:247], 0
    v_permlane32_swap_b32 v254, v255
    v_permlane32_swap_b32 v252, v253
    v_mfma_f32_16x16x32_bf16 v[60:63], a[48:51], a[244:247], 0
    v_cndmask_b32 v255, 0, v255, s[90:91]
    v_mul_f32 v148, v148, v252
    v_mfma_f32_16x16x32_bf16 v[64:67], a[96:99], a[244:247], 0
    s_waitcnt lgkmcnt(2)
    ds_read_b128 a[244:247], v2 offset:29696
    v_cvt_pk_bf16_f32 v100, v20, v21
    v_mfma_f32_16x16x32_bf16 v[44:47], a[4:7], a[248:251], v[44:47]
    v_cvt_pk_bf16_f32 v101, v22, v23
    v_cvt_pk_bf16_f32 v102, v24, v25
    v_mfma_f32_16x16x32_bf16 v[48:51], a[52:55], a[248:251], v[48:51]
    v_cvt_pk_bf16_f32 v103, v26, v27
    v_cvt_pk_bf16_f32 v104, v28, v29
    v_mfma_f32_16x16x32_bf16 v[52:55], a[100:103], a[248:251], v[52:55]
    s_waitcnt lgkmcnt(2)
    ds_read_b128 a[248:251], v2 offset:30720
    v_cvt_pk_bf16_f32 v105, v30, v31
    v_mfma_f32_16x16x32_bf16 v[56:59], a[4:7], a[252:255], v[56:59]
    v_cvt_pk_bf16_f32 v108, v32, v33
    v_cvt_pk_bf16_f32 v109, v34, v35
    v_mfma_f32_16x16x32_bf16 v[60:63], a[52:55], a[252:255], v[60:63]
    v_cvt_pk_bf16_f32 v110, v36, v37
    v_cvt_pk_bf16_f32 v111, v38, v39
    v_mfma_f32_16x16x32_bf16 v[64:67], a[100:103], a[252:255], v[64:67]
    s_waitcnt lgkmcnt(2)
    ds_read_b128 a[252:255], v2 offset:31744
    v_cvt_pk_bf16_f32 v112, v40, v41
    v_mfma_f32_16x16x32_bf16 v[44:47], a[8:11], a[240:243], v[44:47]
    v_cvt_pk_bf16_f32 v113, v42, v43
    v_mul_f32 v149, v149, v252
    v_mfma_f32_16x16x32_bf16 v[48:51], a[56:59], a[240:243], v[48:51]
    v_mul_f32 v150, v150, v252
    v_mul_f32 v151, v151, v252
    v_mfma_f32_16x16x32_bf16 v[52:55], a[104:107], a[240:243], v[52:55]
    s_waitcnt lgkmcnt(2)
    ds_read_b128 a[240:243], v2 offset:32768
    v_mul_f32 v152, v152, v252
    v_mfma_f32_16x16x32_bf16 v[56:59], a[8:11], a[244:247], v[56:59]
    v_mul_f32 v153, v153, v252
    v_mul_f32 v154, v154, v252
    v_mfma_f32_16x16x32_bf16 v[60:63], a[56:59], a[244:247], v[60:63]
    v_mul_f32 v155, v155, v252
    v_mul_f32 v156, v156, v252
    v_mfma_f32_16x16x32_bf16 v[64:67], a[104:107], a[244:247], v[64:67]
    s_waitcnt lgkmcnt(2)
    ds_read_b128 a[244:247], v2 offset:33792
    v_mul_f32 v157, v157, v252
    v_mfma_f32_16x16x32_bf16 v[44:47], a[12:15], a[248:251], v[44:47]
    v_mul_f32 v158, v158, v252
    v_mul_f32 v159, v159, v252
    v_mfma_f32_16x16x32_bf16 v[48:51], a[60:63], a[248:251], v[48:51]
    v_mul_f32 v160, v160, v252
    v_mul_f32 v164, v164, v253
    v_mfma_f32_16x16x32_bf16 v[52:55], a[108:111], a[248:251], v[52:55]
    s_waitcnt lgkmcnt(2)
    ds_read_b128 a[248:251], v2 offset:34816
    v_mul_f32 v165, v165, v253
    v_mfma_f32_16x16x32_bf16 v[56:59], a[12:15], a[252:255], v[56:59]
    v_mul_f32 v166, v166, v253
    v_mul_f32 v167, v167, v253
    v_mfma_f32_16x16x32_bf16 v[60:63], a[60:63], a[252:255], v[60:63]
    v_mul_f32 v168, v168, v253
    v_mul_f32 v169, v169, v253
    v_mfma_f32_16x16x32_bf16 v[64:67], a[108:111], a[252:255], v[64:67]
    s_waitcnt lgkmcnt(2)
    ds_read_b128 a[252:255], v2 offset:35840
    v_mul_f32 v170, v170, v253
    v_mfma_f32_16x16x32_bf16 v[44:47], a[16:19], a[240:243], v[44:47]
    v_mul_f32 v171, v171, v253
    v_mul_f32 v172, v172, v253
    v_mfma_f32_16x16x32_bf16 v[48:51], a[64:67], a[240:243], v[48:51]
    v_mul_f32 v173, v173, v253
    v_mul_f32 v174, v174, v253
    v_mfma_f32_16x16x32_bf16 v[52:55], a[112:115], a[240:243], v[52:55]
    s_waitcnt lgkmcnt(2)
    ds_read_b128 a[240:243], v2 offset:36864
    v_mul_f32 v175, v175, v253
    v_mfma_f32_16x16x32_bf16 v[56:59], a[16:19], a[244:247], v[56:59]
    v_mul_f32 v176, v176, v253
    v_mul_f32 v180, v180, v254
    v_mfma_f32_16x16x32_bf16 v[60:63], a[64:67], a[244:247], v[60:63]
    v_mul_f32 v181, v181, v254
    v_mul_f32 v182, v182, v254
    v_mfma_f32_16x16x32_bf16 v[64:67], a[112:115], a[244:247], v[64:67]
    s_waitcnt lgkmcnt(2)
    ds_read_b128 a[244:247], v2 offset:37888
    v_mul_f32 v183, v183, v254
    v_mfma_f32_16x16x32_bf16 v[44:47], a[20:23], a[248:251], v[44:47]
    v_mul_f32 v184, v184, v254
    v_mul_f32 v185, v185, v254
    v_mfma_f32_16x16x32_bf16 v[48:51], a[68:71], a[248:251], v[48:51]
    v_mul_f32 v186, v186, v254
    v_mul_f32 v187, v187, v254
    v_mfma_f32_16x16x32_bf16 v[52:55], a[116:119], a[248:251], v[52:55]
    s_waitcnt lgkmcnt(2)
    ds_read_b128 a[248:251], v2 offset:38912
    v_mul_f32 v188, v188, v254
    v_mfma_f32_16x16x32_bf16 v[56:59], a[20:23], a[252:255], v[56:59]
    v_mul_f32 v189, v189, v254
    v_mul_f32 v190, v190, v254
    v_mfma_f32_16x16x32_bf16 v[60:63], a[68:71], a[252:255], v[60:63]
    v_mul_f32 v191, v191, v254
    v_mul_f32 v192, v192, v254
    v_mfma_f32_16x16x32_bf16 v[64:67], a[116:119], a[252:255], v[64:67]
    s_waitcnt lgkmcnt(2)
    ds_read_b128 a[252:255], v2 offset:39936
    v_mul_f32 v196, v196, v255
    v_mfma_f32_16x16x32_bf16 v[44:47], a[24:27], a[240:243], v[44:47]
    s_waitcnt vmcnt(13)
    ds_read_u16 v74, v5 offset:0
    v_mul_f32 v197, v197, v255
    v_mfma_f32_16x16x32_bf16 v[48:51], a[72:75], a[240:243], v[48:51]
    v_mul_f32 v198, v198, v255
    v_mul_f32 v199, v199, v255
    v_mfma_f32_16x16x32_bf16 v[52:55], a[120:123], a[240:243], v[52:55]
    s_waitcnt lgkmcnt(3)
    ds_read_b128 a[240:243], v2 offset:40960
    v_mul_f32 v200, v200, v255
    v_mfma_f32_16x16x32_bf16 v[56:59], a[24:27], a[244:247], v[56:59]
    ds_read_u16 v82, v5 offset:2
    v_mul_f32 v201, v201, v255
    v_mfma_f32_16x16x32_bf16 v[60:63], a[72:75], a[244:247], v[60:63]
    v_mul_f32 v202, v202, v255
    v_mul_f32 v203, v203, v255
    v_mfma_f32_16x16x32_bf16 v[64:67], a[120:123], a[244:247], v[64:67]
    s_waitcnt lgkmcnt(4)
    ds_read_b128 a[244:247], v2 offset:41984
    v_mul_f32 v204, v204, v255
    v_mfma_f32_16x16x32_bf16 v[44:47], a[28:31], a[248:251], v[44:47]
    v_mul_f32 v205, v205, v255
    v_mul_f32 v206, v206, v255
    v_mfma_f32_16x16x32_bf16 v[48:51], a[76:79], a[248:251], v[48:51]
    v_mul_f32 v207, v207, v255
    v_mul_f32 v208, v208, v255
    v_mfma_f32_16x16x32_bf16 v[52:55], a[124:127], a[248:251], v[52:55]
    s_waitcnt lgkmcnt(4)
    ds_read_b128 a[248:251], v2 offset:43008
    v_cvt_pk_bf16_f32 v148, v148, v149
    v_mfma_f32_16x16x32_bf16 v[56:59], a[28:31], a[252:255], v[56:59]
    ds_read_u16 v90, v5 offset:64
    v_cvt_pk_bf16_f32 v149, v150, v151
    v_mfma_f32_16x16x32_bf16 v[60:63], a[76:79], a[252:255], v[60:63]
    v_cvt_pk_bf16_f32 v150, v152, v153
    v_cvt_pk_bf16_f32 v151, v154, v155
    v_mfma_f32_16x16x32_bf16 v[64:67], a[124:127], a[252:255], v[64:67]
    s_waitcnt lgkmcnt(4)
    ds_read_b128 a[252:255], v2 offset:44032
    v_cvt_pk_bf16_f32 v152, v156, v157
    v_mfma_f32_16x16x32_bf16 v[44:47], a[32:35], a[240:243], v[44:47]
    ds_read_u16 v98, v5 offset:66
    v_cvt_pk_bf16_f32 v153, v158, v159
    v_mfma_f32_16x16x32_bf16 v[48:51], a[80:83], a[240:243], v[48:51]
    v_cvt_pk_bf16_f32 v154, v160, 0
    v_mov_b32 v155, 0
    v_mfma_f32_16x16x32_bf16 v[52:55], a[128:131], a[240:243], v[52:55]
    s_waitcnt lgkmcnt(4)
    ds_read_b128 a[240:243], v2 offset:45056
    v_cvt_pk_bf16_f32 v164, v164, v165
    v_mfma_f32_16x16x32_bf16 v[56:59], a[32:35], a[244:247], v[56:59]
    v_cvt_pk_bf16_f32 v165, v166, v167
    v_cvt_pk_bf16_f32 v166, v168, v169
    v_mfma_f32_16x16x32_bf16 v[60:63], a[80:83], a[244:247], v[60:63]
    ds_read_u16 v106, v5 offset:128
    v_cvt_pk_bf16_f32 v167, v170, v171
    v_mfma_f32_16x16x32_bf16 v[64:67], a[128:131], a[244:247], v[64:67]
    s_waitcnt lgkmcnt(5)
    ds_read_b128 a[244:247], v2 offset:46080
    v_cvt_pk_bf16_f32 v168, v172, v173
    v_mfma_f32_16x16x32_bf16 v[44:47], a[36:39], a[248:251], v[44:47]
    v_cvt_pk_bf16_f32 v169, v174, v175
    v_cvt_pk_bf16_f32 v170, v176, 0
    v_mfma_f32_16x16x32_bf16 v[48:51], a[84:87], a[248:251], v[48:51]
    ds_read_u16 v114, v5 offset:130
    v_mov_b32 v171, 0
    v_mfma_f32_16x16x32_bf16 v[52:55], a[132:135], a[248:251], v[52:55]
    s_waitcnt lgkmcnt(5)
    ds_read_b128 a[248:251], v2 offset:47104
    v_cvt_pk_bf16_f32 v180, v180, v181
    v_mfma_f32_16x16x32_bf16 v[56:59], a[36:39], a[252:255], v[56:59]
    v_cvt_pk_bf16_f32 v181, v182, v183
    v_cvt_pk_bf16_f32 v182, v184, v185
    v_mfma_f32_16x16x32_bf16 v[60:63], a[84:87], a[252:255], v[60:63]
    v_cvt_pk_bf16_f32 v183, v186, v187
    v_cvt_pk_bf16_f32 v184, v188, v189
    v_mfma_f32_16x16x32_bf16 v[64:67], a[132:135], a[252:255], v[64:67]
    s_waitcnt lgkmcnt(4)
    ds_read_b128 a[252:255], v2 offset:48128
    v_cvt_pk_bf16_f32 v185, v190, v191
    v_mfma_f32_16x16x32_bf16 v[44:47], a[40:43], a[240:243], v[44:47]
    v_cvt_pk_bf16_f32 v186, v192, 0
    v_mov_b32 v187, 0
    v_mfma_f32_16x16x32_bf16 v[48:51], a[88:91], a[240:243], v[48:51]
    v_cvt_pk_bf16_f32 v196, v196, v197
    v_cvt_pk_bf16_f32 v197, v198, v199
    v_mfma_f32_16x16x32_bf16 v[52:55], a[136:139], a[240:243], v[52:55]
    s_waitcnt lgkmcnt(3)
    v_cvt_pk_bf16_f32 v198, v200, v201
    v_cvt_pk_bf16_f32 v199, v202, v203
    v_mfma_f32_16x16x32_bf16 v[56:59], a[40:43], a[244:247], v[56:59]
    v_cvt_pk_bf16_f32 v200, v204, v205
    v_cvt_pk_bf16_f32 v201, v206, v207
    v_mfma_f32_16x16x32_bf16 v[60:63], a[88:91], a[244:247], v[60:63]
    v_cvt_pk_bf16_f32 v202, v208, 0
    v_mov_b32 v203, 0
    v_mfma_f32_16x16x32_bf16 v[64:67], a[136:139], a[244:247], v[64:67]
    s_waitcnt lgkmcnt(1)
    v_mfma_f32_16x16x32_bf16 v[44:47], a[44:47], a[248:251], v[44:47]
    v_mfma_f32_16x16x32_bf16 v[48:51], a[92:95], a[248:251], v[48:51]
    v_mfma_f32_16x16x32_bf16 v[52:55], a[140:143], a[248:251], v[52:55]
    s_waitcnt vmcnt(1) lgkmcnt(0)
    s_barrier
    ds_read_b128 a[240:243], v1 offset:0
    v_mfma_f32_16x16x32_bf16 v[56:59], a[44:47], a[252:255], v[56:59]
    ds_read_b128 a[244:247], v1 offset:1024
    v_mfma_f32_16x16x32_bf16 v[60:63], a[92:95], a[252:255], v[60:63]
    s_add_u32 s45, s29, 442368
    s_add_u32 m0, s29, 49152
    ds_read_b128 a[248:251], v1 offset:2048
    v_mfma_f32_16x16x32_bf16 v[64:67], a[140:143], a[252:255], v[64:67]
    buffer_load_dwordx4 v1, s[20:23], s45 offen offset:0 sc1 lds
    v_mfma_f32_16x16x32_bf16 v[156:159], v[148:151], v[68:71], 0
    v_mfma_f32_16x16x32_bf16 v[172:175], v[164:167], v[68:71], 0
    v_mfma_f32_16x16x32_bf16 v[188:191], v[180:183], v[68:71], 0
    v_mfma_f32_16x16x32_bf16 v[204:207], v[196:199], v[68:71], 0
    buffer_load_dwordx4 v1, s[20:23], s45 offen offset:1024 sc1 lds
    v_mfma_f32_16x16x32_bf16 v[160:163], v[148:151], v[76:79], 0
    v_mfma_f32_16x16x32_bf16 v[176:179], v[164:167], v[76:79], 0
    v_mfma_f32_16x16x32_bf16 v[192:195], v[180:183], v[76:79], 0
    v_mfma_f32_16x16x32_bf16 v[208:211], v[196:199], v[76:79], 0
    buffer_load_dwordx4 v1, s[20:23], s45 offen offset:2048 sc1 lds
    v_mfma_f32_16x16x32_bf16 v[156:159], v[152:155], v[72:75], v[156:159]
    v_mfma_f32_16x16x32_bf16 v[172:175], v[168:171], v[72:75], v[172:175]
    v_mfma_f32_16x16x32_bf16 v[188:191], v[184:187], v[72:75], v[188:191]
    v_mfma_f32_16x16x32_bf16 v[204:207], v[200:203], v[72:75], v[204:207]
    buffer_load_dwordx4 v1, s[20:23], s45 offen offset:3072 sc1 lds
    s_add_u32 s45, s29, 446464
    v_mfma_f32_16x16x32_bf16 v[160:163], v[152:155], v[80:83], v[160:163]
    s_add_u32 m0, s29, 53248
    v_mfma_f32_16x16x32_bf16 v[176:179], v[168:171], v[80:83], v[176:179]
    v_mfma_f32_16x16x32_bf16 v[192:195], v[184:187], v[80:83], v[192:195]
    v_mfma_f32_16x16x32_bf16 v[208:211], v[200:203], v[80:83], v[208:211]
    s_waitcnt lgkmcnt(2)
    buffer_load_dwordx4 v1, s[20:23], s45 offen offset:0 sc1 lds
    v_mfma_f32_16x16x32_bf16 v[20:23], a[0:3], a[240:243], 0
    ds_read_b128 a[252:255], v1 offset:3072
    v_mfma_f32_16x16x32_bf16 v[24:27], a[48:51], a[240:243], 0
    v_cvt_pk_bf16_f32 v68, v44, v45
    v_cvt_pk_bf16_f32 v69, v46, v47
    v_mfma_f32_16x16x32_bf16 v[28:31], a[96:99], a[240:243], 0
    s_waitcnt lgkmcnt(2)
    ds_read_b128 a[240:243], v1 offset:4096
    v_cvt_pk_bf16_f32 v70, v48, v49
    v_mfma_f32_16x16x32_bf16 v[32:35], a[0:3], a[244:247], 0
    buffer_load_dwordx4 v1, s[20:23], s45 offen offset:1024 sc1 lds
    s_add_u32 s45, s29, 466944
    v_mfma_f32_16x16x32_bf16 v[36:39], a[48:51], a[244:247], 0
    s_add_u32 m0, s29, 73728
    ds_read_u16 v74, v5 offset:192
    v_cvt_pk_bf16_f32 v71, v50, v51
    v_mfma_f32_16x16x32_bf16 v[40:43], a[96:99], a[244:247], 0
    s_waitcnt lgkmcnt(3)
    ds_read_b128 a[244:247], v1 offset:5120
    v_cvt_pk_bf16_f32 v72, v52, v53
    v_mfma_f32_16x16x32_bf16 v[20:23], a[4:7], a[248:251], v[20:23]
    v_cvt_pk_bf16_f32 v73, v54, v55
    v_cvt_pk_bf16_f32 v76, v56, v57
    v_mfma_f32_16x16x32_bf16 v[24:27], a[52:55], a[248:251], v[24:27]
    v_cvt_pk_bf16_f32 v116, v156, v160
    v_cvt_pk_bf16_f32 v120, v157, v161
    v_mfma_f32_16x16x32_bf16 v[28:31], a[100:103], a[248:251], v[28:31]
    s_waitcnt lgkmcnt(3)
    ds_read_b128 a[248:251], v1 offset:6144
    v_cvt_pk_bf16_f32 v124, v158, v162
    v_mfma_f32_16x16x32_bf16 v[32:35], a[4:7], a[252:255], v[32:35]
    v_cvt_pk_bf16_f32 v128, v159, v163
    v_cvt_pk_bf16_f32 v132, v172, v176
    v_mfma_f32_16x16x32_bf16 v[36:39], a[52:55], a[252:255], v[36:39]
    v_cvt_pk_bf16_f32 v136, v173, v177
    v_cvt_pk_bf16_f32 v140, v174, v178
    v_mfma_f32_16x16x32_bf16 v[40:43], a[100:103], a[252:255], v[40:43]
    s_waitcnt lgkmcnt(3)
    ds_read_b128 a[252:255], v1 offset:7168
    v_cvt_pk_bf16_f32 v144, v175, v179
    v_mfma_f32_16x16x32_bf16 v[20:23], a[8:11], a[240:243], v[20:23]
    v_cvt_pk_bf16_f32 v212, v188, v192
    v_cvt_pk_bf16_f32 v216, v189, v193
    v_mfma_f32_16x16x32_bf16 v[24:27], a[56:59], a[240:243], v[24:27]
    v_cvt_pk_bf16_f32 v220, v190, v194
    v_cvt_pk_bf16_f32 v224, v191, v195
    v_mfma_f32_16x16x32_bf16 v[28:31], a[104:107], a[240:243], v[28:31]
    s_waitcnt lgkmcnt(2)
    ds_read_b128 a[240:243], v1 offset:8192
    v_cvt_pk_bf16_f32 v228, v204, v208
    v_mfma_f32_16x16x32_bf16 v[32:35], a[8:11], a[244:247], v[32:35]
    ds_read_u16 v82, v5 offset:194
    v_cvt_pk_bf16_f32 v77, v58, v59
    v_mfma_f32_16x16x32_bf16 v[36:39], a[56:59], a[244:247], v[36:39]
    v_cvt_pk_bf16_f32 v78, v60, v61
    v_cvt_pk_bf16_f32 v79, v62, v63
    v_mfma_f32_16x16x32_bf16 v[40:43], a[104:107], a[244:247], v[40:43]
    s_waitcnt lgkmcnt(3)
    ds_read_b128 a[244:247], v1 offset:9216
    v_cvt_pk_bf16_f32 v80, v64, v65
    v_mfma_f32_16x16x32_bf16 v[20:23], a[12:15], a[248:251], v[20:23]
    v_cvt_pk_bf16_f32 v81, v66, v67
    v_mfma_f32_16x16x32_bf16 v[24:27], a[60:63], a[248:251], v[24:27]
    buffer_load_dwordx4 v1, s[20:23], s45 offen offset:0 sc1 lds
    v_mfma_f32_16x16x32_bf16 v[28:31], a[108:111], a[248:251], v[28:31]
    s_waitcnt lgkmcnt(3)
    ds_read_b128 a[248:251], v1 offset:10240
    v_mfma_f32_16x16x32_bf16 v[32:35], a[12:15], a[252:255], v[32:35]
    v_mfma_f32_16x16x32_bf16 v[36:39], a[60:63], a[252:255], v[36:39]
    v_mfma_f32_16x16x32_bf16 v[40:43], a[108:111], a[252:255], v[40:43]
    s_waitcnt lgkmcnt(3)
    ds_read_b128 a[252:255], v1 offset:11264
    v_mfma_f32_16x16x32_bf16 v[20:23], a[16:19], a[240:243], v[20:23]
    buffer_load_dwordx4 v1, s[20:23], s45 offen offset:1024 sc1 lds
    v_mfma_f32_16x16x32_bf16 v[24:27], a[64:67], a[240:243], v[24:27]
    v_mfma_f32_16x16x32_bf16 v[28:31], a[112:115], a[240:243], v[28:31]
    s_waitcnt lgkmcnt(2)
    ds_read_b128 a[240:243], v1 offset:12288
    v_mfma_f32_16x16x32_bf16 v[32:35], a[16:19], a[244:247], v[32:35]
    v_mfma_f32_16x16x32_bf16 v[36:39], a[64:67], a[244:247], v[36:39]
    buffer_load_dwordx4 v1, s[20:23], s45 offen offset:2048 sc1 lds
    v_mfma_f32_16x16x32_bf16 v[40:43], a[112:115], a[244:247], v[40:43]
    s_waitcnt lgkmcnt(2)
    ds_read_b128 a[244:247], v1 offset:13312
    v_mfma_f32_16x16x32_bf16 v[20:23], a[20:23], a[248:251], v[20:23]
    v_mfma_f32_16x16x32_bf16 v[24:27], a[68:71], a[248:251], v[24:27]
    v_mfma_f32_16x16x32_bf16 v[28:31], a[116:119], a[248:251], v[28:31]
    s_waitcnt lgkmcnt(2)
    ds_read_b128 a[248:251], v1 offset:14336
    v_mfma_f32_16x16x32_bf16 v[32:35], a[20:23], a[252:255], v[32:35]
    buffer_load_dwordx4 v1, s[20:23], s45 offen offset:3072 sc1 lds
    s_add_u32 s45, s29, 471040
    v_mfma_f32_16x16x32_bf16 v[36:39], a[68:71], a[252:255], v[36:39]
    s_add_u32 m0, s29, 77824
    v_mfma_f32_16x16x32_bf16 v[40:43], a[116:119], a[252:255], v[40:43]
    ds_read_b128 a[252:255], v1 offset:15360
    v_mfma_f32_16x16x32_bf16 v[156:159], v[148:151], v[84:87], 0
    v_mfma_f32_16x16x32_bf16 v[172:175], v[164:167], v[84:87], 0
    buffer_load_dwordx4 v1, s[20:23], s45 offen offset:0 sc1 lds
    v_mfma_f32_16x16x32_bf16 v[188:191], v[180:183], v[84:87], 0
    v_mfma_f32_16x16x32_bf16 v[204:207], v[196:199], v[84:87], 0
    v_mfma_f32_16x16x32_bf16 v[160:163], v[148:151], v[92:95], 0
    v_mfma_f32_16x16x32_bf16 v[176:179], v[164:167], v[92:95], 0
    buffer_load_dwordx4 v1, s[20:23], s45 offen offset:1024 sc1 lds
    v_mfma_f32_16x16x32_bf16 v[192:195], v[180:183], v[92:95], 0
    v_mfma_f32_16x16x32_bf16 v[208:211], v[196:199], v[92:95], 0
    v_mfma_f32_16x16x32_bf16 v[156:159], v[152:155], v[88:91], v[156:159]
    v_mfma_f32_16x16x32_bf16 v[172:175], v[168:171], v[88:91], v[172:175]
    v_mfma_f32_16x16x32_bf16 v[188:191], v[184:187], v[88:91], v[188:191]
    v_mfma_f32_16x16x32_bf16 v[204:207], v[200:203], v[88:91], v[204:207]
    v_mfma_f32_16x16x32_bf16 v[160:163], v[152:155], v[96:99], v[160:163]
    v_mfma_f32_16x16x32_bf16 v[176:179], v[168:171], v[96:99], v[176:179]
    v_mfma_f32_16x16x32_bf16 v[192:195], v[184:187], v[96:99], v[192:195]
    v_mfma_f32_16x16x32_bf16 v[208:211], v[200:203], v[96:99], v[208:211]
    s_waitcnt lgkmcnt(3)
    v_mfma_f32_16x16x32_bf16 v[20:23], a[24:27], a[240:243], v[20:23]
    v_mfma_f32_16x16x32_bf16 v[24:27], a[72:75], a[240:243], v[24:27]
    v_mfma_f32_16x16x32_bf16 v[28:31], a[120:123], a[240:243], v[28:31]
    s_waitcnt lgkmcnt(2)
    ds_read_b128 a[240:243], v1 offset:16384
    v_mfma_f32_16x16x32_bf16 v[32:35], a[24:27], a[244:247], v[32:35]
    v_mfma_f32_16x16x32_bf16 v[36:39], a[72:75], a[244:247], v[36:39]
    v_mfma_f32_16x16x32_bf16 v[40:43], a[120:123], a[244:247], v[40:43]
    s_waitcnt lgkmcnt(2)
    ds_read_b128 a[244:247], v1 offset:17408
    v_mfma_f32_16x16x32_bf16 v[20:23], a[28:31], a[248:251], v[20:23]
    v_mfma_f32_16x16x32_bf16 v[24:27], a[76:79], a[248:251], v[24:27]
    v_cvt_pk_bf16_f32 v117, v156, v160
    v_cvt_pk_bf16_f32 v121, v157, v161
    v_mfma_f32_16x16x32_bf16 v[28:31], a[124:127], a[248:251], v[28:31]
    s_waitcnt lgkmcnt(2)
    ds_read_b128 a[248:251], v1 offset:18432
    v_cvt_pk_bf16_f32 v125, v158, v162
    v_mfma_f32_16x16x32_bf16 v[32:35], a[28:31], a[252:255], v[32:35]
    v_cvt_pk_bf16_f32 v129, v159, v163
    v_cvt_pk_bf16_f32 v133, v172, v176
    v_mfma_f32_16x16x32_bf16 v[36:39], a[76:79], a[252:255], v[36:39]
    v_cvt_pk_bf16_f32 v137, v173, v177
    v_cvt_pk_bf16_f32 v141, v174, v178
    v_mfma_f32_16x16x32_bf16 v[40:43], a[124:127], a[252:255], v[40:43]
    s_waitcnt lgkmcnt(2)
    ds_read_b128 a[252:255], v1 offset:19456
    v_cvt_pk_bf16_f32 v145, v175, v179
    v_mfma_f32_16x16x32_bf16 v[20:23], a[32:35], a[240:243], v[20:23]
    v_cvt_pk_bf16_f32 v213, v188, v192
    v_cvt_pk_bf16_f32 v217, v189, v193
    v_mfma_f32_16x16x32_bf16 v[24:27], a[80:83], a[240:243], v[24:27]
    v_cvt_pk_bf16_f32 v221, v190, v194
    v_cvt_pk_bf16_f32 v225, v191, v195
    v_mfma_f32_16x16x32_bf16 v[28:31], a[128:131], a[240:243], v[28:31]
    s_waitcnt lgkmcnt(2)
    ds_read_b128 a[240:243], v1 offset:20480
    v_cvt_pk_bf16_f32 v229, v204, v208
    v_mfma_f32_16x16x32_bf16 v[32:35], a[32:35], a[244:247], v[32:35]
    v_mfma_f32_16x16x32_bf16 v[36:39], a[80:83], a[244:247], v[36:39]
    v_mfma_f32_16x16x32_bf16 v[40:43], a[128:131], a[244:247], v[40:43]
    s_waitcnt lgkmcnt(2)
    ds_read_b128 a[244:247], v1 offset:21504
    v_mfma_f32_16x16x32_bf16 v[20:23], a[36:39], a[248:251], v[20:23]
    v_mfma_f32_16x16x32_bf16 v[24:27], a[84:87], a[248:251], v[24:27]
    v_mfma_f32_16x16x32_bf16 v[28:31], a[132:135], a[248:251], v[28:31]
    s_waitcnt lgkmcnt(2)
    ds_read_b128 a[248:251], v1 offset:22528
    v_mfma_f32_16x16x32_bf16 v[32:35], a[36:39], a[252:255], v[32:35]
    v_mfma_f32_16x16x32_bf16 v[36:39], a[84:87], a[252:255], v[36:39]
    v_mfma_f32_16x16x32_bf16 v[40:43], a[132:135], a[252:255], v[40:43]
    s_waitcnt lgkmcnt(2)
    ds_read_b128 a[252:255], v1 offset:23552
    v_mfma_f32_16x16x32_bf16 v[20:23], a[40:43], a[240:243], v[20:23]
    v_mfma_f32_16x16x32_bf16 v[24:27], a[88:91], a[240:243], v[24:27]
    v_mfma_f32_16x16x32_bf16 v[28:31], a[136:139], a[240:243], v[28:31]
    s_waitcnt lgkmcnt(2)
    ds_read_b128 a[240:243], v1 offset:24576
    v_mfma_f32_16x16x32_bf16 v[32:35], a[40:43], a[244:247], v[32:35]
    v_mfma_f32_16x16x32_bf16 v[36:39], a[88:91], a[244:247], v[36:39]
    v_mfma_f32_16x16x32_bf16 v[40:43], a[136:139], a[244:247], v[40:43]
    s_waitcnt lgkmcnt(2)
    ds_read_b128 a[244:247], v1 offset:25600
    v_mfma_f32_16x16x32_bf16 v[20:23], a[44:47], a[248:251], v[20:23]
    v_mfma_f32_16x16x32_bf16 v[24:27], a[92:95], a[248:251], v[24:27]
    v_mfma_f32_16x16x32_bf16 v[28:31], a[140:143], a[248:251], v[28:31]
    s_waitcnt lgkmcnt(2)
    ds_read_b128 a[248:251], v1 offset:26624
    v_mfma_f32_16x16x32_bf16 v[32:35], a[44:47], a[252:255], v[32:35]
    v_mfma_f32_16x16x32_bf16 v[36:39], a[92:95], a[252:255], v[36:39]
    v_mfma_f32_16x16x32_bf16 v[40:43], a[140:143], a[252:255], v[40:43]
    buffer_load_ubyte v0, off, s[48:51], s37 sc1
    v_mfma_f32_16x16x32_bf16 v[156:159], v[148:151], v[100:103], 0
    v_mfma_f32_16x16x32_bf16 v[172:175], v[164:167], v[100:103], 0
    v_mfma_f32_16x16x32_bf16 v[188:191], v[180:183], v[100:103], 0
    v_mfma_f32_16x16x32_bf16 v[204:207], v[196:199], v[100:103], 0
    v_mfma_f32_16x16x32_bf16 v[160:163], v[148:151], v[108:111], 0
    v_mfma_f32_16x16x32_bf16 v[176:179], v[164:167], v[108:111], 0
    v_mfma_f32_16x16x32_bf16 v[192:195], v[180:183], v[108:111], 0
    v_mfma_f32_16x16x32_bf16 v[208:211], v[196:199], v[108:111], 0
    v_mfma_f32_16x16x32_bf16 v[156:159], v[152:155], v[104:107], v[156:159]
    v_mfma_f32_16x16x32_bf16 v[172:175], v[168:171], v[104:107], v[172:175]
    v_mfma_f32_16x16x32_bf16 v[188:191], v[184:187], v[104:107], v[188:191]
    v_mfma_f32_16x16x32_bf16 v[204:207], v[200:203], v[104:107], v[204:207]
    v_mfma_f32_16x16x32_bf16 v[160:163], v[152:155], v[112:115], v[160:163]
    v_mfma_f32_16x16x32_bf16 v[176:179], v[168:171], v[112:115], v[176:179]
    v_mfma_f32_16x16x32_bf16 v[192:195], v[184:187], v[112:115], v[192:195]
    v_mfma_f32_16x16x32_bf16 v[208:211], v[200:203], v[112:115], v[208:211]
    s_waitcnt lgkmcnt(2)
    v_mfma_f32_16x16x32_bf16 v[44:47], a[0:3], a[240:243], 0
    ds_read_b128 a[252:255], v1 offset:27648
    v_mfma_f32_16x16x32_bf16 v[48:51], a[48:51], a[240:243], 0
    v_cvt_pk_bf16_f32 v84, v20, v21
    v_cvt_pk_bf16_f32 v85, v22, v23
    v_mfma_f32_16x16x32_bf16 v[52:55], a[96:99], a[240:243], 0
    s_waitcnt lgkmcnt(2)
    ds_read_b128 a[240:243], v1 offset:28672
    v_cvt_pk_bf16_f32 v86, v24, v25
    v_mfma_f32_16x16x32_bf16 v[56:59], a[0:3], a[244:247], 0
    v_cvt_pk_bf16_f32 v87, v26, v27
    v_cvt_pk_bf16_f32 v88, v28, v29
    v_mfma_f32_16x16x32_bf16 v[60:63], a[48:51], a[244:247], 0
    ds_read_u16 v90, v5 offset:256
    v_cvt_pk_bf16_f32 v89, v30, v31
    v_mfma_f32_16x16x32_bf16 v[64:67], a[96:99], a[244:247], 0
    s_waitcnt lgkmcnt(3)
    ds_read_b128 a[244:247], v1 offset:29696
    v_cvt_pk_bf16_f32 v92, v32, v33
    v_mfma_f32_16x16x32_bf16 v[44:47], a[4:7], a[248:251], v[44:47]
    v_cvt_pk_bf16_f32 v93, v34, v35
    v_cvt_pk_bf16_f32 v94, v36, v37
    v_mfma_f32_16x16x32_bf16 v[48:51], a[52:55], a[248:251], v[48:51]
    v_cvt_pk_bf16_f32 v118, v156, v160
    v_cvt_pk_bf16_f32 v122, v157, v161
    v_mfma_f32_16x16x32_bf16 v[52:55], a[100:103], a[248:251], v[52:55]
    s_waitcnt lgkmcnt(3)
    ds_read_b128 a[248:251], v1 offset:30720
    v_cvt_pk_bf16_f32 v126, v158, v162
    v_mfma_f32_16x16x32_bf16 v[56:59], a[4:7], a[252:255], v[56:59]
    v_cvt_pk_bf16_f32 v130, v159, v163
    v_cvt_pk_bf16_f32 v134, v172, v176
    v_mfma_f32_16x16x32_bf16 v[60:63], a[52:55], a[252:255], v[60:63]
    v_cvt_pk_bf16_f32 v138, v173, v177
    v_cvt_pk_bf16_f32 v142, v174, v178
    v_mfma_f32_16x16x32_bf16 v[64:67], a[100:103], a[252:255], v[64:67]
    s_waitcnt lgkmcnt(3)
    ds_read_b128 a[252:255], v1 offset:31744
    v_cvt_pk_bf16_f32 v146, v175, v179
    v_mfma_f32_16x16x32_bf16 v[44:47], a[8:11], a[240:243], v[44:47]
    v_cvt_pk_bf16_f32 v214, v188, v192
    v_cvt_pk_bf16_f32 v218, v189, v193
    v_mfma_f32_16x16x32_bf16 v[48:51], a[56:59], a[240:243], v[48:51]
    v_cvt_pk_bf16_f32 v222, v190, v194
    v_cvt_pk_bf16_f32 v226, v191, v195
    v_mfma_f32_16x16x32_bf16 v[52:55], a[104:107], a[240:243], v[52:55]
    s_waitcnt lgkmcnt(2)
    ds_read_b128 a[240:243], v1 offset:32768
    v_cvt_pk_bf16_f32 v230, v204, v208
    v_mfma_f32_16x16x32_bf16 v[56:59], a[8:11], a[244:247], v[56:59]
    ds_read_u16 v98, v5 offset:258
    v_cvt_pk_bf16_f32 v95, v38, v39
    v_mfma_f32_16x16x32_bf16 v[60:63], a[56:59], a[244:247], v[60:63]
    v_cvt_pk_bf16_f32 v96, v40, v41
    v_cvt_pk_bf16_f32 v97, v42, v43
    v_mfma_f32_16x16x32_bf16 v[64:67], a[104:107], a[244:247], v[64:67]
    s_waitcnt lgkmcnt(3)
    ds_read_b128 a[244:247], v1 offset:33792
    v_mfma_f32_16x16x32_bf16 v[44:47], a[12:15], a[248:251], v[44:47]
    v_mfma_f32_16x16x32_bf16 v[48:51], a[60:63], a[248:251], v[48:51]
    v_mfma_f32_16x16x32_bf16 v[52:55], a[108:111], a[248:251], v[52:55]
    s_waitcnt lgkmcnt(3)
    ds_read_b128 a[248:251], v1 offset:34816
    v_mfma_f32_16x16x32_bf16 v[56:59], a[12:15], a[252:255], v[56:59]
    v_mfma_f32_16x16x32_bf16 v[60:63], a[60:63], a[252:255], v[60:63]
    v_mfma_f32_16x16x32_bf16 v[64:67], a[108:111], a[252:255], v[64:67]
    s_waitcnt lgkmcnt(3)
    ds_read_b128 a[252:255], v1 offset:35840
    v_mfma_f32_16x16x32_bf16 v[44:47], a[16:19], a[240:243], v[44:47]
    v_mfma_f32_16x16x32_bf16 v[48:51], a[64:67], a[240:243], v[48:51]
    v_mfma_f32_16x16x32_bf16 v[52:55], a[112:115], a[240:243], v[52:55]
    s_waitcnt lgkmcnt(2)
    ds_read_b128 a[240:243], v1 offset:36864
    v_mfma_f32_16x16x32_bf16 v[56:59], a[16:19], a[244:247], v[56:59]
    v_mfma_f32_16x16x32_bf16 v[60:63], a[64:67], a[244:247], v[60:63]
    v_mfma_f32_16x16x32_bf16 v[64:67], a[112:115], a[244:247], v[64:67]
    s_waitcnt lgkmcnt(2)
    ds_read_b128 a[244:247], v1 offset:37888
    v_mfma_f32_16x16x32_bf16 v[44:47], a[20:23], a[248:251], v[44:47]
    v_mfma_f32_16x16x32_bf16 v[48:51], a[68:71], a[248:251], v[48:51]
    v_mfma_f32_16x16x32_bf16 v[52:55], a[116:119], a[248:251], v[52:55]
    s_waitcnt lgkmcnt(2)
    ds_read_b128 a[248:251], v1 offset:38912
    v_mfma_f32_16x16x32_bf16 v[56:59], a[20:23], a[252:255], v[56:59]
    v_mfma_f32_16x16x32_bf16 v[60:63], a[68:71], a[252:255], v[60:63]
    v_mfma_f32_16x16x32_bf16 v[64:67], a[116:119], a[252:255], v[64:67]
    ds_read_b128 a[252:255], v1 offset:39936
    v_mfma_f32_16x16x32_bf16 v[156:159], v[148:151], v[68:71], 0
    v_mfma_f32_16x16x32_bf16 v[172:175], v[164:167], v[68:71], 0
    v_mfma_f32_16x16x32_bf16 v[188:191], v[180:183], v[68:71], 0
    v_mfma_f32_16x16x32_bf16 v[204:207], v[196:199], v[68:71], 0
    v_mfma_f32_16x16x32_bf16 v[160:163], v[148:151], v[76:79], 0
    v_mfma_f32_16x16x32_bf16 v[176:179], v[164:167], v[76:79], 0
    v_mfma_f32_16x16x32_bf16 v[192:195], v[180:183], v[76:79], 0
    v_mfma_f32_16x16x32_bf16 v[208:211], v[196:199], v[76:79], 0
    v_mfma_f32_16x16x32_bf16 v[156:159], v[152:155], v[72:75], v[156:159]
    v_mfma_f32_16x16x32_bf16 v[172:175], v[168:171], v[72:75], v[172:175]
    v_mfma_f32_16x16x32_bf16 v[188:191], v[184:187], v[72:75], v[188:191]
    v_mfma_f32_16x16x32_bf16 v[204:207], v[200:203], v[72:75], v[204:207]
    v_mfma_f32_16x16x32_bf16 v[160:163], v[152:155], v[80:83], v[160:163]
    v_mfma_f32_16x16x32_bf16 v[176:179], v[168:171], v[80:83], v[176:179]
    v_mfma_f32_16x16x32_bf16 v[192:195], v[184:187], v[80:83], v[192:195]
    v_mfma_f32_16x16x32_bf16 v[208:211], v[200:203], v[80:83], v[208:211]
    s_waitcnt lgkmcnt(3)
    v_mfma_f32_16x16x32_bf16 v[44:47], a[24:27], a[240:243], v[44:47]
    v_mfma_f32_16x16x32_bf16 v[48:51], a[72:75], a[240:243], v[48:51]
    v_mfma_f32_16x16x32_bf16 v[52:55], a[120:123], a[240:243], v[52:55]
    s_waitcnt lgkmcnt(2)
    ds_read_b128 a[240:243], v1 offset:40960
    v_mfma_f32_16x16x32_bf16 v[56:59], a[24:27], a[244:247], v[56:59]
    v_mfma_f32_16x16x32_bf16 v[60:63], a[72:75], a[244:247], v[60:63]
    v_mfma_f32_16x16x32_bf16 v[64:67], a[120:123], a[244:247], v[64:67]
    s_waitcnt lgkmcnt(2)
    ds_read_b128 a[244:247], v1 offset:41984
    v_mfma_f32_16x16x32_bf16 v[44:47], a[28:31], a[248:251], v[44:47]
    v_mfma_f32_16x16x32_bf16 v[48:51], a[76:79], a[248:251], v[48:51]
    v_cvt_pk_bf16_f32 v119, v156, v160
    v_cvt_pk_bf16_f32 v123, v157, v161
    v_mfma_f32_16x16x32_bf16 v[52:55], a[124:127], a[248:251], v[52:55]
    s_waitcnt lgkmcnt(2)
    ds_read_b128 a[248:251], v1 offset:43008
    v_cvt_pk_bf16_f32 v127, v158, v162
    v_mfma_f32_16x16x32_bf16 v[56:59], a[28:31], a[252:255], v[56:59]
    v_cvt_pk_bf16_f32 v131, v159, v163
    v_cvt_pk_bf16_f32 v135, v172, v176
    v_mfma_f32_16x16x32_bf16 v[60:63], a[76:79], a[252:255], v[60:63]
    v_cvt_pk_bf16_f32 v139, v173, v177
    v_cvt_pk_bf16_f32 v143, v174, v178
    v_mfma_f32_16x16x32_bf16 v[64:67], a[124:127], a[252:255], v[64:67]
    s_waitcnt lgkmcnt(2)
    ds_read_b128 a[252:255], v1 offset:44032
    v_cvt_pk_bf16_f32 v147, v175, v179
    v_mfma_f32_16x16x32_bf16 v[44:47], a[32:35], a[240:243], v[44:47]
    v_cvt_pk_bf16_f32 v215, v188, v192
    v_cvt_pk_bf16_f32 v219, v189, v193
    v_mfma_f32_16x16x32_bf16 v[48:51], a[80:83], a[240:243], v[48:51]
    v_cvt_pk_bf16_f32 v223, v190, v194
    v_cvt_pk_bf16_f32 v227, v191, v195
    v_mfma_f32_16x16x32_bf16 v[52:55], a[128:131], a[240:243], v[52:55]
    s_waitcnt lgkmcnt(2)
    ds_read_b128 a[240:243], v1 offset:45056
    v_cvt_pk_bf16_f32 v231, v204, v208
    v_mfma_f32_16x16x32_bf16 v[56:59], a[32:35], a[244:247], v[56:59]
    buffer_store_dwordx4 v[116:119], v7, s[24:27], s34 offen offset:0 nt
    v_mfma_f32_16x16x32_bf16 v[60:63], a[80:83], a[244:247], v[60:63]
    v_mfma_f32_16x16x32_bf16 v[64:67], a[128:131], a[244:247], v[64:67]
    s_waitcnt lgkmcnt(2)
    ds_read_b128 a[244:247], v1 offset:46080
    v_mfma_f32_16x16x32_bf16 v[44:47], a[36:39], a[248:251], v[44:47]
    v_mfma_f32_16x16x32_bf16 v[48:51], a[84:87], a[248:251], v[48:51]
    buffer_store_dwordx4 v[120:123], v8, s[24:27], s34 offen offset:0 nt
    v_mfma_f32_16x16x32_bf16 v[52:55], a[132:135], a[248:251], v[52:55]
    s_waitcnt lgkmcnt(2)
    ds_read_b128 a[248:251], v1 offset:47104
    v_mfma_f32_16x16x32_bf16 v[56:59], a[36:39], a[252:255], v[56:59]
    v_mfma_f32_16x16x32_bf16 v[60:63], a[84:87], a[252:255], v[60:63]
    v_mfma_f32_16x16x32_bf16 v[64:67], a[132:135], a[252:255], v[64:67]
    s_waitcnt lgkmcnt(2)
    ds_read_b128 a[252:255], v1 offset:48128
    v_mfma_f32_16x16x32_bf16 v[44:47], a[40:43], a[240:243], v[44:47]
    buffer_store_dwordx4 v[124:127], v9, s[24:27], s34 offen offset:0 nt
    v_mfma_f32_16x16x32_bf16 v[48:51], a[88:91], a[240:243], v[48:51]
    v_mfma_f32_16x16x32_bf16 v[52:55], a[136:139], a[240:243], v[52:55]
    s_waitcnt lgkmcnt(2)
    v_mfma_f32_16x16x32_bf16 v[56:59], a[40:43], a[244:247], v[56:59]
    v_mfma_f32_16x16x32_bf16 v[60:63], a[88:91], a[244:247], v[60:63]
    buffer_store_dwordx4 v[128:131], v10, s[24:27], s34 offen offset:0 nt
    v_mfma_f32_16x16x32_bf16 v[64:67], a[136:139], a[244:247], v[64:67]
    s_waitcnt lgkmcnt(1)
    v_mfma_f32_16x16x32_bf16 v[44:47], a[44:47], a[248:251], v[44:47]
    v_mfma_f32_16x16x32_bf16 v[48:51], a[92:95], a[248:251], v[48:51]
    v_mfma_f32_16x16x32_bf16 v[52:55], a[140:143], a[248:251], v[52:55]
    s_waitcnt vmcnt(5) lgkmcnt(0)
    s_barrier
    ds_read_b128 a[240:243], v2 offset:0
    v_mfma_f32_16x16x32_bf16 v[56:59], a[44:47], a[252:255], v[56:59]
    ds_read_b128 a[244:247], v2 offset:1024
    v_mfma_f32_16x16x32_bf16 v[60:63], a[92:95], a[252:255], v[60:63]
    s_add_u32 s45, s29, 491520
    s_add_u32 m0, s29, 0
    ds_read_b128 a[248:251], v2 offset:2048
    v_mfma_f32_16x16x32_bf16 v[64:67], a[140:143], a[252:255], v[64:67]
    buffer_load_dwordx4 v1, s[20:23], s45 offen offset:0 sc1 lds
    v_mfma_f32_16x16x32_bf16 v[156:159], v[148:151], v[84:87], 0
    v_mfma_f32_16x16x32_bf16 v[172:175], v[164:167], v[84:87], 0
    v_mfma_f32_16x16x32_bf16 v[188:191], v[180:183], v[84:87], 0
    v_mfma_f32_16x16x32_bf16 v[204:207], v[196:199], v[84:87], 0
    buffer_load_dwordx4 v1, s[20:23], s45 offen offset:1024 sc1 lds
    v_mfma_f32_16x16x32_bf16 v[160:163], v[148:151], v[92:95], 0
    v_mfma_f32_16x16x32_bf16 v[176:179], v[164:167], v[92:95], 0
    v_mfma_f32_16x16x32_bf16 v[192:195], v[180:183], v[92:95], 0
    v_mfma_f32_16x16x32_bf16 v[208:211], v[196:199], v[92:95], 0
    buffer_load_dwordx4 v1, s[20:23], s45 offen offset:2048 sc1 lds
    v_mfma_f32_16x16x32_bf16 v[156:159], v[152:155], v[88:91], v[156:159]
    v_mfma_f32_16x16x32_bf16 v[172:175], v[168:171], v[88:91], v[172:175]
    s_waitcnt vmcnt(7)
    v_readfirstlane_b32 s60, v0
    s_nop 1
    s_cmp_ge_u32 s60, 3
    s_cbranch_scc0 L_slow_vb
L_back_vb:
    v_mfma_f32_16x16x32_bf16 v[188:191], v[184:187], v[88:91], v[188:191]
    v_mfma_f32_16x16x32_bf16 v[204:207], v[200:203], v[88:91], v[204:207]
    buffer_load_dwordx4 v1, s[20:23], s45 offen offset:3072 sc1 lds
    s_add_u32 s45, s29, 495616
    v_mfma_f32_16x16x32_bf16 v[160:163], v[152:155], v[96:99], v[160:163]
    s_add_u32 m0, s29, 4096
    v_mfma_f32_16x16x32_bf16 v[176:179], v[168:171], v[96:99], v[176:179]
    v_mfma_f32_16x16x32_bf16 v[192:195], v[184:187], v[96:99], v[192:195]
    v_mfma_f32_16x16x32_bf16 v[208:211], v[200:203], v[96:99], v[208:211]
    s_waitcnt lgkmcnt(2)
    buffer_load_dwordx4 v1, s[20:23], s45 offen offset:0 sc1 lds
    v_mfma_f32_16x16x32_bf16 v[20:23], a[0:3], a[240:243], 0
    ds_read_b128 a[252:255], v2 offset:3072
    v_mfma_f32_16x16x32_bf16 v[24:27], a[48:51], a[240:243], 0
    v_cvt_pk_bf16_f32 v100, v44, v45
    v_cvt_pk_bf16_f32 v101, v46, v47
    v_mfma_f32_16x16x32_bf16 v[28:31], a[96:99], a[240:243], 0
    s_waitcnt lgkmcnt(2)
    ds_read_b128 a[240:243], v2 offset:4096
    v_cvt_pk_bf16_f32 v102, v48, v49
    v_mfma_f32_16x16x32_bf16 v[32:35], a[0:3], a[244:247], 0
    buffer_load_dwordx4 v1, s[20:23], s45 offen offset:1024 sc1 lds
    s_add_u32 s45, s29, 516096
    v_mfma_f32_16x16x32_bf16 v[36:39], a[48:51], a[244:247], 0
    s_add_u32 m0, s29, 24576
    ds_read_u16 v106, v5 offset:320
    v_cvt_pk_bf16_f32 v103, v50, v51
    v_mfma_f32_16x16x32_bf16 v[40:43], a[96:99], a[244:247], 0
    s_waitcnt lgkmcnt(3)
    ds_read_b128 a[244:247], v2 offset:5120
    v_cvt_pk_bf16_f32 v104, v52, v53
    v_mfma_f32_16x16x32_bf16 v[20:23], a[4:7], a[248:251], v[20:23]
    v_cvt_pk_bf16_f32 v105, v54, v55
    v_cvt_pk_bf16_f32 v108, v56, v57
    v_mfma_f32_16x16x32_bf16 v[24:27], a[52:55], a[248:251], v[24:27]
    ds_read_u16 v114, v5 offset:322
    v_cvt_pk_bf16_f32 v109, v58, v59
    v_mfma_f32_16x16x32_bf16 v[28:31], a[100:103], a[248:251], v[28:31]
    s_waitcnt lgkmcnt(4)
    ds_read_b128 a[248:251], v2 offset:6144
    v_cvt_pk_bf16_f32 v110, v60, v61
    v_mfma_f32_16x16x32_bf16 v[32:35], a[4:7], a[252:255], v[32:35]
    buffer_load_dwordx4 v1, s[20:23], s45 offen offset:0 sc1 lds
    v_mfma_f32_16x16x32_bf16 v[36:39], a[52:55], a[252:255], v[36:39]
    v_cvt_pk_bf16_f32 v111, v62, v63
    v_cvt_pk_bf16_f32 v112, v64, v65
    v_mfma_f32_16x16x32_bf16 v[40:43], a[100:103], a[252:255], v[40:43]
    s_waitcnt lgkmcnt(4)
    ds_read_b128 a[252:255], v2 offset:7168
    v_cvt_pk_bf16_f32 v113, v66, v67
    v_mfma_f32_16x16x32_bf16 v[20:23], a[8:11], a[240:243], v[20:23]
    v_cvt_pk_bf16_f32 v116, v156, v160
    v_cvt_pk_bf16_f32 v120, v157, v161
    v_mfma_f32_16x16x32_bf16 v[24:27], a[56:59], a[240:243], v[24:27]
    buffer_load_dwordx4 v1, s[20:23], s45 offen offset:1024 sc1 lds
    v_mfma_f32_16x16x32_bf16 v[28:31], a[104:107], a[240:243], v[28:31]
    s_waitcnt lgkmcnt(3)
    ds_read_b128 a[240:243], v2 offset:8192
    v_cvt_pk_bf16_f32 v124, v158, v162
    v_mfma_f32_16x16x32_bf16 v[32:35], a[8:11], a[244:247], v[32:35]
    v_cvt_pk_bf16_f32 v128, v159, v163
    v_mfma_f32_16x16x32_bf16 v[36:39], a[56:59], a[244:247], v[36:39]
    v_mfma_f32_16x16x32_bf16 v[40:43], a[104:107], a[244:247], v[40:43]
    s_waitcnt lgkmcnt(2)
    ds_read_b128 a[244:247], v2 offset:9216
    v_mfma_f32_16x16x32_bf16 v[20:23], a[12:15], a[248:251], v[20:23]
    buffer_load_dwordx4 v1, s[20:23], s45 offen offset:2048 sc1 lds
    v_mfma_f32_16x16x32_bf16 v[24:27], a[60:63], a[248:251], v[24:27]
    v_mfma_f32_16x16x32_bf16 v[28:31], a[108:111], a[248:251], v[28:31]
    s_waitcnt lgkmcnt(2)
    ds_read_b128 a[248:251], v2 offset:10240
    v_mfma_f32_16x16x32_bf16 v[32:35], a[12:15], a[252:255], v[32:35]
    v_mfma_f32_16x16x32_bf16 v[36:39], a[60:63], a[252:255], v[36:39]
    buffer_load_dwordx4 v1, s[20:23], s45 offen offset:3072 sc1 lds
    s_add_u32 s45, s29, 520192
    v_mfma_f32_16x16x32_bf16 v[40:43], a[108:111], a[252:255], v[40:43]
    s_waitcnt lgkmcnt(2)
    s_add_u32 m0, s29, 28672
    ds_read_b128 a[252:255], v2 offset:11264
    v_mfma_f32_16x16x32_bf16 v[20:23], a[16:19], a[240:243], v[20:23]
    v_mfma_f32_16x16x32_bf16 v[24:27], a[64:67], a[240:243], v[24:27]
    v_mfma_f32_16x16x32_bf16 v[28:31], a[112:115], a[240:243], v[28:31]
    s_waitcnt lgkmcnt(2)
    ds_read_b128 a[240:243], v2 offset:12288
    v_mfma_f32_16x16x32_bf16 v[32:35], a[16:19], a[244:247], v[32:35]
    buffer_load_dwordx4 v1, s[20:23], s45 offen offset:0 sc1 lds
    v_mfma_f32_16x16x32_bf16 v[36:39], a[64:67], a[244:247], v[36:39]
    v_mfma_f32_16x16x32_bf16 v[40:43], a[112:115], a[244:247], v[40:43]
    s_waitcnt lgkmcnt(2)
    ds_read_b128 a[244:247], v2 offset:13312
    v_mfma_f32_16x16x32_bf16 v[20:23], a[20:23], a[248:251], v[20:23]
    v_mfma_f32_16x16x32_bf16 v[24:27], a[68:71], a[248:251], v[24:27]
    buffer_load_dwordx4 v1, s[20:23], s45 offen offset:1024 sc1 lds
    s_add_u32 s41, s36, 1280
    v_mfma_f32_16x16x32_bf16 v[28:31], a[116:119], a[248:251], v[28:31]
    s_waitcnt lgkmcnt(2)
    s_add_u32 m0, s32, 2048
    ds_read_b128 a[248:251], v2 offset:14336
    v_mfma_f32_16x16x32_bf16 v[32:35], a[20:23], a[252:255], v[32:35]
    v_mfma_f32_16x16x32_bf16 v[36:39], a[68:71], a[252:255], v[36:39]
    v_mfma_f32_16x16x32_bf16 v[40:43], a[116:119], a[252:255], v[40:43]
    s_waitcnt lgkmcnt(2)
    ds_read_b128 a[252:255], v2 offset:15360
    v_mfma_f32_16x16x32_bf16 v[20:23], a[24:27], a[240:243], v[20:23]
    s_mov_b64 exec, 0xffff
    buffer_load_dwordx4 v1, s[20:23], s41 offen sc1 lds
    s_mov_b64 exec, -1
    v_mfma_f32_16x16x32_bf16 v[24:27], a[72:75], a[240:243], v[24:27]
    v_mfma_f32_16x16x32_bf16 v[28:31], a[120:123], a[240:243], v[28:31]
    s_waitcnt lgkmcnt(2)
    ds_read_b128 a[240:243], v2 offset:16384
    v_mfma_f32_16x16x32_bf16 v[32:35], a[24:27], a[244:247], v[32:35]
    v_mfma_f32_16x16x32_bf16 v[36:39], a[72:75], a[244:247], v[36:39]
    buffer_store_dwordx4 v[132:135], v11, s[24:27], s34 offen offset:0 nt
    v_mfma_f32_16x16x32_bf16 v[40:43], a[120:123], a[244:247], v[40:43]
    s_waitcnt lgkmcnt(2)
    ds_read_b128 a[244:247], v2 offset:17408
    v_mfma_f32_16x16x32_bf16 v[20:23], a[28:31], a[248:251], v[20:23]
    v_cvt_pk_bf16_f32 v132, v172, v176
    v_mfma_f32_16x16x32_bf16 v[24:27], a[76:79], a[248:251], v[24:27]
    v_mfma_f32_16x16x32_bf16 v[28:31], a[124:127], a[248:251], v[28:31]
    s_waitcnt lgkmcnt(2)
    ds_read_b128 a[248:251], v2 offset:18432
    v_mfma_f32_16x16x32_bf16 v[32:35], a[28:31], a[252:255], v[32:35]
    buffer_store_dwordx4 v[136:139], v12, s[24:27], s34 offen offset:0 nt
    v_mfma_f32_16x16x32_bf16 v[36:39], a[76:79], a[252:255], v[36:39]
    v_mfma_f32_16x16x32_bf16 v[40:43], a[124:127], a[252:255], v[40:43]
    s_waitcnt lgkmcnt(2)
    ds_read_b128 a[252:255], v2 offset:19456
    v_cvt_pk_bf16_f32 v136, v173, v177
    v_mfma_f32_16x16x32_bf16 v[20:23], a[32:35], a[240:243], v[20:23]
    v_mfma_f32_16x16x32_bf16 v[24:27], a[80:83], a[240:243], v[24:27]
    buffer_store_dwordx4 v[140:143], v13, s[24:27], s34 offen offset:0 nt
    v_mfma_f32_16x16x32_bf16 v[28:31], a[128:131], a[240:243], v[28:31]
    s_waitcnt lgkmcnt(2)
    ds_read_b128 a[240:243], v2 offset:20480
    v_mfma_f32_16x16x32_bf16 v[32:35], a[32:35], a[244:247], v[32:35]
    v_cvt_pk_bf16_f32 v140, v174, v178
    v_mfma_f32_16x16x32_bf16 v[36:39], a[80:83], a[244:247], v[36:39]
    v_mfma_f32_16x16x32_bf16 v[40:43], a[128:131], a[244:247], v[40:43]
    s_waitcnt lgkmcnt(2)
    ds_read_b128 a[244:247], v2 offset:21504
    v_mfma_f32_16x16x32_bf16 v[20:23], a[36:39], a[248:251], v[20:23]
    buffer_store_dwordx4 v[144:147], v14, s[24:27], s34 offen offset:0 nt
    v_mfma_f32_16x16x32_bf16 v[24:27], a[84:87], a[248:251], v[24:27]
    v_mfma_f32_16x16x32_bf16 v[28:31], a[132:135], a[248:251], v[28:31]
    s_waitcnt lgkmcnt(2)
    ds_read_b128 a[248:251], v2 offset:22528
    v_cvt_pk_bf16_f32 v144, v175, v179
    v_mfma_f32_16x16x32_bf16 v[32:35], a[36:39], a[252:255], v[32:35]
    v_mfma_f32_16x16x32_bf16 v[36:39], a[84:87], a[252:255], v[36:39]
    buffer_store_dwordx4 v[212:215], v15, s[24:27], s34 offen offset:0 nt
    v_mfma_f32_16x16x32_bf16 v[40:43], a[132:135], a[252:255], v[40:43]
    s_waitcnt lgkmcnt(2)
    ds_read_b128 a[252:255], v2 offset:23552
    v_mfma_f32_16x16x32_bf16 v[20:23], a[40:43], a[240:243], v[20:23]
    v_cvt_pk_bf16_f32 v212, v188, v192
    v_mfma_f32_16x16x32_bf16 v[24:27], a[88:91], a[240:243], v[24:27]
    v_mfma_f32_16x16x32_bf16 v[28:31], a[136:139], a[240:243], v[28:31]
    s_waitcnt lgkmcnt(2)
    ds_read_b128 a[240:243], v2 offset:24576
    v_mfma_f32_16x16x32_bf16 v[32:35], a[40:43], a[244:247], v[32:35]
    buffer_store_dwordx4 v[216:219], v16, s[24:27], s34 offen offset:0 nt
    v_mfma_f32_16x16x32_bf16 v[36:39], a[88:91], a[244:247], v[36:39]
    v_mfma_f32_16x16x32_bf16 v[40:43], a[136:139], a[244:247], v[40:43]
    s_waitcnt lgkmcnt(2)
    ds_read_b128 a[244:247], v2 offset:25600
    v_cvt_pk_bf16_f32 v216, v189, v193
    v_mfma_f32_16x16x32_bf16 v[20:23], a[44:47], a[248:251], v[20:23]
    buffer_store_dwordx4 v[220:223], v17, s[24:27], s34 offen offset:0 nt
    buffer_store_dwordx4 v[224:227], v18, s[24:27], s34 offen offset:0 nt
    buffer_store_dwordx4 v[228:231], v19, s[24:27], s34 offen offset:0 nt
    v_mfma_f32_16x16x32_bf16 v[24:27], a[92:95], a[248:251], v[24:27]
    v_mfma_f32_16x16x32_bf16 v[28:31], a[140:143], a[248:251], v[28:31]
    s_waitcnt lgkmcnt(2)
    ds_read_b128 a[248:251], v2 offset:26624
    v_cvt_pk_bf16_f32 v220, v190, v194
    v_mfma_f32_16x16x32_bf16 v[32:35], a[44:47], a[252:255], v[32:35]
    v_cvt_pk_bf16_f32 v224, v191, v195
    v_cvt_pk_bf16_f32 v228, v204, v208
    v_mfma_f32_16x16x32_bf16 v[36:39], a[92:95], a[252:255], v[36:39]
    v_mfma_f32_16x16x32_bf16 v[40:43], a[140:143], a[252:255], v[40:43]
    v_mfma_f32_16x16x32_bf16 v[156:159], v[148:151], v[100:103], 0
    v_mfma_f32_16x16x32_bf16 v[172:175], v[164:167], v[100:103], 0
    v_mfma_f32_16x16x32_bf16 v[188:191], v[180:183], v[100:103], 0
    v_mfma_f32_16x16x32_bf16 v[204:207], v[196:199], v[100:103], 0
    v_mfma_f32_16x16x32_bf16 v[160:163], v[148:151], v[108:111], 0
    v_mfma_f32_16x16x32_bf16 v[176:179], v[164:167], v[108:111], 0
    v_mfma_f32_16x16x32_bf16 v[192:195], v[180:183], v[108:111], 0
    v_mfma_f32_16x16x32_bf16 v[208:211], v[196:199], v[108:111], 0
    v_mfma_f32_16x16x32_bf16 v[156:159], v[152:155], v[104:107], v[156:159]
    v_mfma_f32_16x16x32_bf16 v[172:175], v[168:171], v[104:107], v[172:175]
    v_mfma_f32_16x16x32_bf16 v[188:191], v[184:187], v[104:107], v[188:191]
    v_mfma_f32_16x16x32_bf16 v[204:207], v[200:203], v[104:107], v[204:207]
    v_mfma_f32_16x16x32_bf16 v[160:163], v[152:155], v[112:115], v[160:163]
    v_mfma_f32_16x16x32_bf16 v[176:179], v[168:171], v[112:115], v[176:179]
    v_mfma_f32_16x16x32_bf16 v[192:195], v[184:187], v[112:115], v[192:195]
    v_mfma_f32_16x16x32_bf16 v[208:211], v[200:203], v[112:115], v[208:211]
    s_waitcnt lgkmcnt(2)
    v_mfma_f32_16x16x32_bf16 v[44:47], a[0:3], a[240:243], 0
    ds_read_b128 a[252:255], v2 offset:27648
    v_mfma_f32_16x16x32_bf16 v[48:51], a[48:51], a[240:243], 0
    v_cvt_pk_bf16_f32 v68, v20, v21
    v_cvt_pk_bf16_f32 v69, v22, v23
    v_mfma_f32_16x16x32_bf16 v[52:55], a[96:99], a[240:243], 0
    s_waitcnt lgkmcnt(2)
    ds_read_b128 a[240:243], v2 offset:28672
    v_cvt_pk_bf16_f32 v70, v24, v25
    v_mfma_f32_16x16x32_bf16 v[56:59], a[0:3], a[244:247], 0
    v_cvt_pk_bf16_f32 v71, v26, v27
    v_cvt_pk_bf16_f32 v72, v28, v29
    v_mfma_f32_16x16x32_bf16 v[60:63], a[48:51], a[244:247], 0
    ds_read_u16 v74, v5 offset:384
    v_cvt_pk_bf16_f32 v73, v30, v31
    v_mfma_f32_16x16x32_bf16 v[64:67], a[96:99], a[244:247], 0
    s_waitcnt lgkmcnt(3)
    ds_read_b128 a[244:247], v2 offset:29696
    v_cvt_pk_bf16_f32 v76, v32, v33
    v_mfma_f32_16x16x32_bf16 v[44:47], a[4:7], a[248:251], v[44:47]
    v_cvt_pk_bf16_f32 v77, v34, v35
    v_cvt_pk_bf16_f32 v78, v36, v37
    v_mfma_f32_16x16x32_bf16 v[48:51], a[52:55], a[248:251], v[48:51]
    ds_read_u16 v82, v5 offset:386
    v_cvt_pk_bf16_f32 v79, v38, v39
    v_mfma_f32_16x16x32_bf16 v[52:55], a[100:103], a[248:251], v[52:55]
    s_waitcnt lgkmcnt(4)
    ds_read_b128 a[248:251], v2 offset:30720
    v_cvt_pk_bf16_f32 v80, v40, v41
    v_mfma_f32_16x16x32_bf16 v[56:59], a[4:7], a[252:255], v[56:59]
    v_cvt_pk_bf16_f32 v81, v42, v43
    v_cvt_pk_bf16_f32 v117, v156, v160
    v_mfma_f32_16x16x32_bf16 v[60:63], a[52:55], a[252:255], v[60:63]
    v_cvt_pk_bf16_f32 v121, v157, v161
    v_cvt_pk_bf16_f32 v125, v158, v162
    v_mfma_f32_16x16x32_bf16 v[64:67], a[100:103], a[252:255], v[64:67]
    s_waitcnt lgkmcnt(4)
    ds_read_b128 a[252:255], v2 offset:31744
    v_cvt_pk_bf16_f32 v129, v159, v163
    v_mfma_f32_16x16x32_bf16 v[44:47], a[8:11], a[240:243], v[44:47]
    v_cvt_pk_bf16_f32 v133, v172, v176
    v_cvt_pk_bf16_f32 v137, v173, v177
    v_mfma_f32_16x16x32_bf16 v[48:51], a[56:59], a[240:243], v[48:51]
    v_cvt_pk_bf16_f32 v141, v174, v178
    v_cvt_pk_bf16_f32 v145, v175, v179
    v_mfma_f32_16x16x32_bf16 v[52:55], a[104:107], a[240:243], v[52:55]
    s_waitcnt lgkmcnt(3)
    ds_read_b128 a[240:243], v2 offset:32768
    v_cvt_pk_bf16_f32 v213, v188, v192
    v_mfma_f32_16x16x32_bf16 v[56:59], a[8:11], a[244:247], v[56:59]
    v_cvt_pk_bf16_f32 v217, v189, v193
    v_cvt_pk_bf16_f32 v221, v190, v194
    v_mfma_f32_16x16x32_bf16 v[60:63], a[56:59], a[244:247], v[60:63]
    v_cvt_pk_bf16_f32 v225, v191, v195
    v_cvt_pk_bf16_f32 v229, v204, v208
    v_mfma_f32_16x16x32_bf16 v[64:67], a[104:107], a[244:247], v[64:67]
    s_waitcnt lgkmcnt(2)
    ds_read_b128 a[244:247], v2 offset:33792
    v_mfma_f32_16x16x32_bf16 v[44:47], a[12:15], a[248:251], v[44:47]
    v_mfma_f32_16x16x32_bf16 v[48:51], a[60:63], a[248:251], v[48:51]
    v_mfma_f32_16x16x32_bf16 v[52:55], a[108:111], a[248:251], v[52:55]
    s_waitcnt lgkmcnt(2)
    ds_read_b128 a[248:251], v2 offset:34816
    v_mfma_f32_16x16x32_bf16 v[56:59], a[12:15], a[252:255], v[56:59]
    v_mfma_f32_16x16x32_bf16 v[60:63], a[60:63], a[252:255], v[60:63]
    v_mfma_f32_16x16x32_bf16 v[64:67], a[108:111], a[252:255], v[64:67]
    s_waitcnt lgkmcnt(2)
    ds_read_b128 a[252:255], v2 offset:35840
    v_mfma_f32_16x16x32_bf16 v[44:47], a[16:19], a[240:243], v[44:47]
    v_mfma_f32_16x16x32_bf16 v[48:51], a[64:67], a[240:243], v[48:51]
    v_mfma_f32_16x16x32_bf16 v[52:55], a[112:115], a[240:243], v[52:55]
    s_waitcnt lgkmcnt(2)
    ds_read_b128 a[240:243], v2 offset:36864
    v_mfma_f32_16x16x32_bf16 v[56:59], a[16:19], a[244:247], v[56:59]
    v_mfma_f32_16x16x32_bf16 v[60:63], a[64:67], a[244:247], v[60:63]
    v_mfma_f32_16x16x32_bf16 v[64:67], a[112:115], a[244:247], v[64:67]
    s_waitcnt lgkmcnt(2)
    ds_read_b128 a[244:247], v2 offset:37888
    v_mfma_f32_16x16x32_bf16 v[44:47], a[20:23], a[248:251], v[44:47]
    v_mfma_f32_16x16x32_bf16 v[48:51], a[68:71], a[248:251], v[48:51]
    v_mfma_f32_16x16x32_bf16 v[52:55], a[116:119], a[248:251], v[52:55]
    s_waitcnt lgkmcnt(2)
    ds_read_b128 a[248:251], v2 offset:38912
    v_mfma_f32_16x16x32_bf16 v[56:59], a[20:23], a[252:255], v[56:59]
    v_mfma_f32_16x16x32_bf16 v[60:63], a[68:71], a[252:255], v[60:63]
    v_mfma_f32_16x16x32_bf16 v[64:67], a[116:119], a[252:255], v[64:67]
    s_waitcnt lgkmcnt(2)
    ds_read_b128 a[252:255], v2 offset:39936
    v_mfma_f32_16x16x32_bf16 v[44:47], a[24:27], a[240:243], v[44:47]
    v_mfma_f32_16x16x32_bf16 v[48:51], a[72:75], a[240:243], v[48:51]
    v_mfma_f32_16x16x32_bf16 v[52:55], a[120:123], a[240:243], v[52:55]
    s_waitcnt lgkmcnt(2)
    ds_read_b128 a[240:243], v2 offset:40960
    v_mfma_f32_16x16x32_bf16 v[56:59], a[24:27], a[244:247], v[56:59]
    v_mfma_f32_16x16x32_bf16 v[60:63], a[72:75], a[244:247], v[60:63]
    v_mfma_f32_16x16x32_bf16 v[64:67], a[120:123], a[244:247], v[64:67]
    s_waitcnt lgkmcnt(2)
    ds_read_b128 a[244:247], v2 offset:41984
    v_mfma_f32_16x16x32_bf16 v[44:47], a[28:31], a[248:251], v[44:47]
    v_mfma_f32_16x16x32_bf16 v[48:51], a[76:79], a[248:251], v[48:51]
    v_mfma_f32_16x16x32_bf16 v[52:55], a[124:127], a[248:251], v[52:55]
    s_waitcnt lgkmcnt(2)
    ds_read_b128 a[248:251], v2 offset:43008
    v_mfma_f32_16x16x32_bf16 v[56:59], a[28:31], a[252:255], v[56:59]
    v_mfma_f32_16x16x32_bf16 v[60:63], a[76:79], a[252:255], v[60:63]
    v_mfma_f32_16x16x32_bf16 v[64:67], a[124:127], a[252:255], v[64:67]
    s_waitcnt lgkmcnt(2)
    ds_read_b128 a[252:255], v2 offset:44032
    v_mfma_f32_16x16x32_bf16 v[44:47], a[32:35], a[240:243], v[44:47]
    v_mfma_f32_16x16x32_bf16 v[48:51], a[80:83], a[240:243], v[48:51]
    v_mfma_f32_16x16x32_bf16 v[52:55], a[128:131], a[240:243], v[52:55]
    s_waitcnt lgkmcnt(2)
    ds_read_b128 a[240:243], v2 offset:45056
    v_mfma_f32_16x16x32_bf16 v[56:59], a[32:35], a[244:247], v[56:59]
    v_mfma_f32_16x16x32_bf16 v[60:63], a[80:83], a[244:247], v[60:63]
    v_mfma_f32_16x16x32_bf16 v[64:67], a[128:131], a[244:247], v[64:67]
    s_waitcnt lgkmcnt(2)
    ds_read_b128 a[244:247], v2 offset:46080
    v_mfma_f32_16x16x32_bf16 v[44:47], a[36:39], a[248:251], v[44:47]
    v_mfma_f32_16x16x32_bf16 v[48:51], a[84:87], a[248:251], v[48:51]
    v_mfma_f32_16x16x32_bf16 v[52:55], a[132:135], a[248:251], v[52:55]
    s_waitcnt lgkmcnt(2)
    ds_read_b128 a[248:251], v2 offset:47104
    v_mfma_f32_16x16x32_bf16 v[56:59], a[36:39], a[252:255], v[56:59]
    v_mfma_f32_16x16x32_bf16 v[60:63], a[84:87], a[252:255], v[60:63]
    v_mfma_f32_16x16x32_bf16 v[64:67], a[132:135], a[252:255], v[64:67]
    s_waitcnt lgkmcnt(2)
    ds_read_b128 a[252:255], v2 offset:48128
    v_mfma_f32_16x16x32_bf16 v[44:47], a[40:43], a[240:243], v[44:47]
    v_mfma_f32_16x16x32_bf16 v[48:51], a[88:91], a[240:243], v[48:51]
    v_mfma_f32_16x16x32_bf16 v[52:55], a[136:139], a[240:243], v[52:55]
    s_waitcnt lgkmcnt(2)
    v_mfma_f32_16x16x32_bf16 v[56:59], a[40:43], a[244:247], v[56:59]
    v_mfma_f32_16x16x32_bf16 v[60:63], a[88:91], a[244:247], v[60:63]
    v_mfma_f32_16x16x32_bf16 v[64:67], a[136:139], a[244:247], v[64:67]
    s_waitcnt lgkmcnt(1)
    v_mfma_f32_16x16x32_bf16 v[44:47], a[44:47], a[248:251], v[44:47]
    v_mfma_f32_16x16x32_bf16 v[48:51], a[92:95], a[248:251], v[48:51]
    v_mfma_f32_16x16x32_bf16 v[52:55], a[140:143], a[248:251], v[52:55]
    s_waitcnt vmcnt(10) lgkmcnt(0)
    s_barrier
    ds_read_b128 a[240:243], v1 offset:0
    v_mfma_f32_16x16x32_bf16 v[56:59], a[44:47], a[252:255], v[56:59]
    ds_read_b128 a[244:247], v1 offset:1024
    v_mfma_f32_16x16x32_bf16 v[60:63], a[92:95], a[252:255], v[60:63]
    s_add_u32 s45, s29, 540672
    s_add_u32 m0, s29, 49152
    ds_read_b128 a[248:251], v1 offset:2048
    v_mfma_f32_16x16x32_bf16 v[64:67], a[140:143], a[252:255], v[64:67]
    buffer_load_dwordx4 v1, s[20:23], s45 offen offset:0 sc1 lds
    v_mfma_f32_16x16x32_bf16 v[156:159], v[148:151], v[68:71], 0
    v_mfma_f32_16x16x32_bf16 v[172:175], v[164:167], v[68:71], 0
    v_mfma_f32_16x16x32_bf16 v[188:191], v[180:183], v[68:71], 0
    v_mfma_f32_16x16x32_bf16 v[204:207], v[196:199], v[68:71], 0
    buffer_load_dwordx4 v1, s[20:23], s45 offen offset:1024 sc1 lds
    v_mfma_f32_16x16x32_bf16 v[160:163], v[148:151], v[76:79], 0
    v_mfma_f32_16x16x32_bf16 v[176:179], v[164:167], v[76:79], 0
    v_mfma_f32_16x16x32_bf16 v[192:195], v[180:183], v[76:79], 0
    v_mfma_f32_16x16x32_bf16 v[208:211], v[196:199], v[76:79], 0
    buffer_load_dwordx4 v1, s[20:23], s45 offen offset:2048 sc1 lds
    v_mfma_f32_16x16x32_bf16 v[156:159], v[152:155], v[72:75], v[156:159]
    v_mfma_f32_16x16x32_bf16 v[172:175], v[168:171], v[72:75], v[172:175]
    v_mfma_f32_16x16x32_bf16 v[188:191], v[184:187], v[72:75], v[188:191]
    v_mfma_f32_16x16x32_bf16 v[204:207], v[200:203], v[72:75], v[204:207]
    buffer_load_dwordx4 v1, s[20:23], s45 offen offset:3072 sc1 lds
    s_add_u32 s45, s29, 544768
    v_mfma_f32_16x16x32_bf16 v[160:163], v[152:155], v[80:83], v[160:163]
    s_add_u32 m0, s29, 53248
    v_mfma_f32_16x16x32_bf16 v[176:179], v[168:171], v[80:83], v[176:179]
    v_mfma_f32_16x16x32_bf16 v[192:195], v[184:187], v[80:83], v[192:195]
    v_mfma_f32_16x16x32_bf16 v[208:211], v[200:203], v[80:83], v[208:211]
    s_waitcnt lgkmcnt(2)
    buffer_load_dwordx4 v1, s[20:23], s45 offen offset:0 sc1 lds
    v_mfma_f32_16x16x32_bf16 v[20:23], a[0:3], a[240:243], 0
    ds_read_b128 a[252:255], v1 offset:3072
    v_mfma_f32_16x16x32_bf16 v[24:27], a[48:51], a[240:243], 0
    v_cvt_pk_bf16_f32 v84, v44, v45
    v_cvt_pk_bf16_f32 v85, v46, v47
    v_mfma_f32_16x16x32_bf16 v[28:31], a[96:99], a[240:243], 0
    s_waitcnt lgkmcnt(2)
    ds_read_b128 a[240:243], v1 offset:4096
    v_cvt_pk_bf16_f32 v86, v48, v49
    v_mfma_f32_16x16x32_bf16 v[32:35], a[0:3], a[244:247], 0
    buffer_load_dwordx4 v1, s[20:23], s45 offen offset:1024 sc1 lds
    s_add_u32 s45, s29, 565248
    v_mfma_f32_16x16x32_bf16 v[36:39], a[48:51], a[244:247], 0
    s_add_u32 m0, s29, 73728
    ds_read_u16 v90, v5 offset:448
    v_cvt_pk_bf16_f32 v87, v50, v51
    v_mfma_f32_16x16x32_bf16 v[40:43], a[96:99], a[244:247], 0
    s_waitcnt lgkmcnt(3)
    ds_read_b128 a[244:247], v1 offset:5120
    v_cvt_pk_bf16_f32 v88, v52, v53
    v_mfma_f32_16x16x32_bf16 v[20:23], a[4:7], a[248:251], v[20:23]
    v_cvt_pk_bf16_f32 v89, v54, v55
    v_cvt_pk_bf16_f32 v92, v56, v57
    v_mfma_f32_16x16x32_bf16 v[24:27], a[52:55], a[248:251], v[24:27]
    ds_read_u16 v98, v5 offset:450
    v_cvt_pk_bf16_f32 v93, v58, v59
    v_mfma_f32_16x16x32_bf16 v[28:31], a[100:103], a[248:251], v[28:31]
    s_waitcnt lgkmcnt(4)
    ds_read_b128 a[248:251], v1 offset:6144
    v_cvt_pk_bf16_f32 v94, v60, v61
    v_mfma_f32_16x16x32_bf16 v[32:35], a[4:7], a[252:255], v[32:35]
    v_cvt_pk_bf16_f32 v95, v62, v63
    v_cvt_pk_bf16_f32 v96, v64, v65
    v_mfma_f32_16x16x32_bf16 v[36:39], a[52:55], a[252:255], v[36:39]
    v_cvt_pk_bf16_f32 v97, v66, v67
    v_cvt_pk_bf16_f32 v118, v156, v160
    v_mfma_f32_16x16x32_bf16 v[40:43], a[100:103], a[252:255], v[40:43]
    s_waitcnt lgkmcnt(4)
    ds_read_b128 a[252:255], v1 offset:7168
    v_cvt_pk_bf16_f32 v122, v157, v161
    v_mfma_f32_16x16x32_bf16 v[20:23], a[8:11], a[240:243], v[20:23]
    buffer_load_dwordx4 v1, s[20:23], s45 offen offset:0 sc1 lds
    v_mfma_f32_16x16x32_bf16 v[24:27], a[56:59], a[240:243], v[24:27]
    v_cvt_pk_bf16_f32 v126, v158, v162
    v_cvt_pk_bf16_f32 v130, v159, v163
    v_mfma_f32_16x16x32_bf16 v[28:31], a[104:107], a[240:243], v[28:31]
    s_waitcnt lgkmcnt(3)
    ds_read_b128 a[240:243], v1 offset:8192
    v_cvt_pk_bf16_f32 v134, v172, v176
    v_mfma_f32_16x16x32_bf16 v[32:35], a[8:11], a[244:247], v[32:35]
    v_cvt_pk_bf16_f32 v138, v173, v177
    v_cvt_pk_bf16_f32 v142, v174, v178
    v_mfma_f32_16x16x32_bf16 v[36:39], a[56:59], a[244:247], v[36:39]
    buffer_load_dwordx4 v1, s[20:23], s45 offen offset:1024 sc1 lds
    v_mfma_f32_16x16x32_bf16 v[40:43], a[104:107], a[244:247], v[40:43]
    s_waitcnt lgkmcnt(2)
    ds_read_b128 a[244:247], v1 offset:9216
    v_cvt_pk_bf16_f32 v146, v175, v179
    v_mfma_f32_16x16x32_bf16 v[20:23], a[12:15], a[248:251], v[20:23]
    v_cvt_pk_bf16_f32 v214, v188, v192
    v_cvt_pk_bf16_f32 v218, v189, v193
    v_mfma_f32_16x16x32_bf16 v[24:27], a[60:63], a[248:251], v[24:27]
    v_cvt_pk_bf16_f32 v222, v190, v194
    v_cvt_pk_bf16_f32 v226, v191, v195
    v_mfma_f32_16x16x32_bf16 v[28:31], a[108:111], a[248:251], v[28:31]
    s_waitcnt lgkmcnt(2)
    ds_read_b128 a[248:251], v1 offset:10240
    v_cvt_pk_bf16_f32 v230, v204, v208
    v_mfma_f32_16x16x32_bf16 v[32:35], a[12:15], a[252:255], v[32:35]
    buffer_load_dwordx4 v1, s[20:23], s45 offen offset:2048 sc1 lds
    v_mfma_f32_16x16x32_bf16 v[36:39], a[60:63], a[252:255], v[36:39]
    v_mfma_f32_16x16x32_bf16 v[40:43], a[108:111], a[252:255], v[40:43]
    s_waitcnt lgkmcnt(2)
    ds_read_b128 a[252:255], v1 offset:11264
    v_mfma_f32_16x16x32_bf16 v[20:23], a[16:19], a[240:243], v[20:23]
    v_mfma_f32_16x16x32_bf16 v[24:27], a[64:67], a[240:243], v[24:27]
    buffer_load_dwordx4 v1, s[20:23], s45 offen offset:3072 sc1 lds
    s_add_u32 s45, s29, 569344
    v_mfma_f32_16x16x32_bf16 v[28:31], a[112:115], a[240:243], v[28:31]
    s_waitcnt lgkmcnt(2)
    s_add_u32 m0, s29, 77824
    ds_read_b128 a[240:243], v1 offset:12288
    v_mfma_f32_16x16x32_bf16 v[32:35], a[16:19], a[244:247], v[32:35]
    v_mfma_f32_16x16x32_bf16 v[36:39], a[64:67], a[244:247], v[36:39]
    v_mfma_f32_16x16x32_bf16 v[40:43], a[112:115], a[244:247], v[40:43]
    s_waitcnt lgkmcnt(2)
    ds_read_b128 a[244:247], v1 offset:13312
    v_mfma_f32_16x16x32_bf16 v[20:23], a[20:23], a[248:251], v[20:23]
    buffer_load_dwordx4 v1, s[20:23], s45 offen offset:0 sc1 lds
    v_mfma_f32_16x16x32_bf16 v[24:27], a[68:71], a[248:251], v[24:27]
    v_mfma_f32_16x16x32_bf16 v[28:31], a[116:119], a[248:251], v[28:31]
    s_waitcnt lgkmcnt(2)
    ds_read_b128 a[248:251], v1 offset:14336
    v_mfma_f32_16x16x32_bf16 v[32:35], a[20:23], a[252:255], v[32:35]
    v_mfma_f32_16x16x32_bf16 v[36:39], a[68:71], a[252:255], v[36:39]
    buffer_load_dwordx4 v1, s[20:23], s45 offen offset:1024 sc1 lds
    v_mfma_f32_16x16x32_bf16 v[40:43], a[116:119], a[252:255], v[40:43]
    s_waitcnt lgkmcnt(2)
    ds_read_b128 a[252:255], v1 offset:15360
    v_mfma_f32_16x16x32_bf16 v[20:23], a[24:27], a[240:243], v[20:23]
    v_mfma_f32_16x16x32_bf16 v[24:27], a[72:75], a[240:243], v[24:27]
    v_mfma_f32_16x16x32_bf16 v[28:31], a[120:123], a[240:243], v[28:31]
    s_waitcnt lgkmcnt(2)
    ds_read_b128 a[240:243], v1 offset:16384
    v_mfma_f32_16x16x32_bf16 v[32:35], a[24:27], a[244:247], v[32:35]
    v_mfma_f32_16x16x32_bf16 v[36:39], a[72:75], a[244:247], v[36:39]
    v_mfma_f32_16x16x32_bf16 v[40:43], a[120:123], a[244:247], v[40:43]
    s_waitcnt lgkmcnt(2)
    ds_read_b128 a[244:247], v1 offset:17408
    v_mfma_f32_16x16x32_bf16 v[20:23], a[28:31], a[248:251], v[20:23]
    v_mfma_f32_16x16x32_bf16 v[24:27], a[76:79], a[248:251], v[24:27]
    v_mfma_f32_16x16x32_bf16 v[28:31], a[124:127], a[248:251], v[28:31]
    s_waitcnt lgkmcnt(2)
    ds_read_b128 a[248:251], v1 offset:18432
    v_mfma_f32_16x16x32_bf16 v[32:35], a[28:31], a[252:255], v[32:35]
    v_mfma_f32_16x16x32_bf16 v[36:39], a[76:79], a[252:255], v[36:39]
    v_mfma_f32_16x16x32_bf16 v[40:43], a[124:127], a[252:255], v[40:43]
    s_waitcnt lgkmcnt(2)
    ds_read_b128 a[252:255], v1 offset:19456
    v_mfma_f32_16x16x32_bf16 v[20:23], a[32:35], a[240:243], v[20:23]
    v_mfma_f32_16x16x32_bf16 v[24:27], a[80:83], a[240:243], v[24:27]
    v_mfma_f32_16x16x32_bf16 v[28:31], a[128:131], a[240:243], v[28:31]
    s_waitcnt lgkmcnt(2)
    ds_read_b128 a[240:243], v1 offset:20480
    v_mfma_f32_16x16x32_bf16 v[32:35], a[32:35], a[244:247], v[32:35]
    v_mfma_f32_16x16x32_bf16 v[36:39], a[80:83], a[244:247], v[36:39]
    v_mfma_f32_16x16x32_bf16 v[40:43], a[128:131], a[244:247], v[40:43]
    s_waitcnt lgkmcnt(2)
    ds_read_b128 a[244:247], v1 offset:21504
    v_mfma_f32_16x16x32_bf16 v[20:23], a[36:39], a[248:251], v[20:23]
    v_mfma_f32_16x16x32_bf16 v[24:27], a[84:87], a[248:251], v[24:27]
    v_mfma_f32_16x16x32_bf16 v[28:31], a[132:135], a[248:251], v[28:31]
    s_waitcnt lgkmcnt(2)
    ds_read_b128 a[248:251], v1 offset:22528
    v_mfma_f32_16x16x32_bf16 v[32:35], a[36:39], a[252:255], v[32:35]
    v_mfma_f32_16x16x32_bf16 v[36:39], a[84:87], a[252:255], v[36:39]
    v_mfma_f32_16x16x32_bf16 v[40:43], a[132:135], a[252:255], v[40:43]
    s_waitcnt lgkmcnt(2)
    ds_read_b128 a[252:255], v1 offset:23552
    v_mfma_f32_16x16x32_bf16 v[20:23], a[40:43], a[240:243], v[20:23]
    v_mfma_f32_16x16x32_bf16 v[24:27], a[88:91], a[240:243], v[24:27]
    v_mfma_f32_16x16x32_bf16 v[28:31], a[136:139], a[240:243], v[28:31]
    s_waitcnt lgkmcnt(2)
    ds_read_b128 a[240:243], v1 offset:24576
    v_mfma_f32_16x16x32_bf16 v[32:35], a[40:43], a[244:247], v[32:35]
    v_mfma_f32_16x16x32_bf16 v[36:39], a[88:91], a[244:247], v[36:39]
    v_mfma_f32_16x16x32_bf16 v[40:43], a[136:139], a[244:247], v[40:43]
    s_waitcnt lgkmcnt(2)
    ds_read_b128 a[244:247], v1 offset:25600
    v_mfma_f32_16x16x32_bf16 v[20:23], a[44:47], a[248:251], v[20:23]
    v_mfma_f32_16x16x32_bf16 v[24:27], a[92:95], a[248:251], v[24:27]
    v_mfma_f32_16x16x32_bf16 v[28:31], a[140:143], a[248:251], v[28:31]
    s_waitcnt lgkmcnt(2)
    ds_read_b128 a[248:251], v1 offset:26624
    v_mfma_f32_16x16x32_bf16 v[32:35], a[44:47], a[252:255], v[32:35]
    v_mfma_f32_16x16x32_bf16 v[36:39], a[92:95], a[252:255], v[36:39]
    v_mfma_f32_16x16x32_bf16 v[40:43], a[140:143], a[252:255], v[40:43]
    v_mfma_f32_16x16x32_bf16 v[156:159], v[148:151], v[84:87], 0
    v_mfma_f32_16x16x32_bf16 v[172:175], v[164:167], v[84:87], 0
    v_mfma_f32_16x16x32_bf16 v[188:191], v[180:183], v[84:87], 0
    v_mfma_f32_16x16x32_bf16 v[204:207], v[196:199], v[84:87], 0
    v_mfma_f32_16x16x32_bf16 v[160:163], v[148:151], v[92:95], 0
    v_mfma_f32_16x16x32_bf16 v[176:179], v[164:167], v[92:95], 0
    v_mfma_f32_16x16x32_bf16 v[192:195], v[180:183], v[92:95], 0
    v_mfma_f32_16x16x32_bf16 v[208:211], v[196:199], v[92:95], 0
    v_mfma_f32_16x16x32_bf16 v[156:159], v[152:155], v[88:91], v[156:159]
    v_mfma_f32_16x16x32_bf16 v[172:175], v[168:171], v[88:91], v[172:175]
    v_mfma_f32_16x16x32_bf16 v[188:191], v[184:187], v[88:91], v[188:191]
    v_mfma_f32_16x16x32_bf16 v[204:207], v[200:203], v[88:91], v[204:207]
    v_mfma_f32_16x16x32_bf16 v[160:163], v[152:155], v[96:99], v[160:163]
    v_mfma_f32_16x16x32_bf16 v[176:179], v[168:171], v[96:99], v[176:179]
    v_mfma_f32_16x16x32_bf16 v[192:195], v[184:187], v[96:99], v[192:195]
    v_mfma_f32_16x16x32_bf16 v[208:211], v[200:203], v[96:99], v[208:211]
    s_waitcnt lgkmcnt(2)
    v_mfma_f32_16x16x32_bf16 v[44:47], a[0:3], a[240:243], 0
    ds_read_b128 a[252:255], v1 offset:27648
    v_mfma_f32_16x16x32_bf16 v[48:51], a[48:51], a[240:243], 0
    v_cvt_pk_bf16_f32 v100, v20, v21
    v_cvt_pk_bf16_f32 v101, v22, v23
    v_mfma_f32_16x16x32_bf16 v[52:55], a[96:99], a[240:243], 0
    s_waitcnt lgkmcnt(2)
    ds_read_b128 a[240:243], v1 offset:28672
    v_cvt_pk_bf16_f32 v102, v24, v25
    v_mfma_f32_16x16x32_bf16 v[56:59], a[0:3], a[244:247], 0
    v_cvt_pk_bf16_f32 v103, v26, v27
    v_cvt_pk_bf16_f32 v104, v28, v29
    v_mfma_f32_16x16x32_bf16 v[60:63], a[48:51], a[244:247], 0
    s_waitcnt vmcnt(21)
    ds_read_u16 v106, v5 offset:512
    v_cvt_pk_bf16_f32 v105, v30, v31
    v_mfma_f32_16x16x32_bf16 v[64:67], a[96:99], a[244:247], 0
    s_waitcnt lgkmcnt(3)
    ds_read_b128 a[244:247], v1 offset:29696
    v_cvt_pk_bf16_f32 v108, v32, v33
    v_mfma_f32_16x16x32_bf16 v[44:47], a[4:7], a[248:251], v[44:47]
    v_cvt_pk_bf16_f32 v109, v34, v35
    v_cvt_pk_bf16_f32 v110, v36, v37
    v_mfma_f32_16x16x32_bf16 v[48:51], a[52:55], a[248:251], v[48:51]
    ds_read_u16 v114, v5 offset:514
    v_cvt_pk_bf16_f32 v111, v38, v39
    v_mfma_f32_16x16x32_bf16 v[52:55], a[100:103], a[248:251], v[52:55]
    s_waitcnt lgkmcnt(4)
    ds_read_b128 a[248:251], v1 offset:30720
    v_cvt_pk_bf16_f32 v112, v40, v41
    v_mfma_f32_16x16x32_bf16 v[56:59], a[4:7], a[252:255], v[56:59]
    v_cvt_pk_bf16_f32 v113, v42, v43
    v_cvt_pk_bf16_f32 v119, v156, v160
    v_mfma_f32_16x16x32_bf16 v[60:63], a[52:55], a[252:255], v[60:63]
    v_cvt_pk_bf16_f32 v123, v157, v161
    v_cvt_pk_bf16_f32 v127, v158, v162
    v_mfma_f32_16x16x32_bf16 v[64:67], a[100:103], a[252:255], v[64:67]
    s_waitcnt lgkmcnt(4)
    ds_read_b128 a[252:255], v1 offset:31744
    v_cvt_pk_bf16_f32 v131, v159, v163
    v_mfma_f32_16x16x32_bf16 v[44:47], a[8:11], a[240:243], v[44:47]
    v_cvt_pk_bf16_f32 v135, v172, v176
    v_cvt_pk_bf16_f32 v139, v173, v177
    v_mfma_f32_16x16x32_bf16 v[48:51], a[56:59], a[240:243], v[48:51]
    v_cvt_pk_bf16_f32 v143, v174, v178
    v_cvt_pk_bf16_f32 v147, v175, v179
    v_mfma_f32_16x16x32_bf16 v[52:55], a[104:107], a[240:243], v[52:55]
    s_waitcnt lgkmcnt(3)
    ds_read_b128 a[240:243], v1 offset:32768
    v_cvt_pk_bf16_f32 v215, v188, v192
    v_mfma_f32_16x16x32_bf16 v[56:59], a[8:11], a[244:247], v[56:59]
    v_cvt_pk_bf16_f32 v219, v189, v193
    v_cvt_pk_bf16_f32 v223, v190, v194
    v_mfma_f32_16x16x32_bf16 v[60:63], a[56:59], a[244:247], v[60:63]
    v_cvt_pk_bf16_f32 v227, v191, v195
    v_cvt_pk_bf16_f32 v231, v204, v208
    v_mfma_f32_16x16x32_bf16 v[64:67], a[104:107], a[244:247], v[64:67]
    s_waitcnt lgkmcnt(2)
    ds_read_b128 a[244:247], v1 offset:33792
    v_mfma_f32_16x16x32_bf16 v[44:47], a[12:15], a[248:251], v[44:47]
    buffer_store_dwordx4 v[116:119], v7, s[24:27], s34 offen offset:256 nt
    v_mfma_f32_16x16x32_bf16 v[48:51], a[60:63], a[248:251], v[48:51]
    v_mfma_f32_16x16x32_bf16 v[52:55], a[108:111], a[248:251], v[52:55]
    s_waitcnt lgkmcnt(2)
    ds_read_b128 a[248:251], v1 offset:34816
    v_mfma_f32_16x16x32_bf16 v[56:59], a[12:15], a[252:255], v[56:59]
    v_mfma_f32_16x16x32_bf16 v[60:63], a[60:63], a[252:255], v[60:63]
    buffer_store_dwordx4 v[120:123], v8, s[24:27], s34 offen offset:256 nt
    v_mfma_f32_16x16x32_bf16 v[64:67], a[108:111], a[252:255], v[64:67]
    s_waitcnt lgkmcnt(2)
    ds_read_b128 a[252:255], v1 offset:35840
    v_mfma_f32_16x16x32_bf16 v[44:47], a[16:19], a[240:243], v[44:47]
    v_mfma_f32_16x16x32_bf16 v[48:51], a[64:67], a[240:243], v[48:51]
    v_mfma_f32_16x16x32_bf16 v[52:55], a[112:115], a[240:243], v[52:55]
    s_waitcnt lgkmcnt(2)
    ds_read_b128 a[240:243], v1 offset:36864
    v_mfma_f32_16x16x32_bf16 v[56:59], a[16:19], a[244:247], v[56:59]
    buffer_store_dwordx4 v[124:127], v9, s[24:27], s34 offen offset:256 nt
    v_mfma_f32_16x16x32_bf16 v[60:63], a[64:67], a[244:247], v[60:63]
    v_mfma_f32_16x16x32_bf16 v[64:67], a[112:115], a[244:247], v[64:67]
    s_waitcnt lgkmcnt(2)
    ds_read_b128 a[244:247], v1 offset:37888
    v_mfma_f32_16x16x32_bf16 v[44:47], a[20:23], a[248:251], v[44:47]
    v_mfma_f32_16x16x32_bf16 v[48:51], a[68:71], a[248:251], v[48:51]
    buffer_store_dwordx4 v[128:131], v10, s[24:27], s34 offen offset:256 nt
    v_mfma_f32_16x16x32_bf16 v[52:55], a[116:119], a[248:251], v[52:55]
    s_waitcnt lgkmcnt(2)
    ds_read_b128 a[248:251], v1 offset:38912
    v_mfma_f32_16x16x32_bf16 v[56:59], a[20:23], a[252:255], v[56:59]
    v_mfma_f32_16x16x32_bf16 v[60:63], a[68:71], a[252:255], v[60:63]
    v_mfma_f32_16x16x32_bf16 v[64:67], a[116:119], a[252:255], v[64:67]
    s_waitcnt lgkmcnt(2)
    ds_read_b128 a[252:255], v1 offset:39936
    v_mfma_f32_16x16x32_bf16 v[44:47], a[24:27], a[240:243], v[44:47]
    buffer_store_dwordx4 v[132:135], v11, s[24:27], s34 offen offset:256 nt
    v_mfma_f32_16x16x32_bf16 v[48:51], a[72:75], a[240:243], v[48:51]
    v_mfma_f32_16x16x32_bf16 v[52:55], a[120:123], a[240:243], v[52:55]
    s_waitcnt lgkmcnt(2)
    ds_read_b128 a[240:243], v1 offset:40960
    v_mfma_f32_16x16x32_bf16 v[56:59], a[24:27], a[244:247], v[56:59]
    v_mfma_f32_16x16x32_bf16 v[60:63], a[72:75], a[244:247], v[60:63]
    buffer_store_dwordx4 v[136:139], v12, s[24:27], s34 offen offset:256 nt
    v_mfma_f32_16x16x32_bf16 v[64:67], a[120:123], a[244:247], v[64:67]
    s_waitcnt lgkmcnt(2)
    ds_read_b128 a[244:247], v1 offset:41984
    v_mfma_f32_16x16x32_bf16 v[44:47], a[28:31], a[248:251], v[44:47]
    v_mfma_f32_16x16x32_bf16 v[48:51], a[76:79], a[248:251], v[48:51]
    v_mfma_f32_16x16x32_bf16 v[52:55], a[124:127], a[248:251], v[52:55]
    s_waitcnt lgkmcnt(2)
    ds_read_b128 a[248:251], v1 offset:43008
    v_mfma_f32_16x16x32_bf16 v[56:59], a[28:31], a[252:255], v[56:59]
    buffer_store_dwordx4 v[140:143], v13, s[24:27], s34 offen offset:256 nt
    v_mfma_f32_16x16x32_bf16 v[60:63], a[76:79], a[252:255], v[60:63]
    v_mfma_f32_16x16x32_bf16 v[64:67], a[124:127], a[252:255], v[64:67]
    s_waitcnt lgkmcnt(2)
    ds_read_b128 a[252:255], v1 offset:44032
    v_mfma_f32_16x16x32_bf16 v[44:47], a[32:35], a[240:243], v[44:47]
    v_mfma_f32_16x16x32_bf16 v[48:51], a[80:83], a[240:243], v[48:51]
    buffer_store_dwordx4 v[144:147], v14, s[24:27], s34 offen offset:256 nt
    v_mfma_f32_16x16x32_bf16 v[52:55], a[128:131], a[240:243], v[52:55]
    s_waitcnt lgkmcnt(2)
    ds_read_b128 a[240:243], v1 offset:45056
    v_mfma_f32_16x16x32_bf16 v[56:59], a[32:35], a[244:247], v[56:59]
    v_mfma_f32_16x16x32_bf16 v[60:63], a[80:83], a[244:247], v[60:63]
    v_mfma_f32_16x16x32_bf16 v[64:67], a[128:131], a[244:247], v[64:67]
    s_waitcnt lgkmcnt(2)
    ds_read_b128 a[244:247], v1 offset:46080
    v_mfma_f32_16x16x32_bf16 v[44:47], a[36:39], a[248:251], v[44:47]
    buffer_store_dwordx4 v[212:215], v15, s[24:27], s34 offen offset:256 nt
    v_mfma_f32_16x16x32_bf16 v[48:51], a[84:87], a[248:251], v[48:51]
    v_mfma_f32_16x16x32_bf16 v[52:55], a[132:135], a[248:251], v[52:55]
    s_waitcnt lgkmcnt(2)
    ds_read_b128 a[248:251], v1 offset:47104
    v_mfma_f32_16x16x32_bf16 v[56:59], a[36:39], a[252:255], v[56:59]
    v_mfma_f32_16x16x32_bf16 v[60:63], a[84:87], a[252:255], v[60:63]
    buffer_store_dwordx4 v[216:219], v16, s[24:27], s34 offen offset:256 nt
    v_mfma_f32_16x16x32_bf16 v[64:67], a[132:135], a[252:255], v[64:67]
    s_waitcnt lgkmcnt(2)
    ds_read_b128 a[252:255], v1 offset:48128
    v_mfma_f32_16x16x32_bf16 v[44:47], a[40:43], a[240:243], v[44:47]
    v_mfma_f32_16x16x32_bf16 v[48:51], a[88:91], a[240:243], v[48:51]
    v_mfma_f32_16x16x32_bf16 v[52:55], a[136:139], a[240:243], v[52:55]
    s_waitcnt lgkmcnt(2)
    buffer_store_dwordx4 v[220:223], v17, s[24:27], s34 offen offset:256 nt
    v_mfma_f32_16x16x32_bf16 v[56:59], a[40:43], a[244:247], v[56:59]
    v_mfma_f32_16x16x32_bf16 v[60:63], a[88:91], a[244:247], v[60:63]
    v_mfma_f32_16x16x32_bf16 v[64:67], a[136:139], a[244:247], v[64:67]
    s_waitcnt lgkmcnt(1)
    v_mfma_f32_16x16x32_bf16 v[44:47], a[44:47], a[248:251], v[44:47]
    buffer_store_dwordx4 v[224:227], v18, s[24:27], s34 offen offset:256 nt
    v_mfma_f32_16x16x32_bf16 v[48:51], a[92:95], a[248:251], v[48:51]
    v_mfma_f32_16x16x32_bf16 v[52:55], a[140:143], a[248:251], v[52:55]
    s_waitcnt vmcnt(12) lgkmcnt(0)
    s_barrier
    ds_read_b128 a[240:243], v2 offset:0
    v_mfma_f32_16x16x32_bf16 v[56:59], a[44:47], a[252:255], v[56:59]
    ds_read_b128 a[244:247], v2 offset:1024
    v_mfma_f32_16x16x32_bf16 v[60:63], a[92:95], a[252:255], v[60:63]
    s_add_u32 s45, s29, 0
    s_add_u32 m0, s29, 0
    ds_read_b128 a[248:251], v2 offset:2048
    v_mfma_f32_16x16x32_bf16 v[64:67], a[140:143], a[252:255], v[64:67]
    buffer_load_dwordx4 v1, s[20:23], s45 offen offset:0 sc1 lds
    v_mfma_f32_16x16x32_bf16 v[156:159], v[148:151], v[100:103], 0
    v_mfma_f32_16x16x32_bf16 v[172:175], v[164:167], v[100:103], 0
    v_mfma_f32_16x16x32_bf16 v[188:191], v[180:183], v[100:103], 0
    v_mfma_f32_16x16x32_bf16 v[204:207], v[196:199], v[100:103], 0
    buffer_load_dwordx4 v1, s[20:23], s45 offen offset:1024 sc1 lds
    v_mfma_f32_16x16x32_bf16 v[160:163], v[148:151], v[108:111], 0
    v_mfma_f32_16x16x32_bf16 v[176:179], v[164:167], v[108:111], 0
    v_mfma_f32_16x16x32_bf16 v[192:195], v[180:183], v[108:111], 0
    v_mfma_f32_16x16x32_bf16 v[208:211], v[196:199], v[108:111], 0
    buffer_load_dwordx4 v1, s[20:23], s45 offen offset:2048 sc1 lds
    v_mfma_f32_16x16x32_bf16 v[156:159], v[152:155], v[104:107], v[156:159]
    v_mfma_f32_16x16x32_bf16 v[172:175], v[168:171], v[104:107], v[172:175]
    v_mfma_f32_16x16x32_bf16 v[188:191], v[184:187], v[104:107], v[188:191]
    v_mfma_f32_16x16x32_bf16 v[204:207], v[200:203], v[104:107], v[204:207]
    buffer_load_dwordx4 v1, s[20:23], s45 offen offset:3072 sc1 lds
    s_add_u32 s45, s29, 4096
    v_mfma_f32_16x16x32_bf16 v[160:163], v[152:155], v[112:115], v[160:163]
    s_add_u32 m0, s29, 4096
    v_mfma_f32_16x16x32_bf16 v[176:179], v[168:171], v[112:115], v[176:179]
    v_mfma_f32_16x16x32_bf16 v[192:195], v[184:187], v[112:115], v[192:195]
    v_mfma_f32_16x16x32_bf16 v[208:211], v[200:203], v[112:115], v[208:211]
    s_waitcnt lgkmcnt(2)
    buffer_load_dwordx4 v1, s[20:23], s45 offen offset:0 sc1 lds
    v_mfma_f32_16x16x32_bf16 v[20:23], a[0:3], a[240:243], 0
    ds_read_b128 a[252:255], v2 offset:3072
    v_mfma_f32_16x16x32_bf16 v[24:27], a[48:51], a[240:243], 0
    v_cvt_pk_bf16_f32 v68, v44, v45
    v_cvt_pk_bf16_f32 v69, v46, v47
    v_mfma_f32_16x16x32_bf16 v[28:31], a[96:99], a[240:243], 0
    s_waitcnt lgkmcnt(2)
    ds_read_b128 a[240:243], v2 offset:4096
    v_cvt_pk_bf16_f32 v70, v48, v49
    v_mfma_f32_16x16x32_bf16 v[32:35], a[0:3], a[244:247], 0
    buffer_load_dwordx4 v1, s[20:23], s45 offen offset:1024 sc1 lds
    s_add_u32 s45, s29, 24576
    v_mfma_f32_16x16x32_bf16 v[36:39], a[48:51], a[244:247], 0
    s_add_u32 m0, s29, 24576
    ds_read_u16 v74, v5 offset:576
    v_cvt_pk_bf16_f32 v71, v50, v51
    v_mfma_f32_16x16x32_bf16 v[40:43], a[96:99], a[244:247], 0
    s_waitcnt lgkmcnt(3)
    ds_read_b128 a[244:247], v2 offset:5120
    v_cvt_pk_bf16_f32 v72, v52, v53
    v_mfma_f32_16x16x32_bf16 v[20:23], a[4:7], a[248:251], v[20:23]
    v_cvt_pk_bf16_f32 v73, v54, v55
    v_cvt_pk_bf16_f32 v76, v56, v57
    v_mfma_f32_16x16x32_bf16 v[24:27], a[52:55], a[248:251], v[24:27]
    ds_read_u16 v82, v5 offset:578
    v_cvt_pk_bf16_f32 v77, v58, v59
    v_mfma_f32_16x16x32_bf16 v[28:31], a[100:103], a[248:251], v[28:31]
    s_waitcnt lgkmcnt(4)
    ds_read_b128 a[248:251], v2 offset:6144
    v_cvt_pk_bf16_f32 v78, v60, v61
    v_mfma_f32_16x16x32_bf16 v[32:35], a[4:7], a[252:255], v[32:35]
    v_cvt_pk_bf16_f32 v79, v62, v63
    v_cvt_pk_bf16_f32 v80, v64, v65
    v_mfma_f32_16x16x32_bf16 v[36:39], a[52:55], a[252:255], v[36:39]
    v_cvt_pk_bf16_f32 v81, v66, v67
    v_cvt_pk_bf16_f32 v116, v156, v160
    v_mfma_f32_16x16x32_bf16 v[40:43], a[100:103], a[252:255], v[40:43]
    s_waitcnt lgkmcnt(4)
    ds_read_b128 a[252:255], v2 offset:7168
    v_cvt_pk_bf16_f32 v120, v157, v161
    v_mfma_f32_16x16x32_bf16 v[20:23], a[8:11], a[240:243], v[20:23]
    buffer_load_dwordx4 v1, s[20:23], s45 offen offset:0 sc1 lds
    v_mfma_f32_16x16x32_bf16 v[24:27], a[56:59], a[240:243], v[24:27]
    v_cvt_pk_bf16_f32 v124, v158, v162
    v_cvt_pk_bf16_f32 v128, v159, v163
    v_mfma_f32_16x16x32_bf16 v[28:31], a[104:107], a[240:243], v[28:31]
    s_waitcnt lgkmcnt(3)
    ds_read_b128 a[240:243], v2 offset:8192
    v_cvt_pk_bf16_f32 v132, v172, v176
    v_mfma_f32_16x16x32_bf16 v[32:35], a[8:11], a[244:247], v[32:35]
    v_cvt_pk_bf16_f32 v136, v173, v177
    v_cvt_pk_bf16_f32 v140, v174, v178
    v_mfma_f32_16x16x32_bf16 v[36:39], a[56:59], a[244:247], v[36:39]
    buffer_load_dwordx4 v1, s[20:23], s45 offen offset:1024 sc1 lds
    v_mfma_f32_16x16x32_bf16 v[40:43], a[104:107], a[244:247], v[40:43]
    s_waitcnt lgkmcnt(2)
    ds_read_b128 a[244:247], v2 offset:9216
    v_cvt_pk_bf16_f32 v144, v175, v179
    v_mfma_f32_16x16x32_bf16 v[20:23], a[12:15], a[248:251], v[20:23]
    v_cvt_pk_bf16_f32 v212, v188, v192
    v_cvt_pk_bf16_f32 v216, v189, v193
    v_mfma_f32_16x16x32_bf16 v[24:27], a[60:63], a[248:251], v[24:27]
    v_cvt_pk_bf16_f32 v220, v190, v194
    v_cvt_pk_bf16_f32 v224, v191, v195
    v_mfma_f32_16x16x32_bf16 v[28:31], a[108:111], a[248:251], v[28:31]
    s_waitcnt lgkmcnt(2)
    ds_read_b128 a[248:251], v2 offset:10240
    v_mfma_f32_16x16x32_bf16 v[32:35], a[12:15], a[252:255], v[32:35]
    buffer_load_dwordx4 v1, s[20:23], s45 offen offset:2048 sc1 lds
    v_mfma_f32_16x16x32_bf16 v[36:39], a[60:63], a[252:255], v[36:39]
    v_mfma_f32_16x16x32_bf16 v[40:43], a[108:111], a[252:255], v[40:43]
    s_waitcnt lgkmcnt(2)
    ds_read_b128 a[252:255], v2 offset:11264
    v_mfma_f32_16x16x32_bf16 v[20:23], a[16:19], a[240:243], v[20:23]
    v_mfma_f32_16x16x32_bf16 v[24:27], a[64:67], a[240:243], v[24:27]
    buffer_load_dwordx4 v1, s[20:23], s45 offen offset:3072 sc1 lds
    s_add_u32 s45, s29, 28672
    v_mfma_f32_16x16x32_bf16 v[28:31], a[112:115], a[240:243], v[28:31]
    s_waitcnt lgkmcnt(2)
    s_add_u32 m0, s29, 28672
    ds_read_b128 a[240:243], v2 offset:12288
    v_mfma_f32_16x16x32_bf16 v[32:35], a[16:19], a[244:247], v[32:35]
    v_mfma_f32_16x16x32_bf16 v[36:39], a[64:67], a[244:247], v[36:39]
    v_mfma_f32_16x16x32_bf16 v[40:43], a[112:115], a[244:247], v[40:43]
    s_waitcnt lgkmcnt(2)
    ds_read_b128 a[244:247], v2 offset:13312
    v_mfma_f32_16x16x32_bf16 v[20:23], a[20:23], a[248:251], v[20:23]
    buffer_load_dwordx4 v1, s[20:23], s45 offen offset:0 sc1 lds
    v_mfma_f32_16x16x32_bf16 v[24:27], a[68:71], a[248:251], v[24:27]
    v_mfma_f32_16x16x32_bf16 v[28:31], a[116:119], a[248:251], v[28:31]
    s_waitcnt lgkmcnt(2)
    ds_read_b128 a[248:251], v2 offset:14336
    v_mfma_f32_16x16x32_bf16 v[32:35], a[20:23], a[252:255], v[32:35]
    v_mfma_f32_16x16x32_bf16 v[36:39], a[68:71], a[252:255], v[36:39]
    buffer_store_dwordx4 v[228:231], v19, s[24:27], s34 offen offset:256 nt
    v_mfma_f32_16x16x32_bf16 v[40:43], a[116:119], a[252:255], v[40:43]
    s_waitcnt lgkmcnt(2)
    ds_read_b128 a[252:255], v2 offset:15360
    v_mfma_f32_16x16x32_bf16 v[20:23], a[24:27], a[240:243], v[20:23]
    v_cvt_pk_bf16_f32 v228, v204, v208
    v_mfma_f32_16x16x32_bf16 v[24:27], a[72:75], a[240:243], v[24:27]
    v_mfma_f32_16x16x32_bf16 v[28:31], a[120:123], a[240:243], v[28:31]
    s_waitcnt lgkmcnt(2)
    ds_read_b128 a[240:243], v2 offset:16384
    v_mfma_f32_16x16x32_bf16 v[32:35], a[24:27], a[244:247], v[32:35]
    buffer_load_dwordx4 v1, s[20:23], s45 offen offset:1024 sc1 lds
    v_mfma_f32_16x16x32_bf16 v[36:39], a[72:75], a[244:247], v[36:39]
    v_mfma_f32_16x16x32_bf16 v[40:43], a[120:123], a[244:247], v[40:43]
    s_waitcnt lgkmcnt(2)
    ds_read_b128 a[244:247], v2 offset:17408
    v_mfma_f32_16x16x32_bf16 v[20:23], a[28:31], a[248:251], v[20:23]
    v_mfma_f32_16x16x32_bf16 v[24:27], a[76:79], a[248:251], v[24:27]
    v_mfma_f32_16x16x32_bf16 v[28:31], a[124:127], a[248:251], v[28:31]
    s_waitcnt lgkmcnt(2)
    ds_read_b128 a[248:251], v2 offset:18432
    v_mfma_f32_16x16x32_bf16 v[32:35], a[28:31], a[252:255], v[32:35]
    v_mfma_f32_16x16x32_bf16 v[36:39], a[76:79], a[252:255], v[36:39]
    v_mfma_f32_16x16x32_bf16 v[40:43], a[124:127], a[252:255], v[40:43]
    s_waitcnt lgkmcnt(2)
    ds_read_b128 a[252:255], v2 offset:19456
    v_mfma_f32_16x16x32_bf16 v[20:23], a[32:35], a[240:243], v[20:23]
    v_mfma_f32_16x16x32_bf16 v[24:27], a[80:83], a[240:243], v[24:27]
    v_mfma_f32_16x16x32_bf16 v[28:31], a[128:131], a[240:243], v[28:31]
    s_waitcnt lgkmcnt(2)
    ds_read_b128 a[240:243], v2 offset:20480
    v_mfma_f32_16x16x32_bf16 v[32:35], a[32:35], a[244:247], v[32:35]
    v_mfma_f32_16x16x32_bf16 v[36:39], a[80:83], a[244:247], v[36:39]
    v_mfma_f32_16x16x32_bf16 v[40:43], a[128:131], a[244:247], v[40:43]
    s_waitcnt lgkmcnt(2)
    ds_read_b128 a[244:247], v2 offset:21504
    v_mfma_f32_16x16x32_bf16 v[20:23], a[36:39], a[248:251], v[20:23]
    v_mfma_f32_16x16x32_bf16 v[24:27], a[84:87], a[248:251], v[24:27]
    v_mfma_f32_16x16x32_bf16 v[28:31], a[132:135], a[248:251], v[28:31]
    s_waitcnt lgkmcnt(2)
    ds_read_b128 a[248:251], v2 offset:22528
    v_mfma_f32_16x16x32_bf16 v[32:35], a[36:39], a[252:255], v[32:35]
    v_mfma_f32_16x16x32_bf16 v[36:39], a[84:87], a[252:255], v[36:39]
    v_mfma_f32_16x16x32_bf16 v[40:43], a[132:135], a[252:255], v[40:43]
    s_waitcnt lgkmcnt(2)
    ds_read_b128 a[252:255], v2 offset:23552
    v_mfma_f32_16x16x32_bf16 v[20:23], a[40:43], a[240:243], v[20:23]
    v_mfma_f32_16x16x32_bf16 v[24:27], a[88:91], a[240:243], v[24:27]
    v_mfma_f32_16x16x32_bf16 v[28:31], a[136:139], a[240:243], v[28:31]
    s_waitcnt lgkmcnt(2)
    ds_read_b128 a[240:243], v2 offset:24576
    v_mfma_f32_16x16x32_bf16 v[32:35], a[40:43], a[244:247], v[32:35]
    v_mfma_f32_16x16x32_bf16 v[36:39], a[88:91], a[244:247], v[36:39]
    v_mfma_f32_16x16x32_bf16 v[40:43], a[136:139], a[244:247], v[40:43]
    s_waitcnt lgkmcnt(2)
    ds_read_b128 a[244:247], v2 offset:25600
    v_mfma_f32_16x16x32_bf16 v[20:23], a[44:47], a[248:251], v[20:23]
    v_mfma_f32_16x16x32_bf16 v[24:27], a[92:95], a[248:251], v[24:27]
    v_mfma_f32_16x16x32_bf16 v[28:31], a[140:143], a[248:251], v[28:31]
    s_waitcnt lgkmcnt(2)
    ds_read_b128 a[248:251], v2 offset:26624
    v_mfma_f32_16x16x32_bf16 v[32:35], a[44:47], a[252:255], v[32:35]
    v_mfma_f32_16x16x32_bf16 v[36:39], a[92:95], a[252:255], v[36:39]
    v_mfma_f32_16x16x32_bf16 v[40:43], a[140:143], a[252:255], v[40:43]
    v_mfma_f32_16x16x32_bf16 v[156:159], v[148:151], v[68:71], 0
    v_mfma_f32_16x16x32_bf16 v[172:175], v[164:167], v[68:71], 0
    v_mfma_f32_16x16x32_bf16 v[188:191], v[180:183], v[68:71], 0
    v_mfma_f32_16x16x32_bf16 v[204:207], v[196:199], v[68:71], 0
    v_mfma_f32_16x16x32_bf16 v[160:163], v[148:151], v[76:79], 0
    v_mfma_f32_16x16x32_bf16 v[176:179], v[164:167], v[76:79], 0
    v_mfma_f32_16x16x32_bf16 v[192:195], v[180:183], v[76:79], 0
    v_mfma_f32_16x16x32_bf16 v[208:211], v[196:199], v[76:79], 0
    v_mfma_f32_16x16x32_bf16 v[156:159], v[152:155], v[72:75], v[156:159]
    v_mfma_f32_16x16x32_bf16 v[172:175], v[168:171], v[72:75], v[172:175]
    v_mfma_f32_16x16x32_bf16 v[188:191], v[184:187], v[72:75], v[188:191]
    v_mfma_f32_16x16x32_bf16 v[204:207], v[200:203], v[72:75], v[204:207]
    v_mfma_f32_16x16x32_bf16 v[160:163], v[152:155], v[80:83], v[160:163]
    v_mfma_f32_16x16x32_bf16 v[176:179], v[168:171], v[80:83], v[176:179]
    v_mfma_f32_16x16x32_bf16 v[192:195], v[184:187], v[80:83], v[192:195]
    v_mfma_f32_16x16x32_bf16 v[208:211], v[200:203], v[80:83], v[208:211]
    s_waitcnt lgkmcnt(2)
    v_mfma_f32_16x16x32_bf16 v[44:47], a[0:3], a[240:243], 0
    ds_read_b128 a[252:255], v2 offset:27648
    v_mfma_f32_16x16x32_bf16 v[48:51], a[48:51], a[240:243], 0
    v_cvt_pk_bf16_f32 v84, v20, v21
    v_cvt_pk_bf16_f32 v85, v22, v23
    v_mfma_f32_16x16x32_bf16 v[52:55], a[96:99], a[240:243], 0
    s_waitcnt lgkmcnt(2)
    ds_read_b128 a[240:243], v2 offset:28672
    v_cvt_pk_bf16_f32 v86, v24, v25
    v_mfma_f32_16x16x32_bf16 v[56:59], a[0:3], a[244:247], 0
    v_cvt_pk_bf16_f32 v87, v26, v27
    v_cvt_pk_bf16_f32 v88, v28, v29
    v_mfma_f32_16x16x32_bf16 v[60:63], a[48:51], a[244:247], 0
    ds_read_u16 v90, v5 offset:640
    v_cvt_pk_bf16_f32 v89, v30, v31
    v_mfma_f32_16x16x32_bf16 v[64:67], a[96:99], a[244:247], 0
    s_waitcnt lgkmcnt(3)
    ds_read_b128 a[244:247], v2 offset:29696
    v_cvt_pk_bf16_f32 v92, v32, v33
    v_mfma_f32_16x16x32_bf16 v[44:47], a[4:7], a[248:251], v[44:47]
    v_cvt_pk_bf16_f32 v93, v34, v35
    v_cvt_pk_bf16_f32 v94, v36, v37
    v_mfma_f32_16x16x32_bf16 v[48:51], a[52:55], a[248:251], v[48:51]
    ds_read_u16 v98, v5 offset:642
    v_cvt_pk_bf16_f32 v95, v38, v39
    v_mfma_f32_16x16x32_bf16 v[52:55], a[100:103], a[248:251], v[52:55]
    s_waitcnt lgkmcnt(4)
    ds_read_b128 a[248:251], v2 offset:30720
    v_cvt_pk_bf16_f32 v96, v40, v41
    v_mfma_f32_16x16x32_bf16 v[56:59], a[4:7], a[252:255], v[56:59]
    v_cvt_pk_bf16_f32 v97, v42, v43
    v_cvt_pk_bf16_f32 v117, v156, v160
    v_mfma_f32_16x16x32_bf16 v[60:63], a[52:55], a[252:255], v[60:63]
    v_cvt_pk_bf16_f32 v121, v157, v161
    v_cvt_pk_bf16_f32 v125, v158, v162
    v_mfma_f32_16x16x32_bf16 v[64:67], a[100:103], a[252:255], v[64:67]
    s_waitcnt lgkmcnt(4)
    ds_read_b128 a[252:255], v2 offset:31744
    v_cvt_pk_bf16_f32 v129, v159, v163
    v_mfma_f32_16x16x32_bf16 v[44:47], a[8:11], a[240:243], v[44:47]
    v_cvt_pk_bf16_f32 v133, v172, v176
    v_cvt_pk_bf16_f32 v137, v173, v177
    v_mfma_f32_16x16x32_bf16 v[48:51], a[56:59], a[240:243], v[48:51]
    v_cvt_pk_bf16_f32 v141, v174, v178
    v_cvt_pk_bf16_f32 v145, v175, v179
    v_mfma_f32_16x16x32_bf16 v[52:55], a[104:107], a[240:243], v[52:55]
    s_waitcnt lgkmcnt(3)
    ds_read_b128 a[240:243], v2 offset:32768
    v_cvt_pk_bf16_f32 v213, v188, v192
    v_mfma_f32_16x16x32_bf16 v[56:59], a[8:11], a[244:247], v[56:59]
    v_cvt_pk_bf16_f32 v217, v189, v193
    v_cvt_pk_bf16_f32 v221, v190, v194
    v_mfma_f32_16x16x32_bf16 v[60:63], a[56:59], a[244:247], v[60:63]
    v_cvt_pk_bf16_f32 v225, v191, v195
    v_cvt_pk_bf16_f32 v229, v204, v208
    v_mfma_f32_16x16x32_bf16 v[64:67], a[104:107], a[244:247], v[64:67]
    s_waitcnt lgkmcnt(2)
    ds_read_b128 a[244:247], v2 offset:33792
    v_accvgpr_mov_b32 a0, a144
    v_mfma_f32_16x16x32_bf16 v[44:47], a[12:15], a[248:251], v[44:47]
    v_accvgpr_mov_b32 a1, a145
    v_accvgpr_mov_b32 a2, a146
    v_mfma_f32_16x16x32_bf16 v[48:51], a[60:63], a[248:251], v[48:51]
    v_accvgpr_mov_b32 a3, a147
    v_accvgpr_mov_b32 a48, a176
    v_mfma_f32_16x16x32_bf16 v[52:55], a[108:111], a[248:251], v[52:55]
    s_waitcnt lgkmcnt(2)
    ds_read_b128 a[248:251], v2 offset:34816
    v_accvgpr_mov_b32 a49, a177
    v_mfma_f32_16x16x32_bf16 v[56:59], a[12:15], a[252:255], v[56:59]
    v_accvgpr_mov_b32 a50, a178
    v_accvgpr_mov_b32 a51, a179
    v_mfma_f32_16x16x32_bf16 v[60:63], a[60:63], a[252:255], v[60:63]
    v_accvgpr_mov_b32 a96, a208
    v_accvgpr_mov_b32 a97, a209
    v_mfma_f32_16x16x32_bf16 v[64:67], a[108:111], a[252:255], v[64:67]
    s_waitcnt lgkmcnt(2)
    ds_read_b128 a[252:255], v2 offset:35840
    v_accvgpr_mov_b32 a98, a210
    v_mfma_f32_16x16x32_bf16 v[44:47], a[16:19], a[240:243], v[44:47]
    v_accvgpr_mov_b32 a99, a211
    v_accvgpr_mov_b32 a4, a148
    v_mfma_f32_16x16x32_bf16 v[48:51], a[64:67], a[240:243], v[48:51]
    v_accvgpr_mov_b32 a5, a149
    v_accvgpr_mov_b32 a6, a150
    v_mfma_f32_16x16x32_bf16 v[52:55], a[112:115], a[240:243], v[52:55]
    s_waitcnt lgkmcnt(2)
    ds_read_b128 a[240:243], v2 offset:36864
    v_accvgpr_mov_b32 a7, a151
    v_mfma_f32_16x16x32_bf16 v[56:59], a[16:19], a[244:247], v[56:59]
    v_accvgpr_mov_b32 a52, a180
    v_accvgpr_mov_b32 a53, a181
    v_mfma_f32_16x16x32_bf16 v[60:63], a[64:67], a[244:247], v[60:63]
    v_accvgpr_mov_b32 a54, a182
    v_accvgpr_mov_b32 a55, a183
    v_mfma_f32_16x16x32_bf16 v[64:67], a[112:115], a[244:247], v[64:67]
    s_waitcnt lgkmcnt(2)
    ds_read_b128 a[244:247], v2 offset:37888
    v_accvgpr_mov_b32 a100, a212
    v_mfma_f32_16x16x32_bf16 v[44:47], a[20:23], a[248:251], v[44:47]
    v_accvgpr_mov_b32 a101, a213
    v_accvgpr_mov_b32 a102, a214
    v_mfma_f32_16x16x32_bf16 v[48:51], a[68:71], a[248:251], v[48:51]
    v_accvgpr_mov_b32 a103, a215
    v_accvgpr_mov_b32 a8, a152
    v_mfma_f32_16x16x32_bf16 v[52:55], a[116:119], a[248:251], v[52:55]
    s_waitcnt lgkmcnt(2)
    ds_read_b128 a[248:251], v2 offset:38912
    v_accvgpr_mov_b32 a9, a153
    v_mfma_f32_16x16x32_bf16 v[56:59], a[20:23], a[252:255], v[56:59]
    v_accvgpr_mov_b32 a10, a154
    v_accvgpr_mov_b32 a11, a155
    v_mfma_f32_16x16x32_bf16 v[60:63], a[68:71], a[252:255], v[60:63]
    v_accvgpr_mov_b32 a56, a184
    v_accvgpr_mov_b32 a57, a185
    v_mfma_f32_16x16x32_bf16 v[64:67], a[116:119], a[252:255], v[64:67]
    s_waitcnt lgkmcnt(2)
    ds_read_b128 a[252:255], v2 offset:39936
    v_accvgpr_mov_b32 a58, a186
    v_mfma_f32_16x16x32_bf16 v[44:47], a[24:27], a[240:243], v[44:47]
    v_accvgpr_mov_b32 a59, a187
    v_accvgpr_mov_b32 a104, a216
    v_mfma_f32_16x16x32_bf16 v[48:51], a[72:75], a[240:243], v[48:51]
    v_accvgpr_mov_b32 a105, a217
    v_accvgpr_mov_b32 a106, a218
    v_mfma_f32_16x16x32_bf16 v[52:55], a[120:123], a[240:243], v[52:55]
    s_waitcnt lgkmcnt(2)
    ds_read_b128 a[240:243], v2 offset:40960
    v_accvgpr_mov_b32 a107, a219
    v_mfma_f32_16x16x32_bf16 v[56:59], a[24:27], a[244:247], v[56:59]
    v_accvgpr_mov_b32 a12, a156
    v_accvgpr_mov_b32 a13, a157
    v_mfma_f32_16x16x32_bf16 v[60:63], a[72:75], a[244:247], v[60:63]
    v_accvgpr_mov_b32 a14, a158
    v_accvgpr_mov_b32 a15, a159
    v_mfma_f32_16x16x32_bf16 v[64:67], a[120:123], a[244:247], v[64:67]
    s_waitcnt lgkmcnt(2)
    ds_read_b128 a[244:247], v2 offset:41984
    v_accvgpr_mov_b32 a60, a188
    v_mfma_f32_16x16x32_bf16 v[44:47], a[28:31], a[248:251], v[44:47]
    v_accvgpr_mov_b32 a61, a189
    v_accvgpr_mov_b32 a62, a190
    v_mfma_f32_16x16x32_bf16 v[48:51], a[76:79], a[248:251], v[48:51]
    v_accvgpr_mov_b32 a63, a191
    v_accvgpr_mov_b32 a108, a220
    v_mfma_f32_16x16x32_bf16 v[52:55], a[124:127], a[248:251], v[52:55]
    s_waitcnt lgkmcnt(2)
    ds_read_b128 a[248:251], v2 offset:43008
    v_accvgpr_mov_b32 a109, a221
    v_mfma_f32_16x16x32_bf16 v[56:59], a[28:31], a[252:255], v[56:59]
    v_accvgpr_mov_b32 a110, a222
    v_accvgpr_mov_b32 a111, a223
    v_mfma_f32_16x16x32_bf16 v[60:63], a[76:79], a[252:255], v[60:63]
    v_accvgpr_mov_b32 a16, a160
    v_accvgpr_mov_b32 a17, a161
    v_mfma_f32_16x16x32_bf16 v[64:67], a[124:127], a[252:255], v[64:67]
    s_waitcnt lgkmcnt(2)
    ds_read_b128 a[252:255], v2 offset:44032
    v_accvgpr_mov_b32 a18, a162
    v_mfma_f32_16x16x32_bf16 v[44:47], a[32:35], a[240:243], v[44:47]
    v_accvgpr_mov_b32 a19, a163
    v_accvgpr_mov_b32 a64, a192
    v_mfma_f32_16x16x32_bf16 v[48:51], a[80:83], a[240:243], v[48:51]
    v_accvgpr_mov_b32 a65, a193
    v_accvgpr_mov_b32 a66, a194
    v_mfma_f32_16x16x32_bf16 v[52:55], a[128:131], a[240:243], v[52:55]
    s_waitcnt lgkmcnt(2)
    ds_read_b128 a[240:243], v2 offset:45056
    v_accvgpr_mov_b32 a67, a195
    v_mfma_f32_16x16x32_bf16 v[56:59], a[32:35], a[244:247], v[56:59]
    v_accvgpr_mov_b32 a112, a224
    v_accvgpr_mov_b32 a113, a225
    v_mfma_f32_16x16x32_bf16 v[60:63], a[80:83], a[244:247], v[60:63]
    v_accvgpr_mov_b32 a114, a226
    v_accvgpr_mov_b32 a115, a227
    v_mfma_f32_16x16x32_bf16 v[64:67], a[128:131], a[244:247], v[64:67]
    s_waitcnt lgkmcnt(2)
    ds_read_b128 a[244:247], v2 offset:46080
    v_accvgpr_mov_b32 a20, a164
    v_mfma_f32_16x16x32_bf16 v[44:47], a[36:39], a[248:251], v[44:47]
    v_accvgpr_mov_b32 a21, a165
    v_accvgpr_mov_b32 a22, a166
    v_mfma_f32_16x16x32_bf16 v[48:51], a[84:87], a[248:251], v[48:51]
    v_accvgpr_mov_b32 a23, a167
    v_accvgpr_mov_b32 a68, a196
    v_mfma_f32_16x16x32_bf16 v[52:55], a[132:135], a[248:251], v[52:55]
    s_waitcnt lgkmcnt(2)
    ds_read_b128 a[248:251], v2 offset:47104
    v_accvgpr_mov_b32 a69, a197
    v_mfma_f32_16x16x32_bf16 v[56:59], a[36:39], a[252:255], v[56:59]
    v_accvgpr_mov_b32 a70, a198
    v_accvgpr_mov_b32 a71, a199
    v_mfma_f32_16x16x32_bf16 v[60:63], a[84:87], a[252:255], v[60:63]
    v_accvgpr_mov_b32 a116, a228
    v_accvgpr_mov_b32 a117, a229
    v_mfma_f32_16x16x32_bf16 v[64:67], a[132:135], a[252:255], v[64:67]
    s_waitcnt lgkmcnt(2)
    ds_read_b128 a[252:255], v2 offset:48128
    v_accvgpr_mov_b32 a118, a230
    v_mfma_f32_16x16x32_bf16 v[44:47], a[40:43], a[240:243], v[44:47]
    v_accvgpr_mov_b32 a119, a231
    v_mfma_f32_16x16x32_bf16 v[48:51], a[88:91], a[240:243], v[48:51]
    v_mfma_f32_16x16x32_bf16 v[52:55], a[136:139], a[240:243], v[52:55]
    s_waitcnt lgkmcnt(2)
    v_mfma_f32_16x16x32_bf16 v[56:59], a[40:43], a[244:247], v[56:59]
    v_mfma_f32_16x16x32_bf16 v[60:63], a[88:91], a[244:247], v[60:63]
    v_mfma_f32_16x16x32_bf16 v[64:67], a[136:139], a[244:247], v[64:67]
    s_waitcnt lgkmcnt(1)
    v_mfma_f32_16x16x32_bf16 v[44:47], a[44:47], a[248:251], v[44:47]
    v_mfma_f32_16x16x32_bf16 v[48:51], a[92:95], a[248:251], v[48:51]
    v_mfma_f32_16x16x32_bf16 v[52:55], a[140:143], a[248:251], v[52:55]
    s_waitcnt vmcnt(0) lgkmcnt(0)
    s_barrier
    ds_read_b128 a[240:243], v1 offset:0
    v_mfma_f32_16x16x32_bf16 v[56:59], a[44:47], a[252:255], v[56:59]
    ds_read_b128 a[244:247], v1 offset:1024
    v_mfma_f32_16x16x32_bf16 v[60:63], a[92:95], a[252:255], v[60:63]
    ds_read_b128 a[248:251], v1 offset:2048
    v_mfma_f32_16x16x32_bf16 v[64:67], a[140:143], a[252:255], v[64:67]
    v_mfma_f32_16x16x32_bf16 v[156:159], v[148:151], v[84:87], 0
    v_mfma_f32_16x16x32_bf16 v[172:175], v[164:167], v[84:87], 0
    v_mfma_f32_16x16x32_bf16 v[188:191], v[180:183], v[84:87], 0
    v_mfma_f32_16x16x32_bf16 v[204:207], v[196:199], v[84:87], 0
    v_mfma_f32_16x16x32_bf16 v[160:163], v[148:151], v[92:95], 0
    v_mfma_f32_16x16x32_bf16 v[176:179], v[164:167], v[92:95], 0
    v_mfma_f32_16x16x32_bf16 v[192:195], v[180:183], v[92:95], 0
    v_mfma_f32_16x16x32_bf16 v[208:211], v[196:199], v[92:95], 0
    v_mfma_f32_16x16x32_bf16 v[156:159], v[152:155], v[88:91], v[156:159]
    v_mfma_f32_16x16x32_bf16 v[172:175], v[168:171], v[88:91], v[172:175]
    v_mfma_f32_16x16x32_bf16 v[188:191], v[184:187], v[88:91], v[188:191]
    v_mfma_f32_16x16x32_bf16 v[204:207], v[200:203], v[88:91], v[204:207]
    v_mfma_f32_16x16x32_bf16 v[160:163], v[152:155], v[96:99], v[160:163]
    v_mfma_f32_16x16x32_bf16 v[176:179], v[168:171], v[96:99], v[176:179]
    v_mfma_f32_16x16x32_bf16 v[192:195], v[184:187], v[96:99], v[192:195]
    v_mfma_f32_16x16x32_bf16 v[208:211], v[200:203], v[96:99], v[208:211]
    s_add_u32 s38, s38, 1
    s_cmp_lt_u32 s38, 3
    s_cbranch_scc1 L_round
    s_nop 7
    v_cvt_pk_bf16_f32 v100, v44, v45
    v_cvt_pk_bf16_f32 v101, v46, v47
    v_cvt_pk_bf16_f32 v102, v48, v49
    v_cvt_pk_bf16_f32 v103, v50, v51
    v_cvt_pk_bf16_f32 v104, v52, v53
    v_cvt_pk_bf16_f32 v105, v54, v55
    v_cvt_pk_bf16_f32 v108, v56, v57
    v_cvt_pk_bf16_f32 v109, v58, v59
    v_cvt_pk_bf16_f32 v110, v60, v61
    v_cvt_pk_bf16_f32 v111, v62, v63
    v_cvt_pk_bf16_f32 v112, v64, v65
    v_cvt_pk_bf16_f32 v113, v66, v67
    ds_read_u16 v106, v5 offset:704
    ds_read_u16 v114, v5 offset:706
    v_cvt_pk_bf16_f32 v118, v156, v160
    v_cvt_pk_bf16_f32 v122, v157, v161
    v_cvt_pk_bf16_f32 v126, v158, v162
    v_cvt_pk_bf16_f32 v130, v159, v163
    v_cvt_pk_bf16_f32 v134, v172, v176
    v_cvt_pk_bf16_f32 v138, v173, v177
    v_cvt_pk_bf16_f32 v142, v174, v178
    v_cvt_pk_bf16_f32 v146, v175, v179
    v_cvt_pk_bf16_f32 v214, v188, v192
    v_cvt_pk_bf16_f32 v218, v189, v193
    v_cvt_pk_bf16_f32 v222, v190, v194
    v_cvt_pk_bf16_f32 v226, v191, v195
    v_cvt_pk_bf16_f32 v230, v204, v208
    v_mfma_f32_16x16x32_bf16 v[156:159], v[148:151], v[100:103], 0
    v_mfma_f32_16x16x32_bf16 v[172:175], v[164:167], v[100:103], 0
    v_mfma_f32_16x16x32_bf16 v[188:191], v[180:183], v[100:103], 0
    v_mfma_f32_16x16x32_bf16 v[204:207], v[196:199], v[100:103], 0
    v_mfma_f32_16x16x32_bf16 v[160:163], v[148:151], v[108:111], 0
    v_mfma_f32_16x16x32_bf16 v[176:179], v[164:167], v[108:111], 0
    v_mfma_f32_16x16x32_bf16 v[192:195], v[180:183], v[108:111], 0
    v_mfma_f32_16x16x32_bf16 v[208:211], v[196:199], v[108:111], 0
    s_waitcnt lgkmcnt(1)
    v_mfma_f32_16x16x32_bf16 v[156:159], v[152:155], v[104:107], v[156:159]
    v_mfma_f32_16x16x32_bf16 v[172:175], v[168:171], v[104:107], v[172:175]
    v_mfma_f32_16x16x32_bf16 v[188:191], v[184:187], v[104:107], v[188:191]
    v_mfma_f32_16x16x32_bf16 v[204:207], v[200:203], v[104:107], v[204:207]
    s_waitcnt lgkmcnt(0)
    v_mfma_f32_16x16x32_bf16 v[160:163], v[152:155], v[112:115], v[160:163]
    v_mfma_f32_16x16x32_bf16 v[176:179], v[168:171], v[112:115], v[176:179]
    v_mfma_f32_16x16x32_bf16 v[192:195], v[184:187], v[112:115], v[192:195]
    v_mfma_f32_16x16x32_bf16 v[208:211], v[200:203], v[112:115], v[208:211]
    s_nop 4
    v_cvt_pk_bf16_f32 v119, v156, v160
    v_cvt_pk_bf16_f32 v123, v157, v161
    v_cvt_pk_bf16_f32 v127, v158, v162
    v_cvt_pk_bf16_f32 v131, v159, v163
    v_cvt_pk_bf16_f32 v135, v172, v176
    v_cvt_pk_bf16_f32 v139, v173, v177
    v_cvt_pk_bf16_f32 v143, v174, v178
    v_cvt_pk_bf16_f32 v147, v175, v179
    v_cvt_pk_bf16_f32 v215, v188, v192
    v_cvt_pk_bf16_f32 v219, v189, v193
    v_cvt_pk_bf16_f32 v223, v190, v194
    v_cvt_pk_bf16_f32 v227, v191, v195
    v_cvt_pk_bf16_f32 v231, v204, v208
    buffer_store_dwordx4 v[116:119], v7, s[24:27], s34 offen offset:512 nt
    buffer_store_dwordx4 v[120:123], v8, s[24:27], s34 offen offset:512 nt
    buffer_store_dwordx4 v[124:127], v9, s[24:27], s34 offen offset:512 nt
    buffer_store_dwordx4 v[128:131], v10, s[24:27], s34 offen offset:512 nt
    buffer_store_dwordx4 v[132:135], v11, s[24:27], s34 offen offset:512 nt
    buffer_store_dwordx4 v[136:139], v12, s[24:27], s34 offen offset:512 nt
    buffer_store_dwordx4 v[140:143], v13, s[24:27], s34 offen offset:512 nt
    buffer_store_dwordx4 v[144:147], v14, s[24:27], s34 offen offset:512 nt
    buffer_store_dwordx4 v[212:215], v15, s[24:27], s34 offen offset:512 nt
    buffer_store_dwordx4 v[216:219], v16, s[24:27], s34 offen offset:512 nt
    buffer_store_dwordx4 v[220:223], v17, s[24:27], s34 offen offset:512 nt
    buffer_store_dwordx4 v[224:227], v18, s[24:27], s34 offen offset:512 nt
    buffer_store_dwordx4 v[228:231], v19, s[24:27], s34 offen offset:512 nt
    s_waitcnt vmcnt(0) lgkmcnt(0)
L_end:
    s_endpgm

L_slow_q:
    s_mov_b32 s61, 0
L_spin_q:
    buffer_load_ubyte v0, off, s[48:51], s37 sc1
    s_waitcnt vmcnt(0)
    v_readfirstlane_b32 s60, v0
    s_add_u32 s61, s61, 1
    s_cmp_ge_u32 s61, 400000
    s_cbranch_scc1 L_back_q
    s_cmp_ge_u32 s60, 1
    s_cbranch_scc1 L_back_q
    s_sleep 4
    s_branch L_spin_q

L_slow_va:
    s_mov_b32 s61, 0
L_spin_va:
    buffer_load_ubyte v0, off, s[48:51], s37 sc1
    s_waitcnt vmcnt(0)
    v_readfirstlane_b32 s60, v0
    s_add_u32 s61, s61, 1
    s_cmp_ge_u32 s61, 400000
    s_cbranch_scc1 L_back_va
    s_cmp_ge_u32 s60, 2
    s_cbranch_scc1 L_back_va
    s_sleep 4
    s_branch L_spin_va

L_slow_vb:
    s_mov_b32 s61, 0
L_spin_vb:
    buffer_load_ubyte v0, off, s[48:51], s37 sc1
    s_waitcnt vmcnt(0)
    v_readfirstlane_b32 s60, v0
    s_add_u32 s61, s61, 1
    s_cmp_ge_u32 s61, 400000
    s_cbranch_scc1 L_back_vb
    s_cmp_ge_u32 s60, 3
    s_cbranch_scc1 L_back_vb
    s_sleep 4
    s_branch L_spin_vb
L_nofold1:
    s_mov_b32 s16, s4
    s_mov_b32 s17, s5
    s_mov_b32 s18, 109734912
    s_mov_b32 s19, 0x20000
    s_mov_b32 s20, s14
    s_mov_b32 s21, s15
    s_mov_b32 s22, 5171200
    s_mov_b32 s23, 0x20000
    s_mov_b32 s48, s12
    s_mov_b32 s49, s13
    s_mov_b32 s50, 256
    s_mov_b32 s51, 0x20000
    s_mov_b32 s46, 284928
    s_mov_b32 s24, s10
    s_mov_b32 s25, s11
    s_mov_b32 s26, 0
    s_mov_b32 s27, 0x20000
    s_mul_i32 s29, s28, 6144
    s_mul_i32 s31, s28, 13056
    s_add_u32 s31, s31, 98304
    s_mul_i32 s32, s28, 2304
    s_add_u32 s32, s32, 150528
    s_mul_i32 s39, s30, 12
    s_add_u32 s39, s39, s28
    s_mov_b32 s38, 0
    s_mov_b32 s42, -1
    s_mov_b32 s43, 0xffff
    s_mov_b32 s34, 0
    s_mov_b32 s90, 0x00010001
    s_mov_b32 s91, 0x00010001
    s_mul_i32 s65, s39, 19419
    s_lshr_b32 s65, s65, 20
    s_mul_i32 s65, s65, 1741824
    s_mul_i32 s33, s39, 5376
    s_add_u32 s33, s33, s65
    v_lshlrev_b32 v24, 4, v21
    v_lshlrev_b32 v22, 2, v20
    v_add_u32 v22, 0, v22
    v_mul_u32_u24 v23, 37, v22
    v_lshrrev_b32 v23, 8, v23
    v_mul_lo_u32 v23, v23, s46
    v_mul_u32_u24 v22, 768, v22
    v_add3_u32 v7, v22, v23, v24
    v_lshlrev_b32 v22, 2, v20
    v_add_u32 v22, 1, v22
    v_mul_u32_u24 v23, 37, v22
    v_lshrrev_b32 v23, 8, v23
    v_mul_lo_u32 v23, v23, s46
    v_mul_u32_u24 v22, 768, v22
    v_add3_u32 v8, v22, v23, v24
    v_lshlrev_b32 v22, 2, v20
    v_add_u32 v22, 2, v22
    v_mul_u32_u24 v23, 37, v22
    v_lshrrev_b32 v23, 8, v23
    v_mul_lo_u32 v23, v23, s46
    v_mul_u32_u24 v22, 768, v22
    v_add3_u32 v9, v22, v23, v24
    v_lshlrev_b32 v22, 2, v20
    v_add_u32 v22, 3, v22
    v_mul_u32_u24 v23, 37, v22
    v_lshrrev_b32 v23, 8, v23
    v_mul_lo_u32 v23, v23, s46
    v_mul_u32_u24 v22, 768, v22
    v_add3_u32 v10, v22, v23, v24
    v_lshlrev_b32 v22, 2, v20
    v_add_u32 v22, 16, v22
    v_mul_u32_u24 v23, 37, v22
    v_lshrrev_b32 v23, 8, v23
    v_mul_lo_u32 v23, v23, s46
    v_mul_u32_u24 v22, 768, v22
    v_add3_u32 v11, v22, v23, v24
    v_lshlrev_b32 v22, 2, v20
    v_add_u32 v22, 17, v22
    v_mul_u32_u24 v23, 37, v22
    v_lshrrev_b32 v23, 8, v23
    v_mul_lo_u32 v23, v23, s46
    v_mul_u32_u24 v22, 768, v22
    v_add3_u32 v12, v22, v23, v24
    v_lshlrev_b32 v22, 2, v20
    v_add_u32 v22, 18, v22
    v_mul_u32_u24 v23, 37, v22
    v_lshrrev_b32 v23, 8, v23
    v_mul_lo_u32 v23, v23, s46
    v_mul_u32_u24 v22, 768, v22
    v_add3_u32 v13, v22, v23, v24
    v_lshlrev_b32 v22, 2, v20
    v_add_u32 v22, 19, v22
    v_mul_u32_u24 v23, 37, v22
    v_lshrrev_b32 v23, 8, v23
    v_mul_lo_u32 v23, v23, s46
    v_mul_u32_u24 v22, 768, v22
    v_add3_u32 v14, v22, v23, v24
    v_lshlrev_b32 v22, 2, v20
    v_add_u32 v22, 32, v22
    v_mul_u32_u24 v23, 37, v22
    v_lshrrev_b32 v23, 8, v23
    v_mul_lo_u32 v23, v23, s46
    v_mul_u32_u24 v22, 768, v22
    v_add3_u32 v15, v22, v23, v24
    v_lshlrev_b32 v22, 2, v20
    v_add_u32 v22, 33, v22
    v_mul_u32_u24 v23, 37, v22
    v_lshrrev_b32 v23, 8, v23
    v_mul_lo_u32 v23, v23, s46
    v_mul_u32_u24 v22, 768, v22
    v_add3_u32 v16, v22, v23, v24
    v_lshlrev_b32 v22, 2, v20
    v_add_u32 v22, 34, v22
    v_mul_u32_u24 v23, 37, v22
    v_lshrrev_b32 v23, 8, v23
    v_mul_lo_u32 v23, v23, s46
    v_mul_u32_u24 v22, 768, v22
    v_add3_u32 v17, v22, v23, v24
    v_lshlrev_b32 v22, 2, v20
    v_add_u32 v22, 35, v22
    v_mul_u32_u24 v23, 37, v22
    v_lshrrev_b32 v23, 8, v23
    v_mul_lo_u32 v23, v23, s46
    v_mul_u32_u24 v22, 768, v22
    v_add3_u32 v18, v22, v23, v24
    v_lshlrev_b32 v22, 2, v20
    v_add_u32 v22, 0, v22
    v_xor_b32 v22, v22, v21
    v_sub_u32 v22, v22, v21
    v_lshlrev_b32 v26, 4, v22
    v_lshlrev_b32 v22, 2, v20
    v_add_u32 v22, 1, v22
    v_xor_b32 v22, v22, v21
    v_sub_u32 v22, v22, v21
    v_lshlrev_b32 v27, 4, v22
    v_lshlrev_b32 v22, 2, v20
    v_add_u32 v22, 2, v22
    v_xor_b32 v22, v22, v21
    v_sub_u32 v22, v22, v21
    v_lshlrev_b32 v28, 4, v22
    v_lshlrev_b32 v22, 2, v20
    v_add_u32 v22, 3, v22
    v_xor_b32 v22, v22, v21
    v_sub_u32 v22, v22, v21
    v_lshlrev_b32 v29, 4, v22
    s_mul_i32 s63, s28, 24576
    v_add_u32 v30, v7, v26
    s_add_u32 m0, s63, 0
    s_nop 0
    buffer_load_dwordx4 v30, s[16:19], s33 offen offset:0 nt lds
    s_add_u32 m0, s63, 12032
    s_nop 0
    buffer_load_dwordx4 v30, s[16:19], s33 offen offset:256 nt lds
    v_add_u32 v31, v8, v27
    s_add_u32 m0, s63, 1024
    s_nop 0
    buffer_load_dwordx4 v31, s[16:19], s33 offen offset:0 nt lds
    s_add_u32 m0, s63, 13056
    s_nop 0
    buffer_load_dwordx4 v31, s[16:19], s33 offen offset:256 nt lds
    v_add_u32 v30, v9, v28
    s_add_u32 m0, s63, 2048
    s_nop 0
    buffer_load_dwordx4 v30, s[16:19], s33 offen offset:0 nt lds
    s_add_u32 m0, s63, 14080
    s_nop 0
    buffer_load_dwordx4 v30, s[16:19], s33 offen offset:256 nt lds
    v_add_u32 v31, v10, v29
    s_add_u32 m0, s63, 3072
    s_nop 0
    buffer_load_dwordx4 v31, s[16:19], s33 offen offset:0 nt lds
    s_add_u32 m0, s63, 15104
    s_nop 0
    buffer_load_dwordx4 v31, s[16:19], s33 offen offset:256 nt lds
    v_add_u32 v30, v11, v26
    s_add_u32 m0, s63, 4096
    s_nop 0
    buffer_load_dwordx4 v30, s[16:19], s33 offen offset:0 nt lds
    s_add_u32 m0, s63, 16128
    s_nop 0
    buffer_load_dwordx4 v30, s[16:19], s33 offen offset:256 nt lds
    v_add_u32 v31, v12, v27
    s_add_u32 m0, s63, 5120
    s_nop 0
    buffer_load_dwordx4 v31, s[16:19], s33 offen offset:0 nt lds
    s_add_u32 m0, s63, 17152
    s_nop 0
    buffer_load_dwordx4 v31, s[16:19], s33 offen offset:256 nt lds
    v_add_u32 v30, v13, v28
    s_add_u32 m0, s63, 6144
    s_nop 0
    buffer_load_dwordx4 v30, s[16:19], s33 offen offset:0 nt lds
    s_add_u32 m0, s63, 18176
    s_nop 0
    buffer_load_dwordx4 v30, s[16:19], s33 offen offset:256 nt lds
    v_add_u32 v31, v14, v29
    s_add_u32 m0, s63, 7168
    s_nop 0
    buffer_load_dwordx4 v31, s[16:19], s33 offen offset:0 nt lds
    s_add_u32 m0, s63, 19200
    s_nop 0
    buffer_load_dwordx4 v31, s[16:19], s33 offen offset:256 nt lds
    v_add_u32 v30, v15, v26
    s_add_u32 m0, s63, 8192
    s_nop 0
    buffer_load_dwordx4 v30, s[16:19], s33 offen offset:0 nt lds
    s_add_u32 m0, s63, 20224
    s_nop 0
    buffer_load_dwordx4 v30, s[16:19], s33 offen offset:256 nt lds
    v_add_u32 v31, v16, v27
    s_add_u32 m0, s63, 9216
    s_nop 0
    buffer_load_dwordx4 v31, s[16:19], s33 offen offset:0 nt lds
    s_add_u32 m0, s63, 21248
    s_nop 0
    buffer_load_dwordx4 v31, s[16:19], s33 offen offset:256 nt lds
    v_add_u32 v30, v17, v28
    s_add_u32 m0, s63, 10240
    s_nop 0
    buffer_load_dwordx4 v30, s[16:19], s33 offen offset:0 nt lds
    s_add_u32 m0, s63, 22272
    s_nop 0
    buffer_load_dwordx4 v30, s[16:19], s33 offen offset:256 nt lds
    v_add_u32 v31, v18, v29
    s_add_u32 m0, s63, 11264
    s_nop 0
    buffer_load_dwordx4 v31, s[16:19], s33 offen offset:0 nt lds
    s_add_u32 m0, s63, 23296
    s_nop 0
    buffer_load_dwordx4 v31, s[16:19], s33 offen offset:256 nt lds
    s_add_u32 m0, s32, 0
    s_add_u32 s65, s33, 1746432
    s_mov_b64 exec, s[42:43]
    buffer_load_dwordx4 v1, s[16:19], s65 offen nt lds
    s_mov_b64 exec, -1
    s_add_u32 m0, s31, -512
    s_nop 0
    buffer_load_dwordx4 v7, s[16:19], s33 offen offset:512 nt lds
    s_add_u32 m0, s31, 576
    s_nop 0
    buffer_load_dwordx4 v8, s[16:19], s33 offen offset:512 nt lds
    s_add_u32 m0, s31, 1664
    s_nop 0
    buffer_load_dwordx4 v9, s[16:19], s33 offen offset:512 nt lds
    s_add_u32 m0, s31, 2752
    s_nop 0
    buffer_load_dwordx4 v10, s[16:19], s33 offen offset:512 nt lds
    s_add_u32 m0, s31, 3840
    s_nop 0
    buffer_load_dwordx4 v11, s[16:19], s33 offen offset:512 nt lds
    s_add_u32 m0, s31, 4928
    s_nop 0
    buffer_load_dwordx4 v12, s[16:19], s33 offen offset:512 nt lds
    s_add_u32 m0, s31, 6016
    s_nop 0
    buffer_load_dwordx4 v13, s[16:19], s33 offen offset:512 nt lds
    s_add_u32 m0, s31, 7104
    s_nop 0
    buffer_load_dwordx4 v14, s[16:19], s33 offen offset:512 nt lds
    s_add_u32 m0, s31, 8192
    s_nop 0
    buffer_load_dwordx4 v15, s[16:19], s33 offen offset:512 nt lds
    s_add_u32 m0, s31, 9280
    s_nop 0
    buffer_load_dwordx4 v16, s[16:19], s33 offen offset:512 nt lds
    s_add_u32 m0, s31, 10368
    s_nop 0
    buffer_load_dwordx4 v17, s[16:19], s33 offen offset:512 nt lds
    s_add_u32 m0, s31, 11456
    s_nop 0
    buffer_load_dwordx4 v18, s[16:19], s33 offen offset:512 nt lds
    s_getpc_b64 s[64:65]
L_pc_here:
    s_sub_u32 s64, s64, L_pc_here-L_round
    s_subb_u32 s65, s65, 0
    s_mul_i32 s63, s28, 128
    v_add_u32 v22, s63, v25
    v_add_u32 v22, 0, v22
    v_min_u32 v22, CODE_LINES-1, v22
    v_lshlrev_b32 v22, 7, v22
    v_mov_b32 v23, s65
    v_add_co_u32 v22, vcc, s64, v22
    s_nop 1
    v_addc_co_u32 v23, vcc, 0, v23, vcc
    global_load_dword v40, v[22:23], off
    v_add_u32 v22, s63, v25
    v_add_u32 v22, 64, v22
    v_min_u32 v22, CODE_LINES-1, v22
    v_lshlrev_b32 v22, 7, v22
    v_mov_b32 v23, s65
    v_add_co_u32 v22, vcc, s64, v22
    s_nop 1
    v_addc_co_u32 v23, vcc, 0, v23, vcc
    global_load_dword v40, v[22:23], off
    s_branch L_join
L_nf_wait1:
    s_waitcnt vmcnt(14)
    s_branch L_w1
L_nf_wait2:
    s_waitcnt vmcnt(1) lgkmcnt(0)
    s_branch L_fw1
L_server:
    s_mov_b32 s16, s4
    s_mov_b32 s17, s5
    s_mov_b32 s18, 109734912
    s_mov_b32 s19, 0x20000
    s_mov_b32 s20, s14
    s_mov_b32 s21, s15
    s_mov_b32 s22, 5171200
    s_mov_b32 s23, 0x20000
    s_mov_b32 s48, s12
    s_mov_b32 s49, s13
    s_mov_b32 s50, 256
    s_mov_b32 s51, 0x20000
    s_mov_b32 s46, 284928
    s_mov_b32 s24, s14
    s_mov_b32 s25, s15
    s_mov_b32 s26, 589824
    s_mov_b32 s27, 0x20000
    s_mov_b32 s33, 0
    s_mov_b32 s58, 0
    s_mul_i32 s30, s2, 19
    s_mov_b32 s40, 19419
    s_mov_b32 s41, 1741824
    s_mov_b32 s44, 5376
    s_mov_b32 s45, 1536
    v_and_b32 v22, 3, v21
    v_mul_u32_u24 v22, 1088, v22
    v_lshrrev_b32 v23, 2, v21
    v_lshlrev_b32 v23, 8, v23
    v_lshlrev_b32 v24, 4, v20
    v_add3_u32 v36, v22, v23, v24
    v_mul_u32_u24 v22, 784, v21
    v_add3_u32 v22, v22, v24, 0
    v_add_u32 v31, 65536, v22
L_srv_pass:
    s_lshl_b32 s37, s33, 2
    v_add_u32 v39, 0, v20
    v_add_u32 v22, s30, v39
    v_cmp_gt_u32 vcc, 243, v22
    v_cmp_gt_u32 s[62:63], 19, v39
    v_mul_u32_u24 v37, 12, v22
    s_nop 1
    s_and_b64 vcc, vcc, s[62:63]
    v_add_u32 v37, s28, v37
    v_add_u32 v37, s37, v37
    v_mul_lo_u32 v38, v37, s40
    v_lshrrev_b32 v38, 20, v38
    v_mul_lo_u32 v38, v38, s41
    v_mul_lo_u32 v23, v37, s44
    v_lshlrev_b32 v24, 4, v21
    v_add3_u32 v23, v23, v38, v24
    v_add_u32 v23, 1746432, v23
    v_mov_b32 v24, 0x80000000
    v_cndmask_b32 v26, v24, v23, vcc
    v_add_u32 v39, 4, v20
    v_add_u32 v22, s30, v39
    v_cmp_gt_u32 vcc, 243, v22
    v_cmp_gt_u32 s[62:63], 19, v39
    v_mul_u32_u24 v37, 12, v22
    s_nop 1
    s_and_b64 vcc, vcc, s[62:63]
    v_add_u32 v37, s28, v37
    v_add_u32 v37, s37, v37
    v_mul_lo_u32 v38, v37, s40
    v_lshrrev_b32 v38, 20, v38
    v_mul_lo_u32 v38, v38, s41
    v_mul_lo_u32 v23, v37, s44
    v_lshlrev_b32 v24, 4, v21
    v_add3_u32 v23, v23, v38, v24
    v_add_u32 v23, 1746432, v23
    v_mov_b32 v24, 0x80000000
    v_cndmask_b32 v27, v24, v23, vcc
    v_add_u32 v39, 8, v20
    v_add_u32 v22, s30, v39
    v_cmp_gt_u32 vcc, 243, v22
    v_cmp_gt_u32 s[62:63], 19, v39
    v_mul_u32_u24 v37, 12, v22
    s_nop 1
    s_and_b64 vcc, vcc, s[62:63]
    v_add_u32 v37, s28, v37
    v_add_u32 v37, s37, v37
    v_mul_lo_u32 v38, v37, s40
    v_lshrrev_b32 v38, 20, v38
    v_mul_lo_u32 v38, v38, s41
    v_mul_lo_u32 v23, v37, s44
    v_lshlrev_b32 v24, 4, v21
    v_add3_u32 v23, v23, v38, v24
    v_add_u32 v23, 1746432, v23
    v_mov_b32 v24, 0x80000000
    v_cndmask_b32 v28, v24, v23, vcc
    v_add_u32 v39, 12, v20
    v_add_u32 v22, s30, v39
    v_cmp_gt_u32 vcc, 243, v22
    v_cmp_gt_u32 s[62:63], 19, v39
    v_mul_u32_u24 v37, 12, v22
    s_nop 1
    s_and_b64 vcc, vcc, s[62:63]
    v_add_u32 v37, s28, v37
    v_add_u32 v37, s37, v37
    v_mul_lo_u32 v38, v37, s40
    v_lshrrev_b32 v38, 20, v38
    v_mul_lo_u32 v38, v38, s41
    v_mul_lo_u32 v23, v37, s44
    v_lshlrev_b32 v24, 4, v21
    v_add3_u32 v23, v23, v38, v24
    v_add_u32 v23, 1746432, v23
    v_mov_b32 v24, 0x80000000
    v_cndmask_b32 v29, v24, v23, vcc
    v_add_u32 v39, 16, v20
    v_add_u32 v22, s30, v39
    v_cmp_gt_u32 vcc, 243, v22
    v_cmp_gt_u32 s[62:63], 19, v39
    v_mul_u32_u24 v37, 12, v22
    s_nop 1
    s_and_b64 vcc, vcc, s[62:63]
    v_add_u32 v37, s28, v37
    v_add_u32 v37, s37, v37
    v_mul_lo_u32 v38, v37, s40
    v_lshrrev_b32 v38, 20, v38
    v_mul_lo_u32 v38, v38, s41
    v_mul_lo_u32 v23, v37, s44
    v_lshlrev_b32 v24, 4, v21
    v_add3_u32 v23, v23, v38, v24
    v_add_u32 v23, 1746432, v23
    v_mov_b32 v24, 0x80000000
    v_cndmask_b32 v30, v24, v23, vcc
    s_mul_i32 s39, s28, 1088
    s_add_u32 m0, s39, 0
    s_nop 0
    buffer_load_dwordx4 v26, s[16:19], 0 offen offset:0 lds
    s_add_u32 m0, s39, 4096
    s_nop 0
    buffer_load_dwordx4 v26, s[16:19], 0 offen offset:256 lds
    s_add_u32 m0, s39, 8192
    s_nop 0
    buffer_load_dwordx4 v26, s[16:19], 0 offen offset:512 lds
    s_add_u32 m0, s39, 13056
    s_nop 0
    buffer_load_dwordx4 v27, s[16:19], 0 offen offset:0 lds
    s_add_u32 m0, s39, 17152
    s_nop 0
    buffer_load_dwordx4 v27, s[16:19], 0 offen offset:256 lds
    s_add_u32 m0, s39, 21248
    s_nop 0
    buffer_load_dwordx4 v27, s[16:19], 0 offen offset:512 lds
    s_add_u32 m0, s39, 26112
    s_nop 0
    buffer_load_dwordx4 v28, s[16:19], 0 offen offset:0 lds
    s_add_u32 m0, s39, 30208
    s_nop 0
    buffer_load_dwordx4 v28, s[16:19], 0 offen offset:256 lds
    s_add_u32 m0, s39, 34304
    s_nop 0
    buffer_load_dwordx4 v28, s[16:19], 0 offen offset:512 lds
    s_add_u32 m0, s39, 39168
    s_nop 0
    buffer_load_dwordx4 v29, s[16:19], 0 offen offset:0 lds
    s_add_u32 m0, s39, 43264
    s_nop 0
    buffer_load_dwordx4 v29, s[16:19], 0 offen offset:256 lds
    s_add_u32 m0, s39, 47360
    s_nop 0
    buffer_load_dwordx4 v29, s[16:19], 0 offen offset:512 lds
    s_add_u32 m0, s39, 52224
    s_nop 0
    buffer_load_dwordx4 v30, s[16:19], 0 offen offset:0 lds
    s_add_u32 m0, s39, 56320
    s_nop 0
    buffer_load_dwordx4 v30, s[16:19], 0 offen offset:256 lds
    s_add_u32 m0, s39, 60416
    s_nop 0
    buffer_load_dwordx4 v30, s[16:19], 0 offen offset:512 lds
    s_waitcnt vmcnt(0)
    s_barrier
    ds_read_b128 a[0:3], v36 offset:0
    ds_read_b128 a[4:7], v36 offset:64
    ds_read_b128 a[8:11], v36 offset:128
    ds_read_b128 a[12:15], v36 offset:192
    ds_read_b128 a[16:19], v36 offset:4352
    ds_read_b128 a[20:23], v36 offset:4416
    s_waitcnt lgkmcnt(0)
    ds_read_b128 a[24:27], v36 offset:4480
    ds_read_b128 a[28:31], v36 offset:4544
    ds_read_b128 a[32:35], v36 offset:8704
    ds_read_b128 a[36:39], v36 offset:8768
    ds_read_b128 a[40:43], v36 offset:8832
    ds_read_b128 a[44:47], v36 offset:8896
    s_waitcnt lgkmcnt(0)
    ds_read_b128 a[48:51], v36 offset:13056
    ds_read_b128 a[52:55], v36 offset:13120
    ds_read_b128 a[56:59], v36 offset:13184
    ds_read_b128 a[60:63], v36 offset:13248
    ds_read_b128 a[64:67], v36 offset:17408
    ds_read_b128 a[68:71], v36 offset:17472
    s_waitcnt lgkmcnt(0)
    ds_read_b128 a[72:75], v36 offset:17536
    ds_read_b128 a[76:79], v36 offset:17600
    ds_read_b128 a[80:83], v36 offset:21760
    ds_read_b128 a[84:87], v36 offset:21824
    ds_read_b128 a[88:91], v36 offset:21888
    ds_read_b128 a[92:95], v36 offset:21952
    s_waitcnt lgkmcnt(0)
    ds_read_b128 a[96:99], v36 offset:26112
    ds_read_b128 a[100:103], v36 offset:26176
    ds_read_b128 a[104:107], v36 offset:26240
    ds_read_b128 a[108:111], v36 offset:26304
    ds_read_b128 a[112:115], v36 offset:30464
    ds_read_b128 a[116:119], v36 offset:30528
    s_waitcnt lgkmcnt(0)
    ds_read_b128 a[120:123], v36 offset:30592
    ds_read_b128 a[124:127], v36 offset:30656
    ds_read_b128 a[128:131], v36 offset:34816
    ds_read_b128 a[132:135], v36 offset:34880
    ds_read_b128 a[136:139], v36 offset:34944
    ds_read_b128 a[140:143], v36 offset:35008
    s_waitcnt lgkmcnt(0)
    ds_read_b128 a[144:147], v36 offset:39168
    ds_read_b128 a[148:151], v36 offset:39232
    ds_read_b128 a[152:155], v36 offset:39296
    ds_read_b128 a[156:159], v36 offset:39360
    ds_read_b128 a[160:163], v36 offset:43520
    ds_read_b128 a[164:167], v36 offset:43584
    s_waitcnt lgkmcnt(0)
    ds_read_b128 a[168:171], v36 offset:43648
    ds_read_b128 a[172:175], v36 offset:43712
    ds_read_b128 a[176:179], v36 offset:47872
    ds_read_b128 a[180:183], v36 offset:47936
    ds_read_b128 a[184:187], v36 offset:48000
    ds_read_b128 a[188:191], v36 offset:48064
    s_waitcnt lgkmcnt(0)
    ds_read_b128 a[192:195], v36 offset:52224
    ds_read_b128 a[196:199], v36 offset:52288
    ds_read_b128 a[200:203], v36 offset:52352
    ds_read_b128 a[204:207], v36 offset:52416
    ds_read_b128 a[208:211], v36 offset:56576
    ds_read_b128 a[212:215], v36 offset:56640
    s_waitcnt lgkmcnt(0)
    ds_read_b128 a[216:219], v36 offset:56704
    ds_read_b128 a[220:223], v36 offset:56768
    ds_read_b128 a[224:227], v36 offset:60928
    ds_read_b128 a[228:231], v36 offset:60992
    ds_read_b128 a[232:235], v36 offset:61056
    ds_read_b128 a[236:239], v36 offset:61120
    s_waitcnt lgkmcnt(0)
    s_cmp_lg_u32 s33, 0
    s_cbranch_scc1 L_srv_go0
    s_cmp_lg_u32 s28, 0
    s_cbranch_scc1 L_srv_go0
    s_cmp_lg_u32 s2, 0
    s_cbranch_scc1 L_srv_pollgo
    v_and_b32 v24, 7, v25
    v_lshlrev_b32 v24, 4, v24
    s_mov_b32 s61, 0
L_poll_cnt:
    buffer_load_dword v23, v24, s[48:51], 0 offen sc1
    s_waitcnt vmcnt(0)
    v_cmp_eq_u32 vcc, 18, v23
    s_add_u32 s61, s61, 1
    s_nop 1
    s_cmp_eq_u64 vcc, -1
    s_cbranch_scc1 L_polled_cnt
    s_cmp_ge_u32 s61, 400000
    s_cbranch_scc1 L_polled_cnt
    s_sleep 1
    s_branch L_poll_cnt
L_polled_cnt:
    v_mov_b32 v22, 1
    s_mov_b64 exec, 1
    buffer_store_dword v22, off, s[48:51], 0 offset:128 sc1
    s_mov_b64 exec, -1
    s_branch L_srv_go1
L_srv_pollgo:
    s_mov_b32 s61, 0
L_poll_s:
    buffer_load_dword v23, off, s[48:51], 0 offset:128 sc1
    s_waitcnt vmcnt(0)
    v_readfirstlane_b32 s63, v23
    s_add_u32 s61, s61, 1
    s_nop 0
    s_cmp_eq_u32 s63, 1
    s_cbranch_scc1 L_polled_s
    s_cmp_ge_u32 s61, 400000
    s_cbranch_scc1 L_polled_s
    s_sleep 2
    s_branch L_poll_s
L_polled_s:
L_srv_go1:
L_srv_go0:
    s_barrier
L_srv_go:
    s_mul_i32 s34, s28, 24576
    s_mov_b32 s35, 0
    s_add_u32 s36, s34, 0
    buffer_load_dwordx4 v[40:43], v1, s[24:27], s36 offen offset:0 sc1
    s_add_u32 s36, s34, 1024
    buffer_load_dwordx4 v[44:47], v1, s[24:27], s36 offen offset:0 sc1
    s_add_u32 s36, s34, 2048
    buffer_load_dwordx4 v[48:51], v1, s[24:27], s36 offen offset:0 sc1
    s_add_u32 s36, s34, 3072
    buffer_load_dwordx4 v[52:55], v1, s[24:27], s36 offen offset:0 sc1
    s_add_u32 s36, s34, 4096
    buffer_load_dwordx4 v[56:59], v1, s[24:27], s36 offen offset:0 sc1
    s_add_u32 s36, s34, 5120
    buffer_load_dwordx4 v[60:63], v1, s[24:27], s36 offen offset:0 sc1
    s_add_u32 s36, s34, 6144
    buffer_load_dwordx4 v[64:67], v1, s[24:27], s36 offen offset:0 sc1
    s_add_u32 s36, s34, 7168
    buffer_load_dwordx4 v[68:71], v1, s[24:27], s36 offen offset:0 sc1
    s_add_u32 s36, s34, 8192
    buffer_load_dwordx4 v[72:75], v1, s[24:27], s36 offen offset:0 sc1
    s_add_u32 s36, s34, 9216
    buffer_load_dwordx4 v[76:79], v1, s[24:27], s36 offen offset:0 sc1
    s_add_u32 s36, s34, 10240
    buffer_load_dwordx4 v[80:83], v1, s[24:27], s36 offen offset:0 sc1
    s_add_u32 s36, s34, 11264
    buffer_load_dwordx4 v[84:87], v1, s[24:27], s36 offen offset:0 sc1
L_srv_stage:
    s_waitcnt vmcnt(11)
    v_mfma_f32_16x16x32_bf16 v[136:139], v[40:43], a[0:3], 0
    v_mfma_f32_16x16x32_bf16 v[140:143], v[40:43], a[48:51], 0
    v_mfma_f32_16x16x32_bf16 v[144:147], v[40:43], a[96:99], 0
    v_mfma_f32_16x16x32_bf16 v[148:151], v[40:43], a[144:147], 0
    v_mfma_f32_16x16x32_bf16 v[152:155], v[40:43], a[192:195], 0
    s_add_u32 s36, s34, 12288
    buffer_load_dwordx4 v[40:43], v1, s[24:27], s36 offen offset:0 sc1
    s_waitcnt vmcnt(11)
    v_mfma_f32_16x16x32_bf16 v[156:159], v[44:47], a[0:3], 0
    v_mfma_f32_16x16x32_bf16 v[160:163], v[44:47], a[48:51], 0
    v_mfma_f32_16x16x32_bf16 v[164:167], v[44:47], a[96:99], 0
    v_mfma_f32_16x16x32_bf16 v[168:171], v[44:47], a[144:147], 0
    v_mfma_f32_16x16x32_bf16 v[172:175], v[44:47], a[192:195], 0
    s_add_u32 s36, s34, 13312
    buffer_load_dwordx4 v[44:47], v1, s[24:27], s36 offen offset:0 sc1
    s_waitcnt vmcnt(11)
    v_mfma_f32_16x16x32_bf16 v[136:139], v[48:51], a[4:7], v[136:139]
    v_mfma_f32_16x16x32_bf16 v[140:143], v[48:51], a[52:55], v[140:143]
    v_mfma_f32_16x16x32_bf16 v[144:147], v[48:51], a[100:103], v[144:147]
    v_mfma_f32_16x16x32_bf16 v[148:151], v[48:51], a[148:151], v[148:151]
    v_mfma_f32_16x16x32_bf16 v[152:155], v[48:51], a[196:199], v[152:155]
    s_add_u32 s36, s34, 14336
    buffer_load_dwordx4 v[48:51], v1, s[24:27], s36 offen offset:0 sc1
    s_waitcnt vmcnt(11)
    v_mfma_f32_16x16x32_bf16 v[156:159], v[52:55], a[4:7], v[156:159]
    v_mfma_f32_16x16x32_bf16 v[160:163], v[52:55], a[52:55], v[160:163]
    v_mfma_f32_16x16x32_bf16 v[164:167], v[52:55], a[100:103], v[164:167]
    v_mfma_f32_16x16x32_bf16 v[168:171], v[52:55], a[148:151], v[168:171]
    v_mfma_f32_16x16x32_bf16 v[172:175], v[52:55], a[196:199], v[172:175]
    s_add_u32 s36, s34, 15360
    buffer_load_dwordx4 v[52:55], v1, s[24:27], s36 offen offset:0 sc1
    s_waitcnt vmcnt(11)
    v_mfma_f32_16x16x32_bf16 v[136:139], v[56:59], a[8:11], v[136:139]
    v_mfma_f32_16x16x32_bf16 v[140:143], v[56:59], a[56:59], v[140:143]
    v_mfma_f32_16x16x32_bf16 v[144:147], v[56:59], a[104:107], v[144:147]
    v_mfma_f32_16x16x32_bf16 v[148:151], v[56:59], a[152:155], v[148:151]
    v_mfma_f32_16x16x32_bf16 v[152:155], v[56:59], a[200:203], v[152:155]
    s_add_u32 s36, s34, 16384
    buffer_load_dwordx4 v[56:59], v1, s[24:27], s36 offen offset:0 sc1
    s_waitcnt vmcnt(11)
    v_mfma_f32_16x16x32_bf16 v[156:159], v[60:63], a[8:11], v[156:159]
    v_mfma_f32_16x16x32_bf16 v[160:163], v[60:63], a[56:59], v[160:163]
    v_mfma_f32_16x16x32_bf16 v[164:167], v[60:63], a[104:107], v[164:167]
    v_mfma_f32_16x16x32_bf16 v[168:171], v[60:63], a[152:155], v[168:171]
    v_mfma_f32_16x16x32_bf16 v[172:175], v[60:63], a[200:203], v[172:175]
    s_add_u32 s36, s34, 17408
    buffer_load_dwordx4 v[60:63], v1, s[24:27], s36 offen offset:0 sc1
    s_waitcnt vmcnt(11)
    v_mfma_f32_16x16x32_bf16 v[136:139], v[64:67], a[12:15], v[136:139]
    v_mfma_f32_16x16x32_bf16 v[140:143], v[64:67], a[60:63], v[140:143]
    v_mfma_f32_16x16x32_bf16 v[144:147], v[64:67], a[108:111], v[144:147]
    v_mfma_f32_16x16x32_bf16 v[148:151], v[64:67], a[156:159], v[148:151]
    v_mfma_f32_16x16x32_bf16 v[152:155], v[64:67], a[204:207], v[152:155]
    s_add_u32 s36, s34, 18432
    buffer_load_dwordx4 v[64:67], v1, s[24:27], s36 offen offset:0 sc1
    s_waitcnt vmcnt(11)
    v_mfma_f32_16x16x32_bf16 v[156:159], v[68:71], a[12:15], v[156:159]
    v_mfma_f32_16x16x32_bf16 v[160:163], v[68:71], a[60:63], v[160:163]
    v_mfma_f32_16x16x32_bf16 v[164:167], v[68:71], a[108:111], v[164:167]
    v_mfma_f32_16x16x32_bf16 v[168:171], v[68:71], a[156:159], v[168:171]
    v_mfma_f32_16x16x32_bf16 v[172:175], v[68:71], a[204:207], v[172:175]
    s_add_u32 s36, s34, 19456
    buffer_load_dwordx4 v[68:71], v1, s[24:27], s36 offen offset:0 sc1
    s_waitcnt vmcnt(11)
    v_mfma_f32_16x16x32_bf16 v[136:139], v[72:75], a[16:19], v[136:139]
    v_mfma_f32_16x16x32_bf16 v[140:143], v[72:75], a[64:67], v[140:143]
    v_mfma_f32_16x16x32_bf16 v[144:147], v[72:75], a[112:115], v[144:147]
    v_mfma_f32_16x16x32_bf16 v[148:151], v[72:75], a[160:163], v[148:151]
    v_mfma_f32_16x16x32_bf16 v[152:155], v[72:75], a[208:211], v[152:155]
    s_add_u32 s36, s34, 20480
    buffer_load_dwordx4 v[72:75], v1, s[24:27], s36 offen offset:0 sc1
    s_waitcnt vmcnt(11)
    v_mfma_f32_16x16x32_bf16 v[156:159], v[76:79], a[16:19], v[156:159]
    v_mfma_f32_16x16x32_bf16 v[160:163], v[76:79], a[64:67], v[160:163]
    v_mfma_f32_16x16x32_bf16 v[164:167], v[76:79], a[112:115], v[164:167]
    v_mfma_f32_16x16x32_bf16 v[168:171], v[76:79], a[160:163], v[168:171]
    v_mfma_f32_16x16x32_bf16 v[172:175], v[76:79], a[208:211], v[172:175]
    s_add_u32 s36, s34, 21504
    buffer_load_dwordx4 v[76:79], v1, s[24:27], s36 offen offset:0 sc1
    s_waitcnt vmcnt(11)
    v_mfma_f32_16x16x32_bf16 v[136:139], v[80:83], a[20:23], v[136:139]
    v_mfma_f32_16x16x32_bf16 v[140:143], v[80:83], a[68:71], v[140:143]
    v_mfma_f32_16x16x32_bf16 v[144:147], v[80:83], a[116:119], v[144:147]
    v_mfma_f32_16x16x32_bf16 v[148:151], v[80:83], a[164:167], v[148:151]
    v_mfma_f32_16x16x32_bf16 v[152:155], v[80:83], a[212:215], v[152:155]
    s_add_u32 s36, s34, 22528
    buffer_load_dwordx4 v[80:83], v1, s[24:27], s36 offen offset:0 sc1
    s_waitcnt vmcnt(11)
    v_mfma_f32_16x16x32_bf16 v[156:159], v[84:87], a[20:23], v[156:159]
    v_mfma_f32_16x16x32_bf16 v[160:163], v[84:87], a[68:71], v[160:163]
    v_mfma_f32_16x16x32_bf16 v[164:167], v[84:87], a[116:119], v[164:167]
    v_mfma_f32_16x16x32_bf16 v[168:171], v[84:87], a[164:167], v[168:171]
    v_mfma_f32_16x16x32_bf16 v[172:175], v[84:87], a[212:215], v[172:175]
    s_add_u32 s36, s34, 23552
    buffer_load_dwordx4 v[84:87], v1, s[24:27], s36 offen offset:0 sc1
    s_waitcnt vmcnt(11)
    v_mfma_f32_16x16x32_bf16 v[136:139], v[40:43], a[24:27], v[136:139]
    v_mfma_f32_16x16x32_bf16 v[140:143], v[40:43], a[72:75], v[140:143]
    v_mfma_f32_16x16x32_bf16 v[144:147], v[40:43], a[120:123], v[144:147]
    v_mfma_f32_16x16x32_bf16 v[148:151], v[40:43], a[168:171], v[148:151]
    v_mfma_f32_16x16x32_bf16 v[152:155], v[40:43], a[216:219], v[152:155]
    s_add_u32 s36, s34, 98304
    s_min_u32 s36, s36, 588800
    buffer_load_dwordx4 v[40:43], v1, s[24:27], s36 offen offset:0 sc1
    s_waitcnt vmcnt(11)
    v_mfma_f32_16x16x32_bf16 v[156:159], v[44:47], a[24:27], v[156:159]
    v_mfma_f32_16x16x32_bf16 v[160:163], v[44:47], a[72:75], v[160:163]
    v_mfma_f32_16x16x32_bf16 v[164:167], v[44:47], a[120:123], v[164:167]
    v_mfma_f32_16x16x32_bf16 v[168:171], v[44:47], a[168:171], v[168:171]
    v_mfma_f32_16x16x32_bf16 v[172:175], v[44:47], a[216:219], v[172:175]
    s_add_u32 s36, s34, 99328
    s_min_u32 s36, s36, 588800
    buffer_load_dwordx4 v[44:47], v1, s[24:27], s36 offen offset:0 sc1
    s_waitcnt vmcnt(11)
    v_mfma_f32_16x16x32_bf16 v[136:139], v[48:51], a[28:31], v[136:139]
    v_mfma_f32_16x16x32_bf16 v[140:143], v[48:51], a[76:79], v[140:143]
    v_mfma_f32_16x16x32_bf16 v[144:147], v[48:51], a[124:127], v[144:147]
    v_mfma_f32_16x16x32_bf16 v[148:151], v[48:51], a[172:175], v[148:151]
    v_mfma_f32_16x16x32_bf16 v[152:155], v[48:51], a[220:223], v[152:155]
    s_add_u32 s36, s34, 100352
    s_min_u32 s36, s36, 588800
    buffer_load_dwordx4 v[48:51], v1, s[24:27], s36 offen offset:0 sc1
    s_waitcnt vmcnt(11)
    v_mfma_f32_16x16x32_bf16 v[156:159], v[52:55], a[28:31], v[156:159]
    v_mfma_f32_16x16x32_bf16 v[160:163], v[52:55], a[76:79], v[160:163]
    v_mfma_f32_16x16x32_bf16 v[164:167], v[52:55], a[124:127], v[164:167]
    v_mfma_f32_16x16x32_bf16 v[168:171], v[52:55], a[172:175], v[168:171]
    v_mfma_f32_16x16x32_bf16 v[172:175], v[52:55], a[220:223], v[172:175]
    s_add_u32 s36, s34, 101376
    s_min_u32 s36, s36, 588800
    buffer_load_dwordx4 v[52:55], v1, s[24:27], s36 offen offset:0 sc1
    s_waitcnt vmcnt(11)
    v_mfma_f32_16x16x32_bf16 v[136:139], v[56:59], a[32:35], v[136:139]
    v_mfma_f32_16x16x32_bf16 v[140:143], v[56:59], a[80:83], v[140:143]
    v_mfma_f32_16x16x32_bf16 v[144:147], v[56:59], a[128:131], v[144:147]
    v_mfma_f32_16x16x32_bf16 v[148:151], v[56:59], a[176:179], v[148:151]
    v_mfma_f32_16x16x32_bf16 v[152:155], v[56:59], a[224:227], v[152:155]
    s_add_u32 s36, s34, 102400
    s_min_u32 s36, s36, 588800
    buffer_load_dwordx4 v[56:59], v1, s[24:27], s36 offen offset:0 sc1
    s_waitcnt vmcnt(11)
    v_mfma_f32_16x16x32_bf16 v[156:159], v[60:63], a[32:35], v[156:159]
    v_mfma_f32_16x16x32_bf16 v[160:163], v[60:63], a[80:83], v[160:163]
    v_mfma_f32_16x16x32_bf16 v[164:167], v[60:63], a[128:131], v[164:167]
    v_mfma_f32_16x16x32_bf16 v[168:171], v[60:63], a[176:179], v[168:171]
    v_mfma_f32_16x16x32_bf16 v[172:175], v[60:63], a[224:227], v[172:175]
    s_add_u32 s36, s34, 103424
    s_min_u32 s36, s36, 588800
    buffer_load_dwordx4 v[60:63], v1, s[24:27], s36 offen offset:0 sc1
    s_waitcnt vmcnt(11)
    v_mfma_f32_16x16x32_bf16 v[136:139], v[64:67], a[36:39], v[136:139]
    v_mfma_f32_16x16x32_bf16 v[140:143], v[64:67], a[84:87], v[140:143]
    v_mfma_f32_16x16x32_bf16 v[144:147], v[64:67], a[132:135], v[144:147]
    v_mfma_f32_16x16x32_bf16 v[148:151], v[64:67], a[180:183], v[148:151]
    v_mfma_f32_16x16x32_bf16 v[152:155], v[64:67], a[228:231], v[152:155]
    s_add_u32 s36, s34, 104448
    s_min_u32 s36, s36, 588800
    buffer_load_dwordx4 v[64:67], v1, s[24:27], s36 offen offset:0 sc1
    s_waitcnt vmcnt(11)
    v_mfma_f32_16x16x32_bf16 v[156:159], v[68:71], a[36:39], v[156:159]
    v_mfma_f32_16x16x32_bf16 v[160:163], v[68:71], a[84:87], v[160:163]
    v_mfma_f32_16x16x32_bf16 v[164:167], v[68:71], a[132:135], v[164:167]
    v_mfma_f32_16x16x32_bf16 v[168:171], v[68:71], a[180:183], v[168:171]
    v_mfma_f32_16x16x32_bf16 v[172:175], v[68:71], a[228:231], v[172:175]
    s_add_u32 s36, s34, 105472
    s_min_u32 s36, s36, 588800
    buffer_load_dwordx4 v[68:71], v1, s[24:27], s36 offen offset:0 sc1
    s_waitcnt vmcnt(11)
    v_mfma_f32_16x16x32_bf16 v[136:139], v[72:75], a[40:43], v[136:139]
    v_mfma_f32_16x16x32_bf16 v[140:143], v[72:75], a[88:91], v[140:143]
    v_mfma_f32_16x16x32_bf16 v[144:147], v[72:75], a[136:139], v[144:147]
    v_mfma_f32_16x16x32_bf16 v[148:151], v[72:75], a[184:187], v[148:151]
    v_mfma_f32_16x16x32_bf16 v[152:155], v[72:75], a[232:235], v[152:155]
    s_add_u32 s36, s34, 106496
    s_min_u32 s36, s36, 588800
    buffer_load_dwordx4 v[72:75], v1, s[24:27], s36 offen offset:0 sc1
    s_waitcnt vmcnt(11)
    v_mfma_f32_16x16x32_bf16 v[156:159], v[76:79], a[40:43], v[156:159]
    v_mfma_f32_16x16x32_bf16 v[160:163], v[76:79], a[88:91], v[160:163]
    v_mfma_f32_16x16x32_bf16 v[164:167], v[76:79], a[136:139], v[164:167]
    v_mfma_f32_16x16x32_bf16 v[168:171], v[76:79], a[184:187], v[168:171]
    v_mfma_f32_16x16x32_bf16 v[172:175], v[76:79], a[232:235], v[172:175]
    s_add_u32 s36, s34, 107520
    s_min_u32 s36, s36, 588800
    buffer_load_dwordx4 v[76:79], v1, s[24:27], s36 offen offset:0 sc1
    s_waitcnt vmcnt(11)
    v_mfma_f32_16x16x32_bf16 v[136:139], v[80:83], a[44:47], v[136:139]
    v_mfma_f32_16x16x32_bf16 v[140:143], v[80:83], a[92:95], v[140:143]
    v_mfma_f32_16x16x32_bf16 v[144:147], v[80:83], a[140:143], v[144:147]
    v_mfma_f32_16x16x32_bf16 v[148:151], v[80:83], a[188:191], v[148:151]
    v_mfma_f32_16x16x32_bf16 v[152:155], v[80:83], a[236:239], v[152:155]
    s_add_u32 s36, s34, 108544
    s_min_u32 s36, s36, 588800
    buffer_load_dwordx4 v[80:83], v1, s[24:27], s36 offen offset:0 sc1
    s_waitcnt vmcnt(11)
    v_mfma_f32_16x16x32_bf16 v[156:159], v[84:87], a[44:47], v[156:159]
    v_mfma_f32_16x16x32_bf16 v[160:163], v[84:87], a[92:95], v[160:163]
    v_mfma_f32_16x16x32_bf16 v[164:167], v[84:87], a[140:143], v[164:167]
    v_mfma_f32_16x16x32_bf16 v[168:171], v[84:87], a[188:191], v[168:171]
    v_mfma_f32_16x16x32_bf16 v[172:175], v[84:87], a[236:239], v[172:175]
    s_add_u32 s36, s34, 109568
    s_min_u32 s36, s36, 588800
    buffer_load_dwordx4 v[84:87], v1, s[24:27], s36 offen offset:0 sc1
    s_nop 7
    s_cmp_eq_u32 s58, 0
    s_cbranch_scc1 L_srv_nopend
    s_barrier
    s_cmp_lg_u32 s28, 0
    s_cbranch_scc1 L_srv_pend1
    s_mul_i32 s39, s33, 13
    s_add_u32 s39, s39, s2
    s_add_u32 s39, s39, 132
    v_mov_b32 v22, s58
    s_mov_b64 exec, 1
    buffer_store_byte v22, off, s[48:51], s39 sc1
    s_mov_b64 exec, -1
L_srv_pend1:
    s_mov_b32 s58, 0
L_srv_nopend:
    s_cmp_ge_u32 s35, 3
    s_cbranch_scc1 L_srv_v
    v_cvt_pk_bf16_f32 v176, v136, v137
    v_cvt_pk_bf16_f32 v177, v138, v139
    v_cvt_pk_bf16_f32 v178, v156, v157
    v_cvt_pk_bf16_f32 v179, v158, v159
    v_cvt_pk_bf16_f32 v180, v140, v141
    v_cvt_pk_bf16_f32 v181, v142, v143
    v_cvt_pk_bf16_f32 v182, v160, v161
    v_cvt_pk_bf16_f32 v183, v162, v163
    v_cvt_pk_bf16_f32 v184, v144, v145
    v_cvt_pk_bf16_f32 v185, v146, v147
    v_cvt_pk_bf16_f32 v186, v164, v165
    v_cvt_pk_bf16_f32 v187, v166, v167
    v_cvt_pk_bf16_f32 v188, v148, v149
    v_cvt_pk_bf16_f32 v189, v150, v151
    v_cvt_pk_bf16_f32 v190, v168, v169
    v_cvt_pk_bf16_f32 v191, v170, v171
    v_cvt_pk_bf16_f32 v192, v152, v153
    v_cvt_pk_bf16_f32 v193, v154, v155
    v_cvt_pk_bf16_f32 v194, v172, v173
    v_cvt_pk_bf16_f32 v195, v174, v175
    s_lshl_b32 s39, s35, 2
    s_add_u32 s39, s39, s28
    s_lshl_b32 s39, s39, 6
    s_branch L_srv_st
L_srv_v:
    v_cvt_pk_bf16_f32 v176, v136, v156
    v_cvt_pk_bf16_f32 v177, v137, v157
    v_cvt_pk_bf16_f32 v178, v138, v158
    v_cvt_pk_bf16_f32 v179, v139, v159
    v_cvt_pk_bf16_f32 v180, v140, v160
    v_cvt_pk_bf16_f32 v181, v141, v161
    v_cvt_pk_bf16_f32 v182, v142, v162
    v_cvt_pk_bf16_f32 v183, v143, v163
    v_cvt_pk_bf16_f32 v184, v144, v164
    v_cvt_pk_bf16_f32 v185, v145, v165
    v_cvt_pk_bf16_f32 v186, v146, v166
    v_cvt_pk_bf16_f32 v187, v147, v167
    v_cvt_pk_bf16_f32 v188, v148, v168
    v_cvt_pk_bf16_f32 v189, v149, v169
    v_cvt_pk_bf16_f32 v190, v150, v170
    v_cvt_pk_bf16_f32 v191, v151, v171
    v_cvt_pk_bf16_f32 v192, v152, v172
    v_cvt_pk_bf16_f32 v193, v153, v173
    v_cvt_pk_bf16_f32 v194, v154, v174
    v_cvt_pk_bf16_f32 v195, v155, v175
    s_sub_u32 s39, s35, 3
    s_lshl_b32 s39, s39, 2
    s_add_u32 s39, s39, s28
    s_lshl_b32 s39, s39, 6
L_srv_st:
    v_add_u32 v32, s39, v31
    ds_write_b128 v32, v[176:179] offset:0
    ds_write_b128 v32, v[180:183] offset:12544
    ds_write_b128 v32, v[184:187] offset:25088
    ds_write_b128 v32, v[188:191] offset:37632
    ds_write_b128 v32, v[192:195] offset:50176
    s_add_u32 s34, s34, 98304
    s_add_u32 s35, s35, 1
    s_cmp_eq_u32 s35, 3
    s_cbranch_scc1 L_srv_flag
    s_cmp_ge_u32 s35, 5
    s_cbranch_scc0 L_srv_stage
L_srv_flag:
    s_cmp_eq_u32 s35, 3
    s_cselect_b32 s46, -1, -1
    s_cselect_b32 s47, 0xffff, 0
    s_cselect_b32 s52, 0, 768
    s_cselect_b32 s37, 1, 2
    s_mov_b32 s53, 0
    s_cmp_eq_u32 s35, 6
    s_cselect_b32 s46, 0xffff, s46
    s_cselect_b32 s52, 1280, s52
    s_cselect_b32 s53, 512, s53
    s_cselect_b32 s37, 3, s37
    s_mul_i32 s54, s28, 15680
    s_add_u32 s54, s54, s53
    s_add_u32 s54, s54, 65536
    v_add_u32 v33, s54, v1
    s_mul_i32 s55, s28, 5
    s_lshl_b32 s56, s33, 2
    s_waitcnt lgkmcnt(0)
    s_barrier
    ds_read_b128 v[196:199], v33 offset:0
    ds_read_b128 v[200:203], v33 offset:784
    ds_read_b128 v[204:207], v33 offset:1568
    ds_read_b128 v[208:211], v33 offset:2352
    ds_read_b128 v[212:215], v33 offset:3136
    ds_read_b128 v[216:219], v33 offset:3920
    ds_read_b128 v[220:223], v33 offset:4704
    ds_read_b128 v[224:227], v33 offset:5488
    ds_read_b128 v[228:231], v33 offset:6272
    ds_read_b128 v[232:235], v33 offset:7056
    s_waitcnt lgkmcnt(0)
    s_mov_b64 exec, s[46:47]
    s_add_u32 s57, s55, 0
    s_cmp_lt_u32 s57, 19
    s_cbranch_scc0 L_srv_sk0
    s_add_u32 s57, s57, s30
    s_cmp_lt_u32 s57, 243
    s_cbranch_scc0 L_srv_sk0
    s_mul_i32 s57, s57, 12
    s_add_u32 s57, s57, s56
    s_add_u32 s57, s57, 0
    s_mul_i32 s57, s57, 1536
    s_add_u32 s57, s57, s52
    s_add_u32 s57, s57, 593920
    buffer_store_dwordx4 v[196:199], v1, s[20:23], s57 offen sc1
L_srv_sk0:
    s_add_u32 s57, s55, 0
    s_cmp_lt_u32 s57, 19
    s_cbranch_scc0 L_srv_sk1
    s_add_u32 s57, s57, s30
    s_cmp_lt_u32 s57, 243
    s_cbranch_scc0 L_srv_sk1
    s_mul_i32 s57, s57, 12
    s_add_u32 s57, s57, s56
    s_add_u32 s57, s57, 1
    s_mul_i32 s57, s57, 1536
    s_add_u32 s57, s57, s52
    s_add_u32 s57, s57, 593920
    buffer_store_dwordx4 v[200:203], v1, s[20:23], s57 offen sc1
L_srv_sk1:
    s_add_u32 s57, s55, 0
    s_cmp_lt_u32 s57, 19
    s_cbranch_scc0 L_srv_sk2
    s_add_u32 s57, s57, s30
    s_cmp_lt_u32 s57, 243
    s_cbranch_scc0 L_srv_sk2
    s_mul_i32 s57, s57, 12
    s_add_u32 s57, s57, s56
    s_add_u32 s57, s57, 2
    s_mul_i32 s57, s57, 1536
    s_add_u32 s57, s57, s52
    s_add_u32 s57, s57, 593920
    buffer_store_dwordx4 v[204:207], v1, s[20:23], s57 offen sc1
L_srv_sk2:
    s_add_u32 s57, s55, 0
    s_cmp_lt_u32 s57, 19
    s_cbranch_scc0 L_srv_sk3
    s_add_u32 s57, s57, s30
    s_cmp_lt_u32 s57, 243
    s_cbranch_scc0 L_srv_sk3
    s_mul_i32 s57, s57, 12
    s_add_u32 s57, s57, s56
    s_add_u32 s57, s57, 3
    s_mul_i32 s57, s57, 1536
    s_add_u32 s57, s57, s52
    s_add_u32 s57, s57, 593920
    buffer_store_dwordx4 v[208:211], v1, s[20:23], s57 offen sc1
L_srv_sk3:
    s_add_u32 s57, s55, 1
    s_cmp_lt_u32 s57, 19
    s_cbranch_scc0 L_srv_sk4
    s_add_u32 s57, s57, s30
    s_cmp_lt_u32 s57, 243
    s_cbranch_scc0 L_srv_sk4
    s_mul_i32 s57, s57, 12
    s_add_u32 s57, s57, s56
    s_add_u32 s57, s57, 0
    s_mul_i32 s57, s57, 1536
    s_add_u32 s57, s57, s52
    s_add_u32 s57, s57, 593920
    buffer_store_dwordx4 v[212:215], v1, s[20:23], s57 offen sc1
L_srv_sk4:
    s_add_u32 s57, s55, 1
    s_cmp_lt_u32 s57, 19
    s_cbranch_scc0 L_srv_sk5
    s_add_u32 s57, s57, s30
    s_cmp_lt_u32 s57, 243
    s_cbranch_scc0 L_srv_sk5
    s_mul_i32 s57, s57, 12
    s_add_u32 s57, s57, s56
    s_add_u32 s57, s57, 1
    s_mul_i32 s57, s57, 1536
    s_add_u32 s57, s57, s52
    s_add_u32 s57, s57, 593920
    buffer_store_dwordx4 v[216:219], v1, s[20:23], s57 offen sc1
L_srv_sk5:
    s_add_u32 s57, s55, 1
    s_cmp_lt_u32 s57, 19
    s_cbranch_scc0 L_srv_sk6
    s_add_u32 s57, s57, s30
    s_cmp_lt_u32 s57, 243
    s_cbranch_scc0 L_srv_sk6
    s_mul_i32 s57, s57, 12
    s_add_u32 s57, s57, s56
    s_add_u32 s57, s57, 2
    s_mul_i32 s57, s57, 1536
    s_add_u32 s57, s57, s52
    s_add_u32 s57, s57, 593920
    buffer_store_dwordx4 v[220:223], v1, s[20:23], s57 offen sc1
L_srv_sk6:
    s_add_u32 s57, s55, 1
    s_cmp_lt_u32 s57, 19
    s_cbranch_scc0 L_srv_sk7
    s_add_u32 s57, s57, s30
    s_cmp_lt_u32 s57, 243
    s_cbranch_scc0 L_srv_sk7
    s_mul_i32 s57, s57, 12
    s_add_u32 s57, s57, s56
    s_add_u32 s57, s57, 3
    s_mul_i32 s57, s57, 1536
    s_add_u32 s57, s57, s52
    s_add_u32 s57, s57, 593920
    buffer_store_dwordx4 v[224:227], v1, s[20:23], s57 offen sc1
L_srv_sk7:
    s_add_u32 s57, s55, 2
    s_cmp_lt_u32 s57, 19
    s_cbranch_scc0 L_srv_sk8
    s_add_u32 s57, s57, s30
    s_cmp_lt_u32 s57, 243
    s_cbranch_scc0 L_srv_sk8
    s_mul_i32 s57, s57, 12
    s_add_u32 s57, s57, s56
    s_add_u32 s57, s57, 0
    s_mul_i32 s57, s57, 1536
    s_add_u32 s57, s57, s52
    s_add_u32 s57, s57, 593920
    buffer_store_dwordx4 v[228:231], v1, s[20:23], s57 offen sc1
L_srv_sk8:
    s_add_u32 s57, s55, 2
    s_cmp_lt_u32 s57, 19
    s_cbranch_scc0 L_srv_sk9
    s_add_u32 s57, s57, s30
    s_cmp_lt_u32 s57, 243
    s_cbranch_scc0 L_srv_sk9
    s_mul_i32 s57, s57, 12
    s_add_u32 s57, s57, s56
    s_add_u32 s57, s57, 1
    s_mul_i32 s57, s57, 1536
    s_add_u32 s57, s57, s52
    s_add_u32 s57, s57, 593920
    buffer_store_dwordx4 v[232:235], v1, s[20:23], s57 offen sc1
L_srv_sk9:
    s_mov_b64 exec, -1
    s_nop 1
    ds_read_b128 v[196:199], v33 offset:7840
    ds_read_b128 v[200:203], v33 offset:8624
    ds_read_b128 v[204:207], v33 offset:9408
    ds_read_b128 v[208:211], v33 offset:10192
    ds_read_b128 v[212:215], v33 offset:10976
    ds_read_b128 v[216:219], v33 offset:11760
    ds_read_b128 v[220:223], v33 offset:12544
    ds_read_b128 v[224:227], v33 offset:13328
    ds_read_b128 v[228:231], v33 offset:14112
    ds_read_b128 v[232:235], v33 offset:14896
    s_waitcnt lgkmcnt(0)
    s_mov_b64 exec, s[46:47]
    s_add_u32 s57, s55, 2
    s_cmp_lt_u32 s57, 19
    s_cbranch_scc0 L_srv_sk10
    s_add_u32 s57, s57, s30
    s_cmp_lt_u32 s57, 243
    s_cbranch_scc0 L_srv_sk10
    s_mul_i32 s57, s57, 12
    s_add_u32 s57, s57, s56
    s_add_u32 s57, s57, 2
    s_mul_i32 s57, s57, 1536
    s_add_u32 s57, s57, s52
    s_add_u32 s57, s57, 593920
    buffer_store_dwordx4 v[196:199], v1, s[20:23], s57 offen sc1
L_srv_sk10:
    s_add_u32 s57, s55, 2
    s_cmp_lt_u32 s57, 19
    s_cbranch_scc0 L_srv_sk11
    s_add_u32 s57, s57, s30
    s_cmp_lt_u32 s57, 243
    s_cbranch_scc0 L_srv_sk11
    s_mul_i32 s57, s57, 12
    s_add_u32 s57, s57, s56
    s_add_u32 s57, s57, 3
    s_mul_i32 s57, s57, 1536
    s_add_u32 s57, s57, s52
    s_add_u32 s57, s57, 593920
    buffer_store_dwordx4 v[200:203], v1, s[20:23], s57 offen sc1
L_srv_sk11:
    s_add_u32 s57, s55, 3
    s_cmp_lt_u32 s57, 19
    s_cbranch_scc0 L_srv_sk12
    s_add_u32 s57, s57, s30
    s_cmp_lt_u32 s57, 243
    s_cbranch_scc0 L_srv_sk12
    s_mul_i32 s57, s57, 12
    s_add_u32 s57, s57, s56
    s_add_u32 s57, s57, 0
    s_mul_i32 s57, s57, 1536
    s_add_u32 s57, s57, s52
    s_add_u32 s57, s57, 593920
    buffer_store_dwordx4 v[204:207], v1, s[20:23], s57 offen sc1
L_srv_sk12:
    s_add_u32 s57, s55, 3
    s_cmp_lt_u32 s57, 19
    s_cbranch_scc0 L_srv_sk13
    s_add_u32 s57, s57, s30
    s_cmp_lt_u32 s57, 243
    s_cbranch_scc0 L_srv_sk13
    s_mul_i32 s57, s57, 12
    s_add_u32 s57, s57, s56
    s_add_u32 s57, s57, 1
    s_mul_i32 s57, s57, 1536
    s_add_u32 s57, s57, s52
    s_add_u32 s57, s57, 593920
    buffer_store_dwordx4 v[208:211], v1, s[20:23], s57 offen sc1
L_srv_sk13:
    s_add_u32 s57, s55, 3
    s_cmp_lt_u32 s57, 19
    s_cbranch_scc0 L_srv_sk14
    s_add_u32 s57, s57, s30
    s_cmp_lt_u32 s57, 243
    s_cbranch_scc0 L_srv_sk14
    s_mul_i32 s57, s57, 12
    s_add_u32 s57, s57, s56
    s_add_u32 s57, s57, 2
    s_mul_i32 s57, s57, 1536
    s_add_u32 s57, s57, s52
    s_add_u32 s57, s57, 593920
    buffer_store_dwordx4 v[212:215], v1, s[20:23], s57 offen sc1
L_srv_sk14:
    s_add_u32 s57, s55, 3
    s_cmp_lt_u32 s57, 19
    s_cbranch_scc0 L_srv_sk15
    s_add_u32 s57, s57, s30
    s_cmp_lt_u32 s57, 243
    s_cbranch_scc0 L_srv_sk15
    s_mul_i32 s57, s57, 12
    s_add_u32 s57, s57, s56
    s_add_u32 s57, s57, 3
    s_mul_i32 s57, s57, 1536
    s_add_u32 s57, s57, s52
    s_add_u32 s57, s57, 593920
    buffer_store_dwordx4 v[216:219], v1, s[20:23], s57 offen sc1
L_srv_sk15:
    s_add_u32 s57, s55, 4
    s_cmp_lt_u32 s57, 19
    s_cbranch_scc0 L_srv_sk16
    s_add_u32 s57, s57, s30
    s_cmp_lt_u32 s57, 243
    s_cbranch_scc0 L_srv_sk16
    s_mul_i32 s57, s57, 12
    s_add_u32 s57, s57, s56
    s_add_u32 s57, s57, 0
    s_mul_i32 s57, s57, 1536
    s_add_u32 s57, s57, s52
    s_add_u32 s57, s57, 593920
    buffer_store_dwordx4 v[220:223], v1, s[20:23], s57 offen sc1
L_srv_sk16:
    s_add_u32 s57, s55, 4
    s_cmp_lt_u32 s57, 19
    s_cbranch_scc0 L_srv_sk17
    s_add_u32 s57, s57, s30
    s_cmp_lt_u32 s57, 243
    s_cbranch_scc0 L_srv_sk17
    s_mul_i32 s57, s57, 12
    s_add_u32 s57, s57, s56
    s_add_u32 s57, s57, 1
    s_mul_i32 s57, s57, 1536
    s_add_u32 s57, s57, s52
    s_add_u32 s57, s57, 593920
    buffer_store_dwordx4 v[224:227], v1, s[20:23], s57 offen sc1
L_srv_sk17:
    s_add_u32 s57, s55, 4
    s_cmp_lt_u32 s57, 19
    s_cbranch_scc0 L_srv_sk18
    s_add_u32 s57, s57, s30
    s_cmp_lt_u32 s57, 243
    s_cbranch_scc0 L_srv_sk18
    s_mul_i32 s57, s57, 12
    s_add_u32 s57, s57, s56
    s_add_u32 s57, s57, 2
    s_mul_i32 s57, s57, 1536
    s_add_u32 s57, s57, s52
    s_add_u32 s57, s57, 593920
    buffer_store_dwordx4 v[228:231], v1, s[20:23], s57 offen sc1
L_srv_sk18:
    s_add_u32 s57, s55, 4
    s_cmp_lt_u32 s57, 19
    s_cbranch_scc0 L_srv_sk19
    s_add_u32 s57, s57, s30
    s_cmp_lt_u32 s57, 243
    s_cbranch_scc0 L_srv_sk19
    s_mul_i32 s57, s57, 12
    s_add_u32 s57, s57, s56
    s_add_u32 s57, s57, 3
    s_mul_i32 s57, s57, 1536
    s_add_u32 s57, s57, s52
    s_add_u32 s57, s57, 593920
    buffer_store_dwordx4 v[232:235], v1, s[20:23], s57 offen sc1
L_srv_sk19:
    s_mov_b64 exec, -1
    s_nop 1
    s_mov_b32 s58, s37
    s_cmp_lt_u32 s35, 6
    s_cbranch_scc1 L_srv_stage
    s_waitcnt vmcnt(0)
    s_barrier
    s_mov_b32 s58, 0
    s_cmp_lg_u32 s28, 0
    s_cbranch_scc1 L_srv_noflag
    s_mul_i32 s39, s33, 13
    s_add_u32 s39, s39, s2
    s_add_u32 s39, s39, 132
    v_mov_b32 v22, s37
    s_mov_b64 exec, 1
    buffer_store_byte v22, off, s[48:51], s39 sc1
    s_mov_b64 exec, -1
L_srv_noflag:
    s_add_u32 s33, s33, 1
    s_cmp_lt_u32 s33, 3
    s_cbranch_scc1 L_srv_pass
    s_waitcnt vmcnt(0)
    s_endpgm
L_code_end:
.set CODE_LINES, (L_code_end-L_round)/128
    .fill 256, 4, 0xbf800000
.section .rodata,"a"
.p2align 6
.amdhsa_kernel standalone__swin_window_attn__vision_kernel
  .amdhsa_next_free_vgpr 512
  .amdhsa_next_free_sgpr 102
  .amdhsa_accum_offset 256
  .amdhsa_group_segment_fixed_size 0
  .amdhsa_kernarg_size 48
  .amdhsa_user_sgpr_count 2
  .amdhsa_user_sgpr_kernarg_segment_ptr 1
  .amdhsa_system_sgpr_workgroup_id_x 1
  .amdhsa_float_denorm_mode_32 3
.end_amdhsa_kernel
```
